```python
import torch

def _softmax(x, axis=-1):
    return torch.softmax(x, dim=axis)
def _gelu(x):
    return torch.nn.functional.gelu(x, approximate="tanh")
def _silu(x):
    return torch.nn.functional.silu(x)
def _sigmoid(x):
    return torch.sigmoid(x)
def _layernorm(x, axis=-1, eps=1e-5):
    m = x.mean(dim=axis, keepdim=True)
    v = x.var(dim=axis, keepdim=True, unbiased=False)
    return (x - m) / torch.sqrt(v + eps)
def _scatter_add(tgt, idx, src, axis=0):
    return tgt.clone().index_add_(axis, idx, src)
def _segment_sum(src, seg, n):
    out = torch.zeros((n,) + src.shape[1:], dtype=src.dtype)
    return out.index_add_(0, seg, src)
def _pad(x, pw):
    flat = tuple(v for pair in reversed(pw) for v in pair)
    return torch.nn.functional.pad(x, flat)

kernel_name = 'interleave_layers__spectral_fnet__glu_gated_glu__prompt'

def setup_inputs():

    _w = (lambda a: (lambda t: t.to(torch.bfloat16) if t.is_floating_point() else t)(torch.as_tensor(a)))
    def _A_setup():
        B, S, D = 1, 2048, 1024
        ns = torch.arange(S)[:, None] * torch.arange(S)[None, :]
        nd = torch.arange(D)[:, None] * torch.arange(D)[None, :]
        Ws_re = torch.cos(-2.0 * torch.pi * ns / S).to(float)
        Ws_im = torch.sin(-2.0 * torch.pi * ns / S).to(float)
        Wd_re = torch.cos(-2.0 * torch.pi * nd / D).to(float)
        Wd_im = torch.sin(-2.0 * torch.pi * nd / D).to(float)
        return {
            "x": _w((lambda *s: torch.randn(*s, dtype=torch.bfloat16) * 0.05)(B, S, D)),
            "dft_seq_re": _w(Ws_re),
            "dft_seq_im": _w(Ws_im),
            "dft_hid_re": _w(Wd_re),
            "dft_hid_im": _w(Wd_im),
        }
    _A_in = _A_setup()

    def _B_setup():
        B, S, D, F = 1, 2048, 1024, 3584
        return {
            "x": _w((lambda *s: torch.randn(*s, dtype=torch.bfloat16) * 0.05)(B, S, D)),
            "w_gate": _w((lambda *s: torch.randn(*s, dtype=torch.bfloat16) * 1.6)(D, F)),
            "w_up": _w((lambda *s: torch.randn(*s, dtype=torch.bfloat16) * 0.8)(D, F)),
            "w_down": _w((lambda *s: torch.randn(*s, dtype=torch.bfloat16) * 0.8)(F, D)),
        }
    _B_in = _B_setup()

    return {
        "A_x": _A_in["x"],
        "A_dft_seq_re": _A_in["dft_seq_re"],
        "A_dft_seq_im": _A_in["dft_seq_im"],
        "A_dft_hid_re": _A_in["dft_hid_re"],
        "A_dft_hid_im": _A_in["dft_hid_im"],
        "B_x": _B_in["x"],
        "B_w_gate": _B_in["w_gate"],
        "B_w_up": _B_in["w_up"],
        "B_w_down": _B_in["w_down"],
    }

def reference(A_x, A_dft_seq_re, A_dft_seq_im, A_dft_hid_re, A_dft_hid_im, B_x, B_w_gate, B_w_up, B_w_down):
    def _A_ref(x, dft_seq_re, dft_seq_im, dft_hid_re, dft_hid_im):
        a = torch.einsum("bsd,ed->bse", x, dft_hid_re)
        b = torch.einsum("bsd,ed->bse", x, dft_hid_im)
        y = torch.einsum("ts,bse->bte", dft_seq_re, a) - torch.einsum("ts,bse->bte", dft_seq_im, b)
        return y

    def _B_ref(x, w_gate, w_up, w_down):
        g = torch.einsum("bsd,df->bsf", x, w_gate)
        u = torch.einsum("bsd,df->bsf", x, w_up)
        h = _sigmoid(g) * u
        return torch.einsum("bsf,fd->bsd", h, w_down)

    x = A_x
    x = x + _A_ref(_layernorm(x, axis=-1), A_dft_seq_re, A_dft_seq_im, A_dft_hid_re, A_dft_hid_im)
    x = x + _B_ref(_layernorm(x, axis=-1), B_w_gate, B_w_up, B_w_down)
    x = x + _A_ref(_layernorm(x, axis=-1), A_dft_seq_re, A_dft_seq_im, A_dft_hid_re, A_dft_hid_im)
    x = x + _B_ref(_layernorm(x, axis=-1), B_w_gate, B_w_up, B_w_down)
    return x
```

```asm
; @launch kernel=ln_first_kernel grid=(512,1,1) block=(256,1,1) lds=0
; @launch kernel=gemm_a1_kernel grid=(256,1,1) block=(512,1,1) lds=131072
; @launch kernel=gemm_a2_kernel grid=(256,1,1) block=(512,1,1) lds=131072
; @launch kernel=ln_a_in_kernel grid=(512,1,1) block=(256,1,1) lds=0
; @launch kernel=gemm_b1_kernel grid=(256,1,1) block=(512,1,1) lds=131072
; @launch kernel=gemm_b2_kernel grid=(256,1,1) block=(512,1,1) lds=131072
; @launch kernel=ln_b_kernel grid=(512,1,1) block=(256,1,1) lds=0
; @launch kernel=gemm_a1_kernel grid=(256,1,1) block=(512,1,1) lds=131072
; @launch kernel=gemm_a2_kernel grid=(256,1,1) block=(512,1,1) lds=131072
; @launch kernel=ln_a_ws_kernel grid=(512,1,1) block=(256,1,1) lds=0
; @launch kernel=gemm_b1_kernel grid=(256,1,1) block=(512,1,1) lds=131072
; @launch kernel=gemm_b2_kernel grid=(256,1,1) block=(512,1,1) lds=131072
; @launch kernel=ln_final_kernel grid=(512,1,1) block=(256,1,1) lds=0
.amdgcn_target "amdgcn-amd-amdhsa--gfx950"
.text
.globl gemm_a1_kernel
.p2align 8
.type gemm_a1_kernel,@function
gemm_a1_kernel:
    s_cmp_ge_u32 s2, 256
    s_cbranch_scc1 gemm_a1_kernel_end
    s_load_dwordx2 s[4:5], s[0:1], 24
    s_load_dwordx2 s[6:7], s[0:1], 32
    s_load_dwordx2 s[36:37], s[0:1], 88
    s_and_b32 s31, s2, 7
    s_lshr_b32 s34, s2, 3
    s_waitcnt lgkmcnt(0)
    s_lshr_b32 s29, s31, 1
    s_lshl_b32 s29, s29, 2
    s_and_b32 s30, s34, 3
    s_add_u32 s20, s29, s30
    s_and_b32 s29, s31, 1
    s_lshl_b32 s29, s29, 3
    s_lshr_b32 s30, s34, 2
    s_add_u32 s21, s29, s30
    s_cmp_lt_u32 s20, 8
    s_cselect_b64 s[32:33], s[4:5], s[6:7]
    s_and_b32 s29, s20, 7
    s_mul_i32 s29, s29, 262144
    s_add_u32 s8, s32, s29
    s_addc_u32 s9, s33, 0
    s_sub_u32 s10, 2097152, s29
    s_mov_b32 s11, 0x20000
    s_mov_b32 s38, s36
    s_mov_b32 s39, s37
    s_mul_i32 s29, s21, 262144
    s_add_u32 s12, s38, s29
    s_addc_u32 s13, s39, 0
    s_sub_u32 s14, 4194304, s29
    s_mov_b32 s15, 0x20000
    s_add_u32 s38, s36, 4194304
    s_addc_u32 s39, s37, 0
    s_mul_i32 s29, s20, 524288
    s_mul_i32 s30, s21, 256
    s_add_u32 s29, s29, s30
    s_add_u32 s16, s38, s29
    s_addc_u32 s17, s39, 0
    s_sub_u32 s18, 8388608, s29
    s_mov_b32 s19, 0x20000
    v_and_b32 v1, 63, v0
    v_lshrrev_b32 v2, 6, v0
    s_nop 0
    v_readfirstlane_b32 s24, v2
    s_nop 3
    s_cmp_lt_u32 s24, 4
    s_cbranch_scc1 gemm_a1_kernel_compute
    s_sub_u32 s24, s24, 4
    v_subrev_u32 v2, 4, v2
    v_lshrrev_b32 v3, 3, v1
    v_and_b32 v4, 7, v1
    v_mul_u32_u24 v5, 32, v2
    v_add_u32 v5, v5, v3
    v_and_b32 v6, 3, v5
    v_lshrrev_b32 v7, 1, v5
    v_and_or_b32 v6, v7, 4, v6
    v_xor_b32 v6, v6, v4
    v_lshlrev_b32 v6, 4, v6
    v_mul_u32_u24 v9, 2048, v5
    v_add_u32 v9, v9, v6
    v_mul_u32_u24 v5, 32, v2
    v_add_u32 v5, v5, v3
    v_add_u32 v5, 8, v5
    v_and_b32 v6, 3, v5
    v_lshrrev_b32 v7, 1, v5
    v_and_or_b32 v6, v7, 4, v6
    v_xor_b32 v6, v6, v4
    v_lshlrev_b32 v6, 4, v6
    v_mul_u32_u24 v10, 2048, v5
    v_add_u32 v10, v10, v6
    v_mul_u32_u24 v5, 32, v2
    v_add_u32 v5, v5, v3
    v_add_u32 v5, 16, v5
    v_and_b32 v6, 3, v5
    v_lshrrev_b32 v7, 1, v5
    v_and_or_b32 v6, v7, 4, v6
    v_xor_b32 v6, v6, v4
    v_lshlrev_b32 v6, 4, v6
    v_mul_u32_u24 v11, 2048, v5
    v_add_u32 v11, v11, v6
    v_mul_u32_u24 v5, 32, v2
    v_add_u32 v5, v5, v3
    v_add_u32 v5, 24, v5
    v_and_b32 v6, 3, v5
    v_lshrrev_b32 v7, 1, v5
    v_and_or_b32 v6, v7, 4, v6
    v_xor_b32 v6, v6, v4
    v_lshlrev_b32 v6, 4, v6
    v_mul_u32_u24 v12, 2048, v5
    v_add_u32 v12, v12, v6
    v_mul_u32_u24 v5, 32, v2
    v_add_u32 v5, v5, v3
    v_and_b32 v6, 3, v5
    v_lshrrev_b32 v7, 1, v5
    v_and_or_b32 v6, v7, 4, v6
    v_xor_b32 v6, v6, v4
    v_lshlrev_b32 v6, 4, v6
    v_mul_u32_u24 v13, 2048, v5
    v_add_u32 v13, v13, v6
    v_mul_u32_u24 v5, 32, v2
    v_add_u32 v5, v5, v3
    v_add_u32 v5, 8, v5
    v_and_b32 v6, 3, v5
    v_lshrrev_b32 v7, 1, v5
    v_and_or_b32 v6, v7, 4, v6
    v_xor_b32 v6, v6, v4
    v_lshlrev_b32 v6, 4, v6
    v_mul_u32_u24 v14, 2048, v5
    v_add_u32 v14, v14, v6
    v_mul_u32_u24 v5, 32, v2
    v_add_u32 v5, v5, v3
    v_add_u32 v5, 16, v5
    v_and_b32 v6, 3, v5
    v_lshrrev_b32 v7, 1, v5
    v_and_or_b32 v6, v7, 4, v6
    v_xor_b32 v6, v6, v4
    v_lshlrev_b32 v6, 4, v6
    v_mul_u32_u24 v15, 2048, v5
    v_add_u32 v15, v15, v6
    v_mul_u32_u24 v5, 32, v2
    v_add_u32 v5, v5, v3
    v_add_u32 v5, 24, v5
    v_and_b32 v6, 3, v5
    v_lshrrev_b32 v7, 1, v5
    v_and_or_b32 v6, v7, 4, v6
    v_xor_b32 v6, v6, v4
    v_lshlrev_b32 v6, 4, v6
    v_mul_u32_u24 v16, 2048, v5
    v_add_u32 v16, v16, v6
    s_mul_i32 s25, s24, 4096
    s_mul_i32 s26, s24, 4096
    s_add_u32 s26, s26, 16384
    s_mov_b32 s27, 0
    s_add_u32 m0, s25, 0
    s_nop 0
    buffer_load_dwordx4 v9, s[8:11], s27 offen lds
    s_add_u32 m0, s25, 1024
    s_nop 0
    buffer_load_dwordx4 v10, s[8:11], s27 offen lds
    s_add_u32 m0, s25, 2048
    s_nop 0
    buffer_load_dwordx4 v11, s[8:11], s27 offen lds
    s_add_u32 m0, s25, 3072
    s_nop 0
    buffer_load_dwordx4 v12, s[8:11], s27 offen lds
    s_add_u32 m0, s26, 0
    s_nop 0
    buffer_load_dwordx4 v13, s[12:15], s27 offen lds
    s_add_u32 m0, s26, 1024
    s_nop 0
    buffer_load_dwordx4 v14, s[12:15], s27 offen lds
    s_add_u32 m0, s26, 2048
    s_nop 0
    buffer_load_dwordx4 v15, s[12:15], s27 offen lds
    s_add_u32 m0, s26, 3072
    s_nop 0
    buffer_load_dwordx4 v16, s[12:15], s27 offen lds
    s_add_u32 s27, s27, 128
    s_add_u32 m0, s25, 32768
    s_nop 0
    buffer_load_dwordx4 v9, s[8:11], s27 offen lds
    s_add_u32 m0, s25, 33792
    s_nop 0
    buffer_load_dwordx4 v10, s[8:11], s27 offen lds
    s_add_u32 m0, s25, 34816
    s_nop 0
    buffer_load_dwordx4 v11, s[8:11], s27 offen lds
    s_add_u32 m0, s25, 35840
    s_nop 0
    buffer_load_dwordx4 v12, s[8:11], s27 offen lds
    s_add_u32 m0, s26, 32768
    s_nop 0
    buffer_load_dwordx4 v13, s[12:15], s27 offen lds
    s_add_u32 m0, s26, 33792
    s_nop 0
    buffer_load_dwordx4 v14, s[12:15], s27 offen lds
    s_add_u32 m0, s26, 34816
    s_nop 0
    buffer_load_dwordx4 v15, s[12:15], s27 offen lds
    s_add_u32 m0, s26, 35840
    s_nop 0
    buffer_load_dwordx4 v16, s[12:15], s27 offen lds
    s_add_u32 s27, s27, 128
    s_add_u32 m0, s25, 65536
    s_nop 0
    buffer_load_dwordx4 v9, s[8:11], s27 offen lds
    s_add_u32 m0, s25, 66560
    s_nop 0
    buffer_load_dwordx4 v10, s[8:11], s27 offen lds
    s_add_u32 m0, s25, 67584
    s_nop 0
    buffer_load_dwordx4 v11, s[8:11], s27 offen lds
    s_add_u32 m0, s25, 68608
    s_nop 0
    buffer_load_dwordx4 v12, s[8:11], s27 offen lds
    s_add_u32 m0, s26, 65536
    s_nop 0
    buffer_load_dwordx4 v13, s[12:15], s27 offen lds
    s_add_u32 m0, s26, 66560
    s_nop 0
    buffer_load_dwordx4 v14, s[12:15], s27 offen lds
    s_add_u32 m0, s26, 67584
    s_nop 0
    buffer_load_dwordx4 v15, s[12:15], s27 offen lds
    s_add_u32 m0, s26, 68608
    s_nop 0
    buffer_load_dwordx4 v16, s[12:15], s27 offen lds
    s_add_u32 s27, s27, 128
    s_add_u32 m0, s25, 98304
    s_nop 0
    buffer_load_dwordx4 v9, s[8:11], s27 offen lds
    s_add_u32 m0, s25, 99328
    s_nop 0
    buffer_load_dwordx4 v10, s[8:11], s27 offen lds
    s_add_u32 m0, s25, 100352
    s_nop 0
    buffer_load_dwordx4 v11, s[8:11], s27 offen lds
    s_add_u32 m0, s25, 101376
    s_nop 0
    buffer_load_dwordx4 v12, s[8:11], s27 offen lds
    s_add_u32 m0, s26, 98304
    s_nop 0
    buffer_load_dwordx4 v13, s[12:15], s27 offen lds
    s_add_u32 m0, s26, 99328
    s_nop 0
    buffer_load_dwordx4 v14, s[12:15], s27 offen lds
    s_add_u32 m0, s26, 100352
    s_nop 0
    buffer_load_dwordx4 v15, s[12:15], s27 offen lds
    s_add_u32 m0, s26, 101376
    s_nop 0
    buffer_load_dwordx4 v16, s[12:15], s27 offen lds
    s_add_u32 s27, s27, 128
    s_waitcnt vmcnt(24)
    s_barrier
    s_mov_b32 s28, 3
gemm_a1_kernel_lloop:
    s_waitcnt vmcnt(16)
    s_barrier
    s_add_u32 m0, s25, 0
    s_nop 0
    buffer_load_dwordx4 v9, s[8:11], s27 offen lds
    s_add_u32 m0, s25, 1024
    s_nop 0
    buffer_load_dwordx4 v10, s[8:11], s27 offen lds
    s_add_u32 m0, s25, 2048
    s_nop 0
    buffer_load_dwordx4 v11, s[8:11], s27 offen lds
    s_add_u32 m0, s25, 3072
    s_nop 0
    buffer_load_dwordx4 v12, s[8:11], s27 offen lds
    s_add_u32 m0, s26, 0
    s_nop 0
    buffer_load_dwordx4 v13, s[12:15], s27 offen lds
    s_add_u32 m0, s26, 1024
    s_nop 0
    buffer_load_dwordx4 v14, s[12:15], s27 offen lds
    s_add_u32 m0, s26, 2048
    s_nop 0
    buffer_load_dwordx4 v15, s[12:15], s27 offen lds
    s_add_u32 m0, s26, 3072
    s_nop 0
    buffer_load_dwordx4 v16, s[12:15], s27 offen lds
    s_add_u32 s27, s27, 128
    s_waitcnt vmcnt(16)
    s_barrier
    s_add_u32 m0, s25, 32768
    s_nop 0
    buffer_load_dwordx4 v9, s[8:11], s27 offen lds
    s_add_u32 m0, s25, 33792
    s_nop 0
    buffer_load_dwordx4 v10, s[8:11], s27 offen lds
    s_add_u32 m0, s25, 34816
    s_nop 0
    buffer_load_dwordx4 v11, s[8:11], s27 offen lds
    s_add_u32 m0, s25, 35840
    s_nop 0
    buffer_load_dwordx4 v12, s[8:11], s27 offen lds
    s_add_u32 m0, s26, 32768
    s_nop 0
    buffer_load_dwordx4 v13, s[12:15], s27 offen lds
    s_add_u32 m0, s26, 33792
    s_nop 0
    buffer_load_dwordx4 v14, s[12:15], s27 offen lds
    s_add_u32 m0, s26, 34816
    s_nop 0
    buffer_load_dwordx4 v15, s[12:15], s27 offen lds
    s_add_u32 m0, s26, 35840
    s_nop 0
    buffer_load_dwordx4 v16, s[12:15], s27 offen lds
    s_add_u32 s27, s27, 128
    s_waitcnt vmcnt(16)
    s_barrier
    s_add_u32 m0, s25, 65536
    s_nop 0
    buffer_load_dwordx4 v9, s[8:11], s27 offen lds
    s_add_u32 m0, s25, 66560
    s_nop 0
    buffer_load_dwordx4 v10, s[8:11], s27 offen lds
    s_add_u32 m0, s25, 67584
    s_nop 0
    buffer_load_dwordx4 v11, s[8:11], s27 offen lds
    s_add_u32 m0, s25, 68608
    s_nop 0
    buffer_load_dwordx4 v12, s[8:11], s27 offen lds
    s_add_u32 m0, s26, 65536
    s_nop 0
    buffer_load_dwordx4 v13, s[12:15], s27 offen lds
    s_add_u32 m0, s26, 66560
    s_nop 0
    buffer_load_dwordx4 v14, s[12:15], s27 offen lds
    s_add_u32 m0, s26, 67584
    s_nop 0
    buffer_load_dwordx4 v15, s[12:15], s27 offen lds
    s_add_u32 m0, s26, 68608
    s_nop 0
    buffer_load_dwordx4 v16, s[12:15], s27 offen lds
    s_add_u32 s27, s27, 128
    s_waitcnt vmcnt(16)
    s_barrier
    s_add_u32 m0, s25, 98304
    s_nop 0
    buffer_load_dwordx4 v9, s[8:11], s27 offen lds
    s_add_u32 m0, s25, 99328
    s_nop 0
    buffer_load_dwordx4 v10, s[8:11], s27 offen lds
    s_add_u32 m0, s25, 100352
    s_nop 0
    buffer_load_dwordx4 v11, s[8:11], s27 offen lds
    s_add_u32 m0, s25, 101376
    s_nop 0
    buffer_load_dwordx4 v12, s[8:11], s27 offen lds
    s_add_u32 m0, s26, 98304
    s_nop 0
    buffer_load_dwordx4 v13, s[12:15], s27 offen lds
    s_add_u32 m0, s26, 99328
    s_nop 0
    buffer_load_dwordx4 v14, s[12:15], s27 offen lds
    s_add_u32 m0, s26, 100352
    s_nop 0
    buffer_load_dwordx4 v15, s[12:15], s27 offen lds
    s_add_u32 m0, s26, 101376
    s_nop 0
    buffer_load_dwordx4 v16, s[12:15], s27 offen lds
    s_add_u32 s27, s27, 128
    s_sub_u32 s28, s28, 1
    s_cmp_lg_u32 s28, 0
    s_cbranch_scc1 gemm_a1_kernel_lloop
    s_waitcnt vmcnt(16)
    s_barrier
    s_waitcnt vmcnt(8)
    s_barrier
    s_waitcnt vmcnt(0)
    s_barrier
    s_endpgm
gemm_a1_kernel_compute:
    v_and_b32 v3, 15, v1
    v_lshrrev_b32 v4, 4, v1
    v_and_b32 v5, 1, v2
    v_lshrrev_b32 v6, 1, v2
    v_and_b32 v7, 3, v3
    v_lshrrev_b32 v8, 1, v3
    v_and_or_b32 v7, v8, 4, v7
    v_xor_b32 v7, v7, v4
    v_lshlrev_b32 v7, 4, v7
    v_mul_u32_u24 v8, 64, v5
    v_add_u32 v8, v8, v3
    v_lshlrev_b32 v8, 7, v8
    v_add_u32 v17, v8, v7
    v_xor_b32 v18, 64, v17
    v_add_u32 v19, 0x10000, v17
    v_add_u32 v20, 0x10000, v18
    v_lshrrev_b32 v25, 2, v3
    v_lshlrev_b32 v25, 3, v25
    v_and_or_b32 v25, v3, 3, v25
    v_and_b32 v7, 3, v25
    v_lshrrev_b32 v8, 1, v25
    v_and_or_b32 v7, v8, 4, v7
    v_xor_b32 v7, v7, v4
    v_lshlrev_b32 v7, 4, v7
    v_mul_u32_u24 v8, 64, v6
    v_add_u32 v8, v8, v25
    v_lshlrev_b32 v8, 7, v8
    v_add_u32 v21, v8, v7
    v_add_u32 v21, 16384, v21
    v_xor_b32 v22, 64, v21
    v_add_u32 v23, 0x10000, v21
    v_add_u32 v24, 0x10000, v22
    v_mul_u32_u24 v7, 64, v5
    v_add_u32 v7, v7, v3
    v_mul_u32_u24 v7, 4096, v7
    v_mul_u32_u24 v8, 128, v6
    v_add_u32 v7, v7, v8
    v_lshlrev_b32 v28, 4, v1
    v_lshl_add_u32 v28, v5, 14, v28
    v_lshl_add_u32 v26, v4, 4, v7
    v_lshl_add_u32 v27, v4, 3, v7
    v_accvgpr_write_b32 a0, 0
    v_accvgpr_write_b32 a1, 0
    v_accvgpr_write_b32 a2, 0
    v_accvgpr_write_b32 a3, 0
    v_accvgpr_write_b32 a4, 0
    v_accvgpr_write_b32 a5, 0
    v_accvgpr_write_b32 a6, 0
    v_accvgpr_write_b32 a7, 0
    v_accvgpr_write_b32 a8, 0
    v_accvgpr_write_b32 a9, 0
    v_accvgpr_write_b32 a10, 0
    v_accvgpr_write_b32 a11, 0
    v_accvgpr_write_b32 a12, 0
    v_accvgpr_write_b32 a13, 0
    v_accvgpr_write_b32 a14, 0
    v_accvgpr_write_b32 a15, 0
    v_accvgpr_write_b32 a16, 0
    v_accvgpr_write_b32 a17, 0
    v_accvgpr_write_b32 a18, 0
    v_accvgpr_write_b32 a19, 0
    v_accvgpr_write_b32 a20, 0
    v_accvgpr_write_b32 a21, 0
    v_accvgpr_write_b32 a22, 0
    v_accvgpr_write_b32 a23, 0
    v_accvgpr_write_b32 a24, 0
    v_accvgpr_write_b32 a25, 0
    v_accvgpr_write_b32 a26, 0
    v_accvgpr_write_b32 a27, 0
    v_accvgpr_write_b32 a28, 0
    v_accvgpr_write_b32 a29, 0
    v_accvgpr_write_b32 a30, 0
    v_accvgpr_write_b32 a31, 0
    v_accvgpr_write_b32 a32, 0
    v_accvgpr_write_b32 a33, 0
    v_accvgpr_write_b32 a34, 0
    v_accvgpr_write_b32 a35, 0
    v_accvgpr_write_b32 a36, 0
    v_accvgpr_write_b32 a37, 0
    v_accvgpr_write_b32 a38, 0
    v_accvgpr_write_b32 a39, 0
    v_accvgpr_write_b32 a40, 0
    v_accvgpr_write_b32 a41, 0
    v_accvgpr_write_b32 a42, 0
    v_accvgpr_write_b32 a43, 0
    v_accvgpr_write_b32 a44, 0
    v_accvgpr_write_b32 a45, 0
    v_accvgpr_write_b32 a46, 0
    v_accvgpr_write_b32 a47, 0
    v_accvgpr_write_b32 a48, 0
    v_accvgpr_write_b32 a49, 0
    v_accvgpr_write_b32 a50, 0
    v_accvgpr_write_b32 a51, 0
    v_accvgpr_write_b32 a52, 0
    v_accvgpr_write_b32 a53, 0
    v_accvgpr_write_b32 a54, 0
    v_accvgpr_write_b32 a55, 0
    v_accvgpr_write_b32 a56, 0
    v_accvgpr_write_b32 a57, 0
    v_accvgpr_write_b32 a58, 0
    v_accvgpr_write_b32 a59, 0
    v_accvgpr_write_b32 a60, 0
    v_accvgpr_write_b32 a61, 0
    v_accvgpr_write_b32 a62, 0
    v_accvgpr_write_b32 a63, 0
    s_barrier
    ds_read_b128 v[64:67], v21 offset:0
    ds_read_b128 v[32:35], v17 offset:0
    ds_read_b128 v[68:71], v21 offset:512
    ds_read_b128 v[36:39], v17 offset:2048
    ds_read_b128 v[72:75], v21 offset:4096
    ds_read_b128 v[40:43], v17 offset:4096
    ds_read_b128 v[76:79], v21 offset:4608
    ds_read_b128 v[44:47], v17 offset:6144
    s_mov_b32 s28, 3
gemm_a1_kernel_loop:
    s_waitcnt lgkmcnt(0)
    v_mfma_f32_16x16x32_bf16 a[0:3], v[64:67], v[32:35], a[0:3]
    ds_read_b128 v[80:83], v22 offset:0
    v_mfma_f32_16x16x32_bf16 a[4:7], v[64:67], v[36:39], a[4:7]
    ds_read_b128 v[48:51], v18 offset:0
    v_mfma_f32_16x16x32_bf16 a[8:11], v[64:67], v[40:43], a[8:11]
    ds_read_b128 v[84:87], v22 offset:512
    v_mfma_f32_16x16x32_bf16 a[12:15], v[64:67], v[44:47], a[12:15]
    ds_read_b128 v[52:55], v18 offset:2048
    v_mfma_f32_16x16x32_bf16 a[16:19], v[68:71], v[32:35], a[16:19]
    ds_read_b128 v[88:91], v22 offset:4096
    v_mfma_f32_16x16x32_bf16 a[20:23], v[68:71], v[36:39], a[20:23]
    ds_read_b128 v[56:59], v18 offset:4096
    v_mfma_f32_16x16x32_bf16 a[24:27], v[68:71], v[40:43], a[24:27]
    ds_read_b128 v[92:95], v22 offset:4608
    v_mfma_f32_16x16x32_bf16 a[28:31], v[68:71], v[44:47], a[28:31]
    ds_read_b128 v[60:63], v18 offset:6144
    v_mfma_f32_16x16x32_bf16 a[32:35], v[72:75], v[32:35], a[32:35]
    v_mfma_f32_16x16x32_bf16 a[36:39], v[72:75], v[36:39], a[36:39]
    v_mfma_f32_16x16x32_bf16 a[40:43], v[72:75], v[40:43], a[40:43]
    v_mfma_f32_16x16x32_bf16 a[44:47], v[72:75], v[44:47], a[44:47]
    v_mfma_f32_16x16x32_bf16 a[48:51], v[76:79], v[32:35], a[48:51]
    v_mfma_f32_16x16x32_bf16 a[52:55], v[76:79], v[36:39], a[52:55]
    v_mfma_f32_16x16x32_bf16 a[56:59], v[76:79], v[40:43], a[56:59]
    v_mfma_f32_16x16x32_bf16 a[60:63], v[76:79], v[44:47], a[60:63]
    s_waitcnt lgkmcnt(0)
    s_barrier
    v_mfma_f32_16x16x32_bf16 a[0:3], v[80:83], v[48:51], a[0:3]
    ds_read_b128 v[64:67], v21 offset:32768
    v_mfma_f32_16x16x32_bf16 a[4:7], v[80:83], v[52:55], a[4:7]
    ds_read_b128 v[32:35], v17 offset:32768
    v_mfma_f32_16x16x32_bf16 a[8:11], v[80:83], v[56:59], a[8:11]
    ds_read_b128 v[68:71], v21 offset:33280
    v_mfma_f32_16x16x32_bf16 a[12:15], v[80:83], v[60:63], a[12:15]
    ds_read_b128 v[36:39], v17 offset:34816
    v_mfma_f32_16x16x32_bf16 a[16:19], v[84:87], v[48:51], a[16:19]
    ds_read_b128 v[72:75], v21 offset:36864
    v_mfma_f32_16x16x32_bf16 a[20:23], v[84:87], v[52:55], a[20:23]
    ds_read_b128 v[40:43], v17 offset:36864
    v_mfma_f32_16x16x32_bf16 a[24:27], v[84:87], v[56:59], a[24:27]
    ds_read_b128 v[76:79], v21 offset:37376
    v_mfma_f32_16x16x32_bf16 a[28:31], v[84:87], v[60:63], a[28:31]
    ds_read_b128 v[44:47], v17 offset:38912
    v_mfma_f32_16x16x32_bf16 a[32:35], v[88:91], v[48:51], a[32:35]
    v_mfma_f32_16x16x32_bf16 a[36:39], v[88:91], v[52:55], a[36:39]
    v_mfma_f32_16x16x32_bf16 a[40:43], v[88:91], v[56:59], a[40:43]
    v_mfma_f32_16x16x32_bf16 a[44:47], v[88:91], v[60:63], a[44:47]
    v_mfma_f32_16x16x32_bf16 a[48:51], v[92:95], v[48:51], a[48:51]
    v_mfma_f32_16x16x32_bf16 a[52:55], v[92:95], v[52:55], a[52:55]
    v_mfma_f32_16x16x32_bf16 a[56:59], v[92:95], v[56:59], a[56:59]
    v_mfma_f32_16x16x32_bf16 a[60:63], v[92:95], v[60:63], a[60:63]
    s_waitcnt lgkmcnt(0)
    v_mfma_f32_16x16x32_bf16 a[0:3], v[64:67], v[32:35], a[0:3]
    ds_read_b128 v[80:83], v22 offset:32768
    v_mfma_f32_16x16x32_bf16 a[4:7], v[64:67], v[36:39], a[4:7]
    ds_read_b128 v[48:51], v18 offset:32768
    v_mfma_f32_16x16x32_bf16 a[8:11], v[64:67], v[40:43], a[8:11]
    ds_read_b128 v[84:87], v22 offset:33280
    v_mfma_f32_16x16x32_bf16 a[12:15], v[64:67], v[44:47], a[12:15]
    ds_read_b128 v[52:55], v18 offset:34816
    v_mfma_f32_16x16x32_bf16 a[16:19], v[68:71], v[32:35], a[16:19]
    ds_read_b128 v[88:91], v22 offset:36864
    v_mfma_f32_16x16x32_bf16 a[20:23], v[68:71], v[36:39], a[20:23]
    ds_read_b128 v[56:59], v18 offset:36864
    v_mfma_f32_16x16x32_bf16 a[24:27], v[68:71], v[40:43], a[24:27]
    ds_read_b128 v[92:95], v22 offset:37376
    v_mfma_f32_16x16x32_bf16 a[28:31], v[68:71], v[44:47], a[28:31]
    ds_read_b128 v[60:63], v18 offset:38912
    v_mfma_f32_16x16x32_bf16 a[32:35], v[72:75], v[32:35], a[32:35]
    v_mfma_f32_16x16x32_bf16 a[36:39], v[72:75], v[36:39], a[36:39]
    v_mfma_f32_16x16x32_bf16 a[40:43], v[72:75], v[40:43], a[40:43]
    v_mfma_f32_16x16x32_bf16 a[44:47], v[72:75], v[44:47], a[44:47]
    v_mfma_f32_16x16x32_bf16 a[48:51], v[76:79], v[32:35], a[48:51]
    v_mfma_f32_16x16x32_bf16 a[52:55], v[76:79], v[36:39], a[52:55]
    v_mfma_f32_16x16x32_bf16 a[56:59], v[76:79], v[40:43], a[56:59]
    v_mfma_f32_16x16x32_bf16 a[60:63], v[76:79], v[44:47], a[60:63]
    s_waitcnt lgkmcnt(0)
    s_barrier
    v_mfma_f32_16x16x32_bf16 a[0:3], v[80:83], v[48:51], a[0:3]
    ds_read_b128 v[64:67], v23 offset:0
    v_mfma_f32_16x16x32_bf16 a[4:7], v[80:83], v[52:55], a[4:7]
    ds_read_b128 v[32:35], v19 offset:0
    v_mfma_f32_16x16x32_bf16 a[8:11], v[80:83], v[56:59], a[8:11]
    ds_read_b128 v[68:71], v23 offset:512
    v_mfma_f32_16x16x32_bf16 a[12:15], v[80:83], v[60:63], a[12:15]
    ds_read_b128 v[36:39], v19 offset:2048
    v_mfma_f32_16x16x32_bf16 a[16:19], v[84:87], v[48:51], a[16:19]
    ds_read_b128 v[72:75], v23 offset:4096
    v_mfma_f32_16x16x32_bf16 a[20:23], v[84:87], v[52:55], a[20:23]
    ds_read_b128 v[40:43], v19 offset:4096
    v_mfma_f32_16x16x32_bf16 a[24:27], v[84:87], v[56:59], a[24:27]
    ds_read_b128 v[76:79], v23 offset:4608
    v_mfma_f32_16x16x32_bf16 a[28:31], v[84:87], v[60:63], a[28:31]
    ds_read_b128 v[44:47], v19 offset:6144
    v_mfma_f32_16x16x32_bf16 a[32:35], v[88:91], v[48:51], a[32:35]
    v_mfma_f32_16x16x32_bf16 a[36:39], v[88:91], v[52:55], a[36:39]
    v_mfma_f32_16x16x32_bf16 a[40:43], v[88:91], v[56:59], a[40:43]
    v_mfma_f32_16x16x32_bf16 a[44:47], v[88:91], v[60:63], a[44:47]
    v_mfma_f32_16x16x32_bf16 a[48:51], v[92:95], v[48:51], a[48:51]
    v_mfma_f32_16x16x32_bf16 a[52:55], v[92:95], v[52:55], a[52:55]
    v_mfma_f32_16x16x32_bf16 a[56:59], v[92:95], v[56:59], a[56:59]
    v_mfma_f32_16x16x32_bf16 a[60:63], v[92:95], v[60:63], a[60:63]
    s_waitcnt lgkmcnt(0)
    v_mfma_f32_16x16x32_bf16 a[0:3], v[64:67], v[32:35], a[0:3]
    ds_read_b128 v[80:83], v24 offset:0
    v_mfma_f32_16x16x32_bf16 a[4:7], v[64:67], v[36:39], a[4:7]
    ds_read_b128 v[48:51], v20 offset:0
    v_mfma_f32_16x16x32_bf16 a[8:11], v[64:67], v[40:43], a[8:11]
    ds_read_b128 v[84:87], v24 offset:512
    v_mfma_f32_16x16x32_bf16 a[12:15], v[64:67], v[44:47], a[12:15]
    ds_read_b128 v[52:55], v20 offset:2048
    v_mfma_f32_16x16x32_bf16 a[16:19], v[68:71], v[32:35], a[16:19]
    ds_read_b128 v[88:91], v24 offset:4096
    v_mfma_f32_16x16x32_bf16 a[20:23], v[68:71], v[36:39], a[20:23]
    ds_read_b128 v[56:59], v20 offset:4096
    v_mfma_f32_16x16x32_bf16 a[24:27], v[68:71], v[40:43], a[24:27]
    ds_read_b128 v[92:95], v24 offset:4608
    v_mfma_f32_16x16x32_bf16 a[28:31], v[68:71], v[44:47], a[28:31]
    ds_read_b128 v[60:63], v20 offset:6144
    v_mfma_f32_16x16x32_bf16 a[32:35], v[72:75], v[32:35], a[32:35]
    v_mfma_f32_16x16x32_bf16 a[36:39], v[72:75], v[36:39], a[36:39]
    v_mfma_f32_16x16x32_bf16 a[40:43], v[72:75], v[40:43], a[40:43]
    v_mfma_f32_16x16x32_bf16 a[44:47], v[72:75], v[44:47], a[44:47]
    v_mfma_f32_16x16x32_bf16 a[48:51], v[76:79], v[32:35], a[48:51]
    v_mfma_f32_16x16x32_bf16 a[52:55], v[76:79], v[36:39], a[52:55]
    v_mfma_f32_16x16x32_bf16 a[56:59], v[76:79], v[40:43], a[56:59]
    v_mfma_f32_16x16x32_bf16 a[60:63], v[76:79], v[44:47], a[60:63]
    s_waitcnt lgkmcnt(0)
    s_barrier
    v_mfma_f32_16x16x32_bf16 a[0:3], v[80:83], v[48:51], a[0:3]
    ds_read_b128 v[64:67], v23 offset:32768
    v_mfma_f32_16x16x32_bf16 a[4:7], v[80:83], v[52:55], a[4:7]
    ds_read_b128 v[32:35], v19 offset:32768
    v_mfma_f32_16x16x32_bf16 a[8:11], v[80:83], v[56:59], a[8:11]
    ds_read_b128 v[68:71], v23 offset:33280
    v_mfma_f32_16x16x32_bf16 a[12:15], v[80:83], v[60:63], a[12:15]
    ds_read_b128 v[36:39], v19 offset:34816
    v_mfma_f32_16x16x32_bf16 a[16:19], v[84:87], v[48:51], a[16:19]
    ds_read_b128 v[72:75], v23 offset:36864
    v_mfma_f32_16x16x32_bf16 a[20:23], v[84:87], v[52:55], a[20:23]
    ds_read_b128 v[40:43], v19 offset:36864
    v_mfma_f32_16x16x32_bf16 a[24:27], v[84:87], v[56:59], a[24:27]
    ds_read_b128 v[76:79], v23 offset:37376
    v_mfma_f32_16x16x32_bf16 a[28:31], v[84:87], v[60:63], a[28:31]
    ds_read_b128 v[44:47], v19 offset:38912
    v_mfma_f32_16x16x32_bf16 a[32:35], v[88:91], v[48:51], a[32:35]
    v_mfma_f32_16x16x32_bf16 a[36:39], v[88:91], v[52:55], a[36:39]
    v_mfma_f32_16x16x32_bf16 a[40:43], v[88:91], v[56:59], a[40:43]
    v_mfma_f32_16x16x32_bf16 a[44:47], v[88:91], v[60:63], a[44:47]
    v_mfma_f32_16x16x32_bf16 a[48:51], v[92:95], v[48:51], a[48:51]
    v_mfma_f32_16x16x32_bf16 a[52:55], v[92:95], v[52:55], a[52:55]
    v_mfma_f32_16x16x32_bf16 a[56:59], v[92:95], v[56:59], a[56:59]
    v_mfma_f32_16x16x32_bf16 a[60:63], v[92:95], v[60:63], a[60:63]
    s_waitcnt lgkmcnt(0)
    v_mfma_f32_16x16x32_bf16 a[0:3], v[64:67], v[32:35], a[0:3]
    ds_read_b128 v[80:83], v24 offset:32768
    v_mfma_f32_16x16x32_bf16 a[4:7], v[64:67], v[36:39], a[4:7]
    ds_read_b128 v[48:51], v20 offset:32768
    v_mfma_f32_16x16x32_bf16 a[8:11], v[64:67], v[40:43], a[8:11]
    ds_read_b128 v[84:87], v24 offset:33280
    v_mfma_f32_16x16x32_bf16 a[12:15], v[64:67], v[44:47], a[12:15]
    ds_read_b128 v[52:55], v20 offset:34816
    v_mfma_f32_16x16x32_bf16 a[16:19], v[68:71], v[32:35], a[16:19]
    ds_read_b128 v[88:91], v24 offset:36864
    v_mfma_f32_16x16x32_bf16 a[20:23], v[68:71], v[36:39], a[20:23]
    ds_read_b128 v[56:59], v20 offset:36864
    v_mfma_f32_16x16x32_bf16 a[24:27], v[68:71], v[40:43], a[24:27]
    ds_read_b128 v[92:95], v24 offset:37376
    v_mfma_f32_16x16x32_bf16 a[28:31], v[68:71], v[44:47], a[28:31]
    ds_read_b128 v[60:63], v20 offset:38912
    v_mfma_f32_16x16x32_bf16 a[32:35], v[72:75], v[32:35], a[32:35]
    v_mfma_f32_16x16x32_bf16 a[36:39], v[72:75], v[36:39], a[36:39]
    v_mfma_f32_16x16x32_bf16 a[40:43], v[72:75], v[40:43], a[40:43]
    v_mfma_f32_16x16x32_bf16 a[44:47], v[72:75], v[44:47], a[44:47]
    v_mfma_f32_16x16x32_bf16 a[48:51], v[76:79], v[32:35], a[48:51]
    v_mfma_f32_16x16x32_bf16 a[52:55], v[76:79], v[36:39], a[52:55]
    v_mfma_f32_16x16x32_bf16 a[56:59], v[76:79], v[40:43], a[56:59]
    v_mfma_f32_16x16x32_bf16 a[60:63], v[76:79], v[44:47], a[60:63]
    s_waitcnt lgkmcnt(0)
    s_barrier
    v_mfma_f32_16x16x32_bf16 a[0:3], v[80:83], v[48:51], a[0:3]
    ds_read_b128 v[64:67], v21 offset:0
    v_mfma_f32_16x16x32_bf16 a[4:7], v[80:83], v[52:55], a[4:7]
    ds_read_b128 v[32:35], v17 offset:0
    v_mfma_f32_16x16x32_bf16 a[8:11], v[80:83], v[56:59], a[8:11]
    ds_read_b128 v[68:71], v21 offset:512
    v_mfma_f32_16x16x32_bf16 a[12:15], v[80:83], v[60:63], a[12:15]
    ds_read_b128 v[36:39], v17 offset:2048
    v_mfma_f32_16x16x32_bf16 a[16:19], v[84:87], v[48:51], a[16:19]
    ds_read_b128 v[72:75], v21 offset:4096
    v_mfma_f32_16x16x32_bf16 a[20:23], v[84:87], v[52:55], a[20:23]
    ds_read_b128 v[40:43], v17 offset:4096
    v_mfma_f32_16x16x32_bf16 a[24:27], v[84:87], v[56:59], a[24:27]
    ds_read_b128 v[76:79], v21 offset:4608
    v_mfma_f32_16x16x32_bf16 a[28:31], v[84:87], v[60:63], a[28:31]
    ds_read_b128 v[44:47], v17 offset:6144
    v_mfma_f32_16x16x32_bf16 a[32:35], v[88:91], v[48:51], a[32:35]
    v_mfma_f32_16x16x32_bf16 a[36:39], v[88:91], v[52:55], a[36:39]
    v_mfma_f32_16x16x32_bf16 a[40:43], v[88:91], v[56:59], a[40:43]
    v_mfma_f32_16x16x32_bf16 a[44:47], v[88:91], v[60:63], a[44:47]
    v_mfma_f32_16x16x32_bf16 a[48:51], v[92:95], v[48:51], a[48:51]
    v_mfma_f32_16x16x32_bf16 a[52:55], v[92:95], v[52:55], a[52:55]
    v_mfma_f32_16x16x32_bf16 a[56:59], v[92:95], v[56:59], a[56:59]
    v_mfma_f32_16x16x32_bf16 a[60:63], v[92:95], v[60:63], a[60:63]
    s_sub_u32 s28, s28, 1
    s_cmp_lg_u32 s28, 0
    s_cbranch_scc1 gemm_a1_kernel_loop
    s_waitcnt lgkmcnt(0)
    v_mfma_f32_16x16x32_bf16 a[0:3], v[64:67], v[32:35], a[0:3]
    ds_read_b128 v[80:83], v22 offset:0
    v_mfma_f32_16x16x32_bf16 a[4:7], v[64:67], v[36:39], a[4:7]
    ds_read_b128 v[48:51], v18 offset:0
    v_mfma_f32_16x16x32_bf16 a[8:11], v[64:67], v[40:43], a[8:11]
    ds_read_b128 v[84:87], v22 offset:512
    v_mfma_f32_16x16x32_bf16 a[12:15], v[64:67], v[44:47], a[12:15]
    ds_read_b128 v[52:55], v18 offset:2048
    v_mfma_f32_16x16x32_bf16 a[16:19], v[68:71], v[32:35], a[16:19]
    ds_read_b128 v[88:91], v22 offset:4096
    v_mfma_f32_16x16x32_bf16 a[20:23], v[68:71], v[36:39], a[20:23]
    ds_read_b128 v[56:59], v18 offset:4096
    v_mfma_f32_16x16x32_bf16 a[24:27], v[68:71], v[40:43], a[24:27]
    ds_read_b128 v[92:95], v22 offset:4608
    v_mfma_f32_16x16x32_bf16 a[28:31], v[68:71], v[44:47], a[28:31]
    ds_read_b128 v[60:63], v18 offset:6144
    v_mfma_f32_16x16x32_bf16 a[32:35], v[72:75], v[32:35], a[32:35]
    v_mfma_f32_16x16x32_bf16 a[36:39], v[72:75], v[36:39], a[36:39]
    v_mfma_f32_16x16x32_bf16 a[40:43], v[72:75], v[40:43], a[40:43]
    v_mfma_f32_16x16x32_bf16 a[44:47], v[72:75], v[44:47], a[44:47]
    v_mfma_f32_16x16x32_bf16 a[48:51], v[76:79], v[32:35], a[48:51]
    v_mfma_f32_16x16x32_bf16 a[52:55], v[76:79], v[36:39], a[52:55]
    v_mfma_f32_16x16x32_bf16 a[56:59], v[76:79], v[40:43], a[56:59]
    v_mfma_f32_16x16x32_bf16 a[60:63], v[76:79], v[44:47], a[60:63]
    s_waitcnt lgkmcnt(0)
    s_barrier
    v_mfma_f32_16x16x32_bf16 a[0:3], v[80:83], v[48:51], a[0:3]
    ds_read_b128 v[64:67], v21 offset:32768
    v_mfma_f32_16x16x32_bf16 a[4:7], v[80:83], v[52:55], a[4:7]
    ds_read_b128 v[32:35], v17 offset:32768
    v_mfma_f32_16x16x32_bf16 a[8:11], v[80:83], v[56:59], a[8:11]
    ds_read_b128 v[68:71], v21 offset:33280
    v_mfma_f32_16x16x32_bf16 a[12:15], v[80:83], v[60:63], a[12:15]
    ds_read_b128 v[36:39], v17 offset:34816
    v_mfma_f32_16x16x32_bf16 a[16:19], v[84:87], v[48:51], a[16:19]
    ds_read_b128 v[72:75], v21 offset:36864
    v_mfma_f32_16x16x32_bf16 a[20:23], v[84:87], v[52:55], a[20:23]
    ds_read_b128 v[40:43], v17 offset:36864
    v_mfma_f32_16x16x32_bf16 a[24:27], v[84:87], v[56:59], a[24:27]
    ds_read_b128 v[76:79], v21 offset:37376
    v_mfma_f32_16x16x32_bf16 a[28:31], v[84:87], v[60:63], a[28:31]
    ds_read_b128 v[44:47], v17 offset:38912
    v_mfma_f32_16x16x32_bf16 a[32:35], v[88:91], v[48:51], a[32:35]
    v_mfma_f32_16x16x32_bf16 a[36:39], v[88:91], v[52:55], a[36:39]
    v_mfma_f32_16x16x32_bf16 a[40:43], v[88:91], v[56:59], a[40:43]
    v_mfma_f32_16x16x32_bf16 a[44:47], v[88:91], v[60:63], a[44:47]
    v_mfma_f32_16x16x32_bf16 a[48:51], v[92:95], v[48:51], a[48:51]
    v_mfma_f32_16x16x32_bf16 a[52:55], v[92:95], v[52:55], a[52:55]
    v_mfma_f32_16x16x32_bf16 a[56:59], v[92:95], v[56:59], a[56:59]
    v_mfma_f32_16x16x32_bf16 a[60:63], v[92:95], v[60:63], a[60:63]
    s_waitcnt lgkmcnt(0)
    v_mfma_f32_16x16x32_bf16 a[0:3], v[64:67], v[32:35], a[0:3]
    ds_read_b128 v[80:83], v22 offset:32768
    v_mfma_f32_16x16x32_bf16 a[4:7], v[64:67], v[36:39], a[4:7]
    ds_read_b128 v[48:51], v18 offset:32768
    v_mfma_f32_16x16x32_bf16 a[8:11], v[64:67], v[40:43], a[8:11]
    ds_read_b128 v[84:87], v22 offset:33280
    v_mfma_f32_16x16x32_bf16 a[12:15], v[64:67], v[44:47], a[12:15]
    ds_read_b128 v[52:55], v18 offset:34816
    v_mfma_f32_16x16x32_bf16 a[16:19], v[68:71], v[32:35], a[16:19]
    ds_read_b128 v[88:91], v22 offset:36864
    v_mfma_f32_16x16x32_bf16 a[20:23], v[68:71], v[36:39], a[20:23]
    ds_read_b128 v[56:59], v18 offset:36864
    v_mfma_f32_16x16x32_bf16 a[24:27], v[68:71], v[40:43], a[24:27]
    ds_read_b128 v[92:95], v22 offset:37376
    v_mfma_f32_16x16x32_bf16 a[28:31], v[68:71], v[44:47], a[28:31]
    ds_read_b128 v[60:63], v18 offset:38912
    v_mfma_f32_16x16x32_bf16 a[32:35], v[72:75], v[32:35], a[32:35]
    v_mfma_f32_16x16x32_bf16 a[36:39], v[72:75], v[36:39], a[36:39]
    v_mfma_f32_16x16x32_bf16 a[40:43], v[72:75], v[40:43], a[40:43]
    v_mfma_f32_16x16x32_bf16 a[44:47], v[72:75], v[44:47], a[44:47]
    v_mfma_f32_16x16x32_bf16 a[48:51], v[76:79], v[32:35], a[48:51]
    v_mfma_f32_16x16x32_bf16 a[52:55], v[76:79], v[36:39], a[52:55]
    v_mfma_f32_16x16x32_bf16 a[56:59], v[76:79], v[40:43], a[56:59]
    v_mfma_f32_16x16x32_bf16 a[60:63], v[76:79], v[44:47], a[60:63]
    s_waitcnt lgkmcnt(0)
    s_barrier
    v_mfma_f32_16x16x32_bf16 a[0:3], v[80:83], v[48:51], a[0:3]
    ds_read_b128 v[64:67], v23 offset:0
    v_mfma_f32_16x16x32_bf16 a[4:7], v[80:83], v[52:55], a[4:7]
    ds_read_b128 v[32:35], v19 offset:0
    v_mfma_f32_16x16x32_bf16 a[8:11], v[80:83], v[56:59], a[8:11]
    ds_read_b128 v[68:71], v23 offset:512
    v_mfma_f32_16x16x32_bf16 a[12:15], v[80:83], v[60:63], a[12:15]
    ds_read_b128 v[36:39], v19 offset:2048
    v_mfma_f32_16x16x32_bf16 a[16:19], v[84:87], v[48:51], a[16:19]
    ds_read_b128 v[72:75], v23 offset:4096
    v_mfma_f32_16x16x32_bf16 a[20:23], v[84:87], v[52:55], a[20:23]
    ds_read_b128 v[40:43], v19 offset:4096
    v_mfma_f32_16x16x32_bf16 a[24:27], v[84:87], v[56:59], a[24:27]
    ds_read_b128 v[76:79], v23 offset:4608
    v_mfma_f32_16x16x32_bf16 a[28:31], v[84:87], v[60:63], a[28:31]
    ds_read_b128 v[44:47], v19 offset:6144
    v_mfma_f32_16x16x32_bf16 a[32:35], v[88:91], v[48:51], a[32:35]
    v_mfma_f32_16x16x32_bf16 a[36:39], v[88:91], v[52:55], a[36:39]
    v_mfma_f32_16x16x32_bf16 a[40:43], v[88:91], v[56:59], a[40:43]
    v_mfma_f32_16x16x32_bf16 a[44:47], v[88:91], v[60:63], a[44:47]
    v_mfma_f32_16x16x32_bf16 a[48:51], v[92:95], v[48:51], a[48:51]
    v_mfma_f32_16x16x32_bf16 a[52:55], v[92:95], v[52:55], a[52:55]
    v_mfma_f32_16x16x32_bf16 a[56:59], v[92:95], v[56:59], a[56:59]
    v_mfma_f32_16x16x32_bf16 a[60:63], v[92:95], v[60:63], a[60:63]
    s_waitcnt lgkmcnt(0)
    v_mfma_f32_16x16x32_bf16 a[0:3], v[64:67], v[32:35], a[0:3]
    ds_read_b128 v[80:83], v24 offset:0
    v_mfma_f32_16x16x32_bf16 a[4:7], v[64:67], v[36:39], a[4:7]
    ds_read_b128 v[48:51], v20 offset:0
    v_mfma_f32_16x16x32_bf16 a[8:11], v[64:67], v[40:43], a[8:11]
    ds_read_b128 v[84:87], v24 offset:512
    v_mfma_f32_16x16x32_bf16 a[12:15], v[64:67], v[44:47], a[12:15]
    ds_read_b128 v[52:55], v20 offset:2048
    v_mfma_f32_16x16x32_bf16 a[16:19], v[68:71], v[32:35], a[16:19]
    ds_read_b128 v[88:91], v24 offset:4096
    v_mfma_f32_16x16x32_bf16 a[20:23], v[68:71], v[36:39], a[20:23]
    ds_read_b128 v[56:59], v20 offset:4096
    v_mfma_f32_16x16x32_bf16 a[24:27], v[68:71], v[40:43], a[24:27]
    ds_read_b128 v[92:95], v24 offset:4608
    v_mfma_f32_16x16x32_bf16 a[28:31], v[68:71], v[44:47], a[28:31]
    ds_read_b128 v[60:63], v20 offset:6144
    v_mfma_f32_16x16x32_bf16 a[32:35], v[72:75], v[32:35], a[32:35]
    v_mfma_f32_16x16x32_bf16 a[36:39], v[72:75], v[36:39], a[36:39]
    v_mfma_f32_16x16x32_bf16 a[40:43], v[72:75], v[40:43], a[40:43]
    v_mfma_f32_16x16x32_bf16 a[44:47], v[72:75], v[44:47], a[44:47]
    v_mfma_f32_16x16x32_bf16 a[48:51], v[76:79], v[32:35], a[48:51]
    v_mfma_f32_16x16x32_bf16 a[52:55], v[76:79], v[36:39], a[52:55]
    v_mfma_f32_16x16x32_bf16 a[56:59], v[76:79], v[40:43], a[56:59]
    v_mfma_f32_16x16x32_bf16 a[60:63], v[76:79], v[44:47], a[60:63]
    s_waitcnt lgkmcnt(0)
    s_barrier
    v_mfma_f32_16x16x32_bf16 a[0:3], v[80:83], v[48:51], a[0:3]
    ds_read_b128 v[64:67], v23 offset:32768
    v_mfma_f32_16x16x32_bf16 a[4:7], v[80:83], v[52:55], a[4:7]
    ds_read_b128 v[32:35], v19 offset:32768
    v_mfma_f32_16x16x32_bf16 a[8:11], v[80:83], v[56:59], a[8:11]
    ds_read_b128 v[68:71], v23 offset:33280
    v_mfma_f32_16x16x32_bf16 a[12:15], v[80:83], v[60:63], a[12:15]
    ds_read_b128 v[36:39], v19 offset:34816
    v_mfma_f32_16x16x32_bf16 a[16:19], v[84:87], v[48:51], a[16:19]
    ds_read_b128 v[72:75], v23 offset:36864
    v_mfma_f32_16x16x32_bf16 a[20:23], v[84:87], v[52:55], a[20:23]
    ds_read_b128 v[40:43], v19 offset:36864
    v_mfma_f32_16x16x32_bf16 a[24:27], v[84:87], v[56:59], a[24:27]
    ds_read_b128 v[76:79], v23 offset:37376
    v_mfma_f32_16x16x32_bf16 a[28:31], v[84:87], v[60:63], a[28:31]
    ds_read_b128 v[44:47], v19 offset:38912
    v_mfma_f32_16x16x32_bf16 a[32:35], v[88:91], v[48:51], a[32:35]
    v_mfma_f32_16x16x32_bf16 a[36:39], v[88:91], v[52:55], a[36:39]
    v_mfma_f32_16x16x32_bf16 a[40:43], v[88:91], v[56:59], a[40:43]
    v_mfma_f32_16x16x32_bf16 a[44:47], v[88:91], v[60:63], a[44:47]
    v_mfma_f32_16x16x32_bf16 a[48:51], v[92:95], v[48:51], a[48:51]
    v_mfma_f32_16x16x32_bf16 a[52:55], v[92:95], v[52:55], a[52:55]
    v_mfma_f32_16x16x32_bf16 a[56:59], v[92:95], v[56:59], a[56:59]
    v_mfma_f32_16x16x32_bf16 a[60:63], v[92:95], v[60:63], a[60:63]
    s_waitcnt lgkmcnt(0)
    v_mfma_f32_16x16x32_bf16 a[0:3], v[64:67], v[32:35], a[0:3]
    ds_read_b128 v[80:83], v24 offset:32768
    v_mfma_f32_16x16x32_bf16 a[4:7], v[64:67], v[36:39], a[4:7]
    ds_read_b128 v[48:51], v20 offset:32768
    v_mfma_f32_16x16x32_bf16 a[8:11], v[64:67], v[40:43], a[8:11]
    ds_read_b128 v[84:87], v24 offset:33280
    v_mfma_f32_16x16x32_bf16 a[12:15], v[64:67], v[44:47], a[12:15]
    ds_read_b128 v[52:55], v20 offset:34816
    v_mfma_f32_16x16x32_bf16 a[16:19], v[68:71], v[32:35], a[16:19]
    ds_read_b128 v[88:91], v24 offset:36864
    v_mfma_f32_16x16x32_bf16 a[20:23], v[68:71], v[36:39], a[20:23]
    ds_read_b128 v[56:59], v20 offset:36864
    v_mfma_f32_16x16x32_bf16 a[24:27], v[68:71], v[40:43], a[24:27]
    ds_read_b128 v[92:95], v24 offset:37376
    v_mfma_f32_16x16x32_bf16 a[28:31], v[68:71], v[44:47], a[28:31]
    ds_read_b128 v[60:63], v20 offset:38912
    v_mfma_f32_16x16x32_bf16 a[32:35], v[72:75], v[32:35], a[32:35]
    v_mfma_f32_16x16x32_bf16 a[36:39], v[72:75], v[36:39], a[36:39]
    v_mfma_f32_16x16x32_bf16 a[40:43], v[72:75], v[40:43], a[40:43]
    v_mfma_f32_16x16x32_bf16 a[44:47], v[72:75], v[44:47], a[44:47]
    v_mfma_f32_16x16x32_bf16 a[48:51], v[76:79], v[32:35], a[48:51]
    v_mfma_f32_16x16x32_bf16 a[52:55], v[76:79], v[36:39], a[52:55]
    v_mfma_f32_16x16x32_bf16 a[56:59], v[76:79], v[40:43], a[56:59]
    v_mfma_f32_16x16x32_bf16 a[60:63], v[76:79], v[44:47], a[60:63]
    s_waitcnt lgkmcnt(0)
    v_mfma_f32_16x16x32_bf16 a[0:3], v[80:83], v[48:51], a[0:3]
    v_mfma_f32_16x16x32_bf16 a[4:7], v[80:83], v[52:55], a[4:7]
    v_mfma_f32_16x16x32_bf16 a[8:11], v[80:83], v[56:59], a[8:11]
    v_mfma_f32_16x16x32_bf16 a[12:15], v[80:83], v[60:63], a[12:15]
    v_mfma_f32_16x16x32_bf16 a[16:19], v[84:87], v[48:51], a[16:19]
    v_mfma_f32_16x16x32_bf16 a[20:23], v[84:87], v[52:55], a[20:23]
    v_mfma_f32_16x16x32_bf16 a[24:27], v[84:87], v[56:59], a[24:27]
    v_mfma_f32_16x16x32_bf16 a[28:31], v[84:87], v[60:63], a[28:31]
    v_mfma_f32_16x16x32_bf16 a[32:35], v[88:91], v[48:51], a[32:35]
    v_mfma_f32_16x16x32_bf16 a[36:39], v[88:91], v[52:55], a[36:39]
    v_mfma_f32_16x16x32_bf16 a[40:43], v[88:91], v[56:59], a[40:43]
    v_mfma_f32_16x16x32_bf16 a[44:47], v[88:91], v[60:63], a[44:47]
    v_mfma_f32_16x16x32_bf16 a[48:51], v[92:95], v[48:51], a[48:51]
    v_mfma_f32_16x16x32_bf16 a[52:55], v[92:95], v[52:55], a[52:55]
    v_mfma_f32_16x16x32_bf16 a[56:59], v[92:95], v[56:59], a[56:59]
    v_mfma_f32_16x16x32_bf16 a[60:63], v[92:95], v[60:63], a[60:63]
    s_nop 15
    s_nop 7
    v_accvgpr_read_b32 v32, a0
    v_accvgpr_read_b32 v36, a16
    v_accvgpr_read_b32 v33, a1
    v_accvgpr_read_b32 v37, a17
    v_accvgpr_read_b32 v34, a2
    v_accvgpr_read_b32 v38, a18
    v_accvgpr_read_b32 v35, a3
    v_accvgpr_read_b32 v39, a19
    v_cvt_pk_bf16_f32 v40, v32, v33
    v_cvt_pk_bf16_f32 v41, v34, v35
    v_cvt_pk_bf16_f32 v42, v36, v37
    v_cvt_pk_bf16_f32 v43, v38, v39
    s_mov_b32 s29, 0
    buffer_store_dwordx4 v[40:43], v26, s[16:19], s29 offen
    v_accvgpr_read_b32 v48, a32
    v_accvgpr_read_b32 v52, a48
    v_accvgpr_read_b32 v49, a33
    v_accvgpr_read_b32 v53, a49
    v_accvgpr_read_b32 v50, a34
    v_accvgpr_read_b32 v54, a50
    v_accvgpr_read_b32 v51, a35
    v_accvgpr_read_b32 v55, a51
    v_cvt_pk_bf16_f32 v56, v48, v49
    v_cvt_pk_bf16_f32 v57, v50, v51
    v_cvt_pk_bf16_f32 v58, v52, v53
    v_cvt_pk_bf16_f32 v59, v54, v55
    s_mov_b32 s29, 64
    buffer_store_dwordx4 v[56:59], v26, s[16:19], s29 offen
    v_accvgpr_read_b32 v64, a4
    v_accvgpr_read_b32 v68, a20
    v_accvgpr_read_b32 v65, a5
    v_accvgpr_read_b32 v69, a21
    v_accvgpr_read_b32 v66, a6
    v_accvgpr_read_b32 v70, a22
    v_accvgpr_read_b32 v67, a7
    v_accvgpr_read_b32 v71, a23
    v_cvt_pk_bf16_f32 v72, v64, v65
    v_cvt_pk_bf16_f32 v73, v66, v67
    v_cvt_pk_bf16_f32 v74, v68, v69
    v_cvt_pk_bf16_f32 v75, v70, v71
    s_mov_b32 s29, 65536
    buffer_store_dwordx4 v[72:75], v26, s[16:19], s29 offen
    v_accvgpr_read_b32 v80, a36
    v_accvgpr_read_b32 v84, a52
    v_accvgpr_read_b32 v81, a37
    v_accvgpr_read_b32 v85, a53
    v_accvgpr_read_b32 v82, a38
    v_accvgpr_read_b32 v86, a54
    v_accvgpr_read_b32 v83, a39
    v_accvgpr_read_b32 v87, a55
    v_cvt_pk_bf16_f32 v88, v80, v81
    v_cvt_pk_bf16_f32 v89, v82, v83
    v_cvt_pk_bf16_f32 v90, v84, v85
    v_cvt_pk_bf16_f32 v91, v86, v87
    s_mov_b32 s29, 65600
    buffer_store_dwordx4 v[88:91], v26, s[16:19], s29 offen
    v_accvgpr_read_b32 v32, a8
    v_accvgpr_read_b32 v36, a24
    v_accvgpr_read_b32 v33, a9
    v_accvgpr_read_b32 v37, a25
    v_accvgpr_read_b32 v34, a10
    v_accvgpr_read_b32 v38, a26
    v_accvgpr_read_b32 v35, a11
    v_accvgpr_read_b32 v39, a27
    v_cvt_pk_bf16_f32 v40, v32, v33
    v_cvt_pk_bf16_f32 v41, v34, v35
    v_cvt_pk_bf16_f32 v42, v36, v37
    v_cvt_pk_bf16_f32 v43, v38, v39
    s_mov_b32 s29, 131072
    buffer_store_dwordx4 v[40:43], v26, s[16:19], s29 offen
    v_accvgpr_read_b32 v48, a40
    v_accvgpr_read_b32 v52, a56
    v_accvgpr_read_b32 v49, a41
    v_accvgpr_read_b32 v53, a57
    v_accvgpr_read_b32 v50, a42
    v_accvgpr_read_b32 v54, a58
    v_accvgpr_read_b32 v51, a43
    v_accvgpr_read_b32 v55, a59
    v_cvt_pk_bf16_f32 v56, v48, v49
    v_cvt_pk_bf16_f32 v57, v50, v51
    v_cvt_pk_bf16_f32 v58, v52, v53
    v_cvt_pk_bf16_f32 v59, v54, v55
    s_mov_b32 s29, 131136
    buffer_store_dwordx4 v[56:59], v26, s[16:19], s29 offen
    v_accvgpr_read_b32 v64, a12
    v_accvgpr_read_b32 v68, a28
    v_accvgpr_read_b32 v65, a13
    v_accvgpr_read_b32 v69, a29
    v_accvgpr_read_b32 v66, a14
    v_accvgpr_read_b32 v70, a30
    v_accvgpr_read_b32 v67, a15
    v_accvgpr_read_b32 v71, a31
    v_cvt_pk_bf16_f32 v72, v64, v65
    v_cvt_pk_bf16_f32 v73, v66, v67
    v_cvt_pk_bf16_f32 v74, v68, v69
    v_cvt_pk_bf16_f32 v75, v70, v71
    s_mov_b32 s29, 196608
    buffer_store_dwordx4 v[72:75], v26, s[16:19], s29 offen
    v_accvgpr_read_b32 v80, a44
    v_accvgpr_read_b32 v84, a60
    v_accvgpr_read_b32 v81, a45
    v_accvgpr_read_b32 v85, a61
    v_accvgpr_read_b32 v82, a46
    v_accvgpr_read_b32 v86, a62
    v_accvgpr_read_b32 v83, a47
    v_accvgpr_read_b32 v87, a63
    v_cvt_pk_bf16_f32 v88, v80, v81
    v_cvt_pk_bf16_f32 v89, v82, v83
    v_cvt_pk_bf16_f32 v90, v84, v85
    v_cvt_pk_bf16_f32 v91, v86, v87
    s_mov_b32 s29, 196672
    buffer_store_dwordx4 v[88:91], v26, s[16:19], s29 offen
gemm_a1_kernel_end:
    s_endpgm
.section .rodata,"a"
.p2align 6
.amdhsa_kernel gemm_a1_kernel
  .amdhsa_next_free_vgpr 160
  .amdhsa_next_free_sgpr 48
  .amdhsa_accum_offset 96
  .amdhsa_group_segment_fixed_size 0
  .amdhsa_kernarg_size 96
  .amdhsa_user_sgpr_count 2
  .amdhsa_user_sgpr_kernarg_segment_ptr 1
  .amdhsa_system_sgpr_workgroup_id_x 1
  .amdhsa_float_denorm_mode_32 3
  .amdhsa_float_denorm_mode_16_64 3
.end_amdhsa_kernel

.text
.globl gemm_a2_kernel
.p2align 8
.type gemm_a2_kernel,@function
gemm_a2_kernel:
    s_cmp_ge_u32 s2, 256
    s_cbranch_scc1 gemm_a2_kernel_end
    s_load_dwordx2 s[4:5], s[0:1], 8
    s_load_dwordx2 s[6:7], s[0:1], 16
    s_load_dwordx2 s[36:37], s[0:1], 88
    s_and_b32 s31, s2, 7
    s_lshr_b32 s34, s2, 3
    s_waitcnt lgkmcnt(0)
    s_and_b32 s22, s31, 1
    s_lshr_b32 s29, s31, 1
    s_lshl_b32 s29, s29, 2
    s_and_b32 s30, s34, 3
    s_add_u32 s20, s29, s30
    s_lshr_b32 s21, s34, 2
    s_cmp_eq_u32 s22, 0
    s_cselect_b64 s[32:33], s[4:5], s[6:7]
    s_mul_i32 s29, s20, 524288
    s_add_u32 s8, s32, s29
    s_addc_u32 s9, s33, 0
    s_sub_u32 s10, 8388608, s29
    s_mov_b32 s11, 0x20000
    s_add_u32 s38, s36, 4194304
    s_addc_u32 s39, s37, 0
    s_lshl_b32 s29, s22, 3
    s_add_u32 s29, s29, s21
    s_mul_i32 s29, s29, 524288
    s_add_u32 s12, s38, s29
    s_addc_u32 s13, s39, 0
    s_sub_u32 s14, 8388608, s29
    s_mov_b32 s15, 0x20000
    s_add_u32 s38, s36, 12582912
    s_addc_u32 s39, s37, 0
    s_mul_i32 s29, s22, 4194304
    s_mul_i32 s30, s20, 262144
    s_add_u32 s29, s29, s30
    s_mul_i32 s30, s21, 256
    s_add_u32 s29, s29, s30
    s_add_u32 s16, s38, s29
    s_addc_u32 s17, s39, 0
    s_sub_u32 s18, 8388608, s29
    s_mov_b32 s19, 0x20000
    v_and_b32 v1, 63, v0
    v_lshrrev_b32 v2, 6, v0
    s_nop 0
    v_readfirstlane_b32 s24, v2
    s_nop 3
    s_cmp_lt_u32 s24, 4
    s_cbranch_scc1 gemm_a2_kernel_compute
    s_sub_u32 s24, s24, 4
    v_subrev_u32 v2, 4, v2
    v_lshrrev_b32 v3, 3, v1
    v_and_b32 v4, 7, v1
    v_mul_u32_u24 v5, 32, v2
    v_add_u32 v5, v5, v3
    v_and_b32 v6, 3, v5
    v_lshrrev_b32 v7, 1, v5
    v_and_or_b32 v6, v7, 4, v6
    v_xor_b32 v6, v6, v4
    v_lshlrev_b32 v6, 4, v6
    v_mul_u32_u24 v9, 4096, v5
    v_add_u32 v9, v9, v6
    v_mul_u32_u24 v5, 32, v2
    v_add_u32 v5, v5, v3
    v_add_u32 v5, 8, v5
    v_and_b32 v6, 3, v5
    v_lshrrev_b32 v7, 1, v5
    v_and_or_b32 v6, v7, 4, v6
    v_xor_b32 v6, v6, v4
    v_lshlrev_b32 v6, 4, v6
    v_mul_u32_u24 v10, 4096, v5
    v_add_u32 v10, v10, v6
    v_mul_u32_u24 v5, 32, v2
    v_add_u32 v5, v5, v3
    v_add_u32 v5, 16, v5
    v_and_b32 v6, 3, v5
    v_lshrrev_b32 v7, 1, v5
    v_and_or_b32 v6, v7, 4, v6
    v_xor_b32 v6, v6, v4
    v_lshlrev_b32 v6, 4, v6
    v_mul_u32_u24 v11, 4096, v5
    v_add_u32 v11, v11, v6
    v_mul_u32_u24 v5, 32, v2
    v_add_u32 v5, v5, v3
    v_add_u32 v5, 24, v5
    v_and_b32 v6, 3, v5
    v_lshrrev_b32 v7, 1, v5
    v_and_or_b32 v6, v7, 4, v6
    v_xor_b32 v6, v6, v4
    v_lshlrev_b32 v6, 4, v6
    v_mul_u32_u24 v12, 4096, v5
    v_add_u32 v12, v12, v6
    v_mul_u32_u24 v5, 32, v2
    v_add_u32 v5, v5, v3
    v_and_b32 v6, 3, v5
    v_lshrrev_b32 v7, 1, v5
    v_and_or_b32 v6, v7, 4, v6
    v_xor_b32 v6, v6, v4
    v_lshlrev_b32 v6, 4, v6
    v_mul_u32_u24 v13, 4096, v5
    v_add_u32 v13, v13, v6
    v_mul_u32_u24 v5, 32, v2
    v_add_u32 v5, v5, v3
    v_add_u32 v5, 8, v5
    v_and_b32 v6, 3, v5
    v_lshrrev_b32 v7, 1, v5
    v_and_or_b32 v6, v7, 4, v6
    v_xor_b32 v6, v6, v4
    v_lshlrev_b32 v6, 4, v6
    v_mul_u32_u24 v14, 4096, v5
    v_add_u32 v14, v14, v6
    v_mul_u32_u24 v5, 32, v2
    v_add_u32 v5, v5, v3
    v_add_u32 v5, 16, v5
    v_and_b32 v6, 3, v5
    v_lshrrev_b32 v7, 1, v5
    v_and_or_b32 v6, v7, 4, v6
    v_xor_b32 v6, v6, v4
    v_lshlrev_b32 v6, 4, v6
    v_mul_u32_u24 v15, 4096, v5
    v_add_u32 v15, v15, v6
    v_mul_u32_u24 v5, 32, v2
    v_add_u32 v5, v5, v3
    v_add_u32 v5, 24, v5
    v_and_b32 v6, 3, v5
    v_lshrrev_b32 v7, 1, v5
    v_and_or_b32 v6, v7, 4, v6
    v_xor_b32 v6, v6, v4
    v_lshlrev_b32 v6, 4, v6
    v_mul_u32_u24 v16, 4096, v5
    v_add_u32 v16, v16, v6
    s_mul_i32 s25, s24, 4096
    s_mul_i32 s26, s24, 4096
    s_add_u32 s26, s26, 16384
    s_mov_b32 s27, 0
    s_add_u32 m0, s25, 0
    s_nop 0
    buffer_load_dwordx4 v9, s[8:11], s27 offen lds
    s_add_u32 m0, s25, 1024
    s_nop 0
    buffer_load_dwordx4 v10, s[8:11], s27 offen lds
    s_add_u32 m0, s25, 2048
    s_nop 0
    buffer_load_dwordx4 v11, s[8:11], s27 offen lds
    s_add_u32 m0, s25, 3072
    s_nop 0
    buffer_load_dwordx4 v12, s[8:11], s27 offen lds
    s_add_u32 m0, s26, 0
    s_nop 0
    buffer_load_dwordx4 v13, s[12:15], s27 offen lds
    s_add_u32 m0, s26, 1024
    s_nop 0
    buffer_load_dwordx4 v14, s[12:15], s27 offen lds
    s_add_u32 m0, s26, 2048
    s_nop 0
    buffer_load_dwordx4 v15, s[12:15], s27 offen lds
    s_add_u32 m0, s26, 3072
    s_nop 0
    buffer_load_dwordx4 v16, s[12:15], s27 offen lds
    s_add_u32 s27, s27, 128
    s_add_u32 m0, s25, 32768
    s_nop 0
    buffer_load_dwordx4 v9, s[8:11], s27 offen lds
    s_add_u32 m0, s25, 33792
    s_nop 0
    buffer_load_dwordx4 v10, s[8:11], s27 offen lds
    s_add_u32 m0, s25, 34816
    s_nop 0
    buffer_load_dwordx4 v11, s[8:11], s27 offen lds
    s_add_u32 m0, s25, 35840
    s_nop 0
    buffer_load_dwordx4 v12, s[8:11], s27 offen lds
    s_add_u32 m0, s26, 32768
    s_nop 0
    buffer_load_dwordx4 v13, s[12:15], s27 offen lds
    s_add_u32 m0, s26, 33792
    s_nop 0
    buffer_load_dwordx4 v14, s[12:15], s27 offen lds
    s_add_u32 m0, s26, 34816
    s_nop 0
    buffer_load_dwordx4 v15, s[12:15], s27 offen lds
    s_add_u32 m0, s26, 35840
    s_nop 0
    buffer_load_dwordx4 v16, s[12:15], s27 offen lds
    s_add_u32 s27, s27, 128
    s_add_u32 m0, s25, 65536
    s_nop 0
    buffer_load_dwordx4 v9, s[8:11], s27 offen lds
    s_add_u32 m0, s25, 66560
    s_nop 0
    buffer_load_dwordx4 v10, s[8:11], s27 offen lds
    s_add_u32 m0, s25, 67584
    s_nop 0
    buffer_load_dwordx4 v11, s[8:11], s27 offen lds
    s_add_u32 m0, s25, 68608
    s_nop 0
    buffer_load_dwordx4 v12, s[8:11], s27 offen lds
    s_add_u32 m0, s26, 65536
    s_nop 0
    buffer_load_dwordx4 v13, s[12:15], s27 offen lds
    s_add_u32 m0, s26, 66560
    s_nop 0
    buffer_load_dwordx4 v14, s[12:15], s27 offen lds
    s_add_u32 m0, s26, 67584
    s_nop 0
    buffer_load_dwordx4 v15, s[12:15], s27 offen lds
    s_add_u32 m0, s26, 68608
    s_nop 0
    buffer_load_dwordx4 v16, s[12:15], s27 offen lds
    s_add_u32 s27, s27, 128
    s_add_u32 m0, s25, 98304
    s_nop 0
    buffer_load_dwordx4 v9, s[8:11], s27 offen lds
    s_add_u32 m0, s25, 99328
    s_nop 0
    buffer_load_dwordx4 v10, s[8:11], s27 offen lds
    s_add_u32 m0, s25, 100352
    s_nop 0
    buffer_load_dwordx4 v11, s[8:11], s27 offen lds
    s_add_u32 m0, s25, 101376
    s_nop 0
    buffer_load_dwordx4 v12, s[8:11], s27 offen lds
    s_add_u32 m0, s26, 98304
    s_nop 0
    buffer_load_dwordx4 v13, s[12:15], s27 offen lds
    s_add_u32 m0, s26, 99328
    s_nop 0
    buffer_load_dwordx4 v14, s[12:15], s27 offen lds
    s_add_u32 m0, s26, 100352
    s_nop 0
    buffer_load_dwordx4 v15, s[12:15], s27 offen lds
    s_add_u32 m0, s26, 101376
    s_nop 0
    buffer_load_dwordx4 v16, s[12:15], s27 offen lds
    s_add_u32 s27, s27, 128
    s_waitcnt vmcnt(24)
    s_barrier
    s_mov_b32 s28, 7
gemm_a2_kernel_lloop:
    s_waitcnt vmcnt(16)
    s_barrier
    s_add_u32 m0, s25, 0
    s_nop 0
    buffer_load_dwordx4 v9, s[8:11], s27 offen lds
    s_add_u32 m0, s25, 1024
    s_nop 0
    buffer_load_dwordx4 v10, s[8:11], s27 offen lds
    s_add_u32 m0, s25, 2048
    s_nop 0
    buffer_load_dwordx4 v11, s[8:11], s27 offen lds
    s_add_u32 m0, s25, 3072
    s_nop 0
    buffer_load_dwordx4 v12, s[8:11], s27 offen lds
    s_add_u32 m0, s26, 0
    s_nop 0
    buffer_load_dwordx4 v13, s[12:15], s27 offen lds
    s_add_u32 m0, s26, 1024
    s_nop 0
    buffer_load_dwordx4 v14, s[12:15], s27 offen lds
    s_add_u32 m0, s26, 2048
    s_nop 0
    buffer_load_dwordx4 v15, s[12:15], s27 offen lds
    s_add_u32 m0, s26, 3072
    s_nop 0
    buffer_load_dwordx4 v16, s[12:15], s27 offen lds
    s_add_u32 s27, s27, 128
    s_waitcnt vmcnt(16)
    s_barrier
    s_add_u32 m0, s25, 32768
    s_nop 0
    buffer_load_dwordx4 v9, s[8:11], s27 offen lds
    s_add_u32 m0, s25, 33792
    s_nop 0
    buffer_load_dwordx4 v10, s[8:11], s27 offen lds
    s_add_u32 m0, s25, 34816
    s_nop 0
    buffer_load_dwordx4 v11, s[8:11], s27 offen lds
    s_add_u32 m0, s25, 35840
    s_nop 0
    buffer_load_dwordx4 v12, s[8:11], s27 offen lds
    s_add_u32 m0, s26, 32768
    s_nop 0
    buffer_load_dwordx4 v13, s[12:15], s27 offen lds
    s_add_u32 m0, s26, 33792
    s_nop 0
    buffer_load_dwordx4 v14, s[12:15], s27 offen lds
    s_add_u32 m0, s26, 34816
    s_nop 0
    buffer_load_dwordx4 v15, s[12:15], s27 offen lds
    s_add_u32 m0, s26, 35840
    s_nop 0
    buffer_load_dwordx4 v16, s[12:15], s27 offen lds
    s_add_u32 s27, s27, 128
    s_waitcnt vmcnt(16)
    s_barrier
    s_add_u32 m0, s25, 65536
    s_nop 0
    buffer_load_dwordx4 v9, s[8:11], s27 offen lds
    s_add_u32 m0, s25, 66560
    s_nop 0
    buffer_load_dwordx4 v10, s[8:11], s27 offen lds
    s_add_u32 m0, s25, 67584
    s_nop 0
    buffer_load_dwordx4 v11, s[8:11], s27 offen lds
    s_add_u32 m0, s25, 68608
    s_nop 0
    buffer_load_dwordx4 v12, s[8:11], s27 offen lds
    s_add_u32 m0, s26, 65536
    s_nop 0
    buffer_load_dwordx4 v13, s[12:15], s27 offen lds
    s_add_u32 m0, s26, 66560
    s_nop 0
    buffer_load_dwordx4 v14, s[12:15], s27 offen lds
    s_add_u32 m0, s26, 67584
    s_nop 0
    buffer_load_dwordx4 v15, s[12:15], s27 offen lds
    s_add_u32 m0, s26, 68608
    s_nop 0
    buffer_load_dwordx4 v16, s[12:15], s27 offen lds
    s_add_u32 s27, s27, 128
    s_waitcnt vmcnt(16)
    s_barrier
    s_add_u32 m0, s25, 98304
    s_nop 0
    buffer_load_dwordx4 v9, s[8:11], s27 offen lds
    s_add_u32 m0, s25, 99328
    s_nop 0
    buffer_load_dwordx4 v10, s[8:11], s27 offen lds
    s_add_u32 m0, s25, 100352
    s_nop 0
    buffer_load_dwordx4 v11, s[8:11], s27 offen lds
    s_add_u32 m0, s25, 101376
    s_nop 0
    buffer_load_dwordx4 v12, s[8:11], s27 offen lds
    s_add_u32 m0, s26, 98304
    s_nop 0
    buffer_load_dwordx4 v13, s[12:15], s27 offen lds
    s_add_u32 m0, s26, 99328
    s_nop 0
    buffer_load_dwordx4 v14, s[12:15], s27 offen lds
    s_add_u32 m0, s26, 100352
    s_nop 0
    buffer_load_dwordx4 v15, s[12:15], s27 offen lds
    s_add_u32 m0, s26, 101376
    s_nop 0
    buffer_load_dwordx4 v16, s[12:15], s27 offen lds
    s_add_u32 s27, s27, 128
    s_sub_u32 s28, s28, 1
    s_cmp_lg_u32 s28, 0
    s_cbranch_scc1 gemm_a2_kernel_lloop
    s_waitcnt vmcnt(16)
    s_barrier
    s_waitcnt vmcnt(8)
    s_barrier
    s_waitcnt vmcnt(0)
    s_barrier
    s_endpgm
gemm_a2_kernel_compute:
    v_and_b32 v3, 15, v1
    v_lshrrev_b32 v4, 4, v1
    v_and_b32 v5, 1, v2
    v_lshrrev_b32 v6, 1, v2
    v_and_b32 v7, 3, v3
    v_lshrrev_b32 v8, 1, v3
    v_and_or_b32 v7, v8, 4, v7
    v_xor_b32 v7, v7, v4
    v_lshlrev_b32 v7, 4, v7
    v_mul_u32_u24 v8, 64, v5
    v_add_u32 v8, v8, v3
    v_lshlrev_b32 v8, 7, v8
    v_add_u32 v17, v8, v7
    v_xor_b32 v18, 64, v17
    v_add_u32 v19, 0x10000, v17
    v_add_u32 v20, 0x10000, v18
    v_lshrrev_b32 v25, 2, v3
    v_lshlrev_b32 v25, 3, v25
    v_and_or_b32 v25, v3, 3, v25
    v_and_b32 v7, 3, v25
    v_lshrrev_b32 v8, 1, v25
    v_and_or_b32 v7, v8, 4, v7
    v_xor_b32 v7, v7, v4
    v_lshlrev_b32 v7, 4, v7
    v_mul_u32_u24 v8, 64, v6
    v_add_u32 v8, v8, v25
    v_lshlrev_b32 v8, 7, v8
    v_add_u32 v21, v8, v7
    v_add_u32 v21, 16384, v21
    v_xor_b32 v22, 64, v21
    v_add_u32 v23, 0x10000, v21
    v_add_u32 v24, 0x10000, v22
    v_mul_u32_u24 v7, 64, v5
    v_add_u32 v7, v7, v3
    v_mul_u32_u24 v7, 2048, v7
    v_mul_u32_u24 v8, 128, v6
    v_add_u32 v7, v7, v8
    v_lshlrev_b32 v28, 4, v1
    v_lshl_add_u32 v28, v5, 14, v28
    v_lshl_add_u32 v26, v4, 4, v7
    v_lshl_add_u32 v27, v4, 3, v7
    v_accvgpr_write_b32 a0, 0
    v_accvgpr_write_b32 a1, 0
    v_accvgpr_write_b32 a2, 0
    v_accvgpr_write_b32 a3, 0
    v_accvgpr_write_b32 a4, 0
    v_accvgpr_write_b32 a5, 0
    v_accvgpr_write_b32 a6, 0
    v_accvgpr_write_b32 a7, 0
    v_accvgpr_write_b32 a8, 0
    v_accvgpr_write_b32 a9, 0
    v_accvgpr_write_b32 a10, 0
    v_accvgpr_write_b32 a11, 0
    v_accvgpr_write_b32 a12, 0
    v_accvgpr_write_b32 a13, 0
    v_accvgpr_write_b32 a14, 0
    v_accvgpr_write_b32 a15, 0
    v_accvgpr_write_b32 a16, 0
    v_accvgpr_write_b32 a17, 0
    v_accvgpr_write_b32 a18, 0
    v_accvgpr_write_b32 a19, 0
    v_accvgpr_write_b32 a20, 0
    v_accvgpr_write_b32 a21, 0
    v_accvgpr_write_b32 a22, 0
    v_accvgpr_write_b32 a23, 0
    v_accvgpr_write_b32 a24, 0
    v_accvgpr_write_b32 a25, 0
    v_accvgpr_write_b32 a26, 0
    v_accvgpr_write_b32 a27, 0
    v_accvgpr_write_b32 a28, 0
    v_accvgpr_write_b32 a29, 0
    v_accvgpr_write_b32 a30, 0
    v_accvgpr_write_b32 a31, 0
    v_accvgpr_write_b32 a32, 0
    v_accvgpr_write_b32 a33, 0
    v_accvgpr_write_b32 a34, 0
    v_accvgpr_write_b32 a35, 0
    v_accvgpr_write_b32 a36, 0
    v_accvgpr_write_b32 a37, 0
    v_accvgpr_write_b32 a38, 0
    v_accvgpr_write_b32 a39, 0
    v_accvgpr_write_b32 a40, 0
    v_accvgpr_write_b32 a41, 0
    v_accvgpr_write_b32 a42, 0
    v_accvgpr_write_b32 a43, 0
    v_accvgpr_write_b32 a44, 0
    v_accvgpr_write_b32 a45, 0
    v_accvgpr_write_b32 a46, 0
    v_accvgpr_write_b32 a47, 0
    v_accvgpr_write_b32 a48, 0
    v_accvgpr_write_b32 a49, 0
    v_accvgpr_write_b32 a50, 0
    v_accvgpr_write_b32 a51, 0
    v_accvgpr_write_b32 a52, 0
    v_accvgpr_write_b32 a53, 0
    v_accvgpr_write_b32 a54, 0
    v_accvgpr_write_b32 a55, 0
    v_accvgpr_write_b32 a56, 0
    v_accvgpr_write_b32 a57, 0
    v_accvgpr_write_b32 a58, 0
    v_accvgpr_write_b32 a59, 0
    v_accvgpr_write_b32 a60, 0
    v_accvgpr_write_b32 a61, 0
    v_accvgpr_write_b32 a62, 0
    v_accvgpr_write_b32 a63, 0
    s_barrier
    ds_read_b128 v[64:67], v21 offset:0
    ds_read_b128 v[32:35], v17 offset:0
    ds_read_b128 v[68:71], v21 offset:512
    ds_read_b128 v[36:39], v17 offset:2048
    ds_read_b128 v[72:75], v21 offset:4096
    ds_read_b128 v[40:43], v17 offset:4096
    ds_read_b128 v[76:79], v21 offset:4608
    ds_read_b128 v[44:47], v17 offset:6144
    s_mov_b32 s28, 7
gemm_a2_kernel_loop:
    s_waitcnt lgkmcnt(0)
    v_mfma_f32_16x16x32_bf16 a[0:3], v[64:67], v[32:35], a[0:3]
    ds_read_b128 v[80:83], v22 offset:0
    v_mfma_f32_16x16x32_bf16 a[4:7], v[64:67], v[36:39], a[4:7]
    ds_read_b128 v[48:51], v18 offset:0
    v_mfma_f32_16x16x32_bf16 a[8:11], v[64:67], v[40:43], a[8:11]
    ds_read_b128 v[84:87], v22 offset:512
    v_mfma_f32_16x16x32_bf16 a[12:15], v[64:67], v[44:47], a[12:15]
    ds_read_b128 v[52:55], v18 offset:2048
    v_mfma_f32_16x16x32_bf16 a[16:19], v[68:71], v[32:35], a[16:19]
    ds_read_b128 v[88:91], v22 offset:4096
    v_mfma_f32_16x16x32_bf16 a[20:23], v[68:71], v[36:39], a[20:23]
    ds_read_b128 v[56:59], v18 offset:4096
    v_mfma_f32_16x16x32_bf16 a[24:27], v[68:71], v[40:43], a[24:27]
    ds_read_b128 v[92:95], v22 offset:4608
    v_mfma_f32_16x16x32_bf16 a[28:31], v[68:71], v[44:47], a[28:31]
    ds_read_b128 v[60:63], v18 offset:6144
    v_mfma_f32_16x16x32_bf16 a[32:35], v[72:75], v[32:35], a[32:35]
    v_mfma_f32_16x16x32_bf16 a[36:39], v[72:75], v[36:39], a[36:39]
    v_mfma_f32_16x16x32_bf16 a[40:43], v[72:75], v[40:43], a[40:43]
    v_mfma_f32_16x16x32_bf16 a[44:47], v[72:75], v[44:47], a[44:47]
    v_mfma_f32_16x16x32_bf16 a[48:51], v[76:79], v[32:35], a[48:51]
    v_mfma_f32_16x16x32_bf16 a[52:55], v[76:79], v[36:39], a[52:55]
    v_mfma_f32_16x16x32_bf16 a[56:59], v[76:79], v[40:43], a[56:59]
    v_mfma_f32_16x16x32_bf16 a[60:63], v[76:79], v[44:47], a[60:63]
    s_waitcnt lgkmcnt(0)
    s_barrier
    v_mfma_f32_16x16x32_bf16 a[0:3], v[80:83], v[48:51], a[0:3]
    ds_read_b128 v[64:67], v21 offset:32768
    v_mfma_f32_16x16x32_bf16 a[4:7], v[80:83], v[52:55], a[4:7]
    ds_read_b128 v[32:35], v17 offset:32768
    v_mfma_f32_16x16x32_bf16 a[8:11], v[80:83], v[56:59], a[8:11]
    ds_read_b128 v[68:71], v21 offset:33280
    v_mfma_f32_16x16x32_bf16 a[12:15], v[80:83], v[60:63], a[12:15]
    ds_read_b128 v[36:39], v17 offset:34816
    v_mfma_f32_16x16x32_bf16 a[16:19], v[84:87], v[48:51], a[16:19]
    ds_read_b128 v[72:75], v21 offset:36864
    v_mfma_f32_16x16x32_bf16 a[20:23], v[84:87], v[52:55], a[20:23]
    ds_read_b128 v[40:43], v17 offset:36864
    v_mfma_f32_16x16x32_bf16 a[24:27], v[84:87], v[56:59], a[24:27]
    ds_read_b128 v[76:79], v21 offset:37376
    v_mfma_f32_16x16x32_bf16 a[28:31], v[84:87], v[60:63], a[28:31]
    ds_read_b128 v[44:47], v17 offset:38912
    v_mfma_f32_16x16x32_bf16 a[32:35], v[88:91], v[48:51], a[32:35]
    v_mfma_f32_16x16x32_bf16 a[36:39], v[88:91], v[52:55], a[36:39]
    v_mfma_f32_16x16x32_bf16 a[40:43], v[88:91], v[56:59], a[40:43]
    v_mfma_f32_16x16x32_bf16 a[44:47], v[88:91], v[60:63], a[44:47]
    v_mfma_f32_16x16x32_bf16 a[48:51], v[92:95], v[48:51], a[48:51]
    v_mfma_f32_16x16x32_bf16 a[52:55], v[92:95], v[52:55], a[52:55]
    v_mfma_f32_16x16x32_bf16 a[56:59], v[92:95], v[56:59], a[56:59]
    v_mfma_f32_16x16x32_bf16 a[60:63], v[92:95], v[60:63], a[60:63]
    s_waitcnt lgkmcnt(0)
    v_mfma_f32_16x16x32_bf16 a[0:3], v[64:67], v[32:35], a[0:3]
    ds_read_b128 v[80:83], v22 offset:32768
    v_mfma_f32_16x16x32_bf16 a[4:7], v[64:67], v[36:39], a[4:7]
    ds_read_b128 v[48:51], v18 offset:32768
    v_mfma_f32_16x16x32_bf16 a[8:11], v[64:67], v[40:43], a[8:11]
    ds_read_b128 v[84:87], v22 offset:33280
    v_mfma_f32_16x16x32_bf16 a[12:15], v[64:67], v[44:47], a[12:15]
    ds_read_b128 v[52:55], v18 offset:34816
    v_mfma_f32_16x16x32_bf16 a[16:19], v[68:71], v[32:35], a[16:19]
    ds_read_b128 v[88:91], v22 offset:36864
    v_mfma_f32_16x16x32_bf16 a[20:23], v[68:71], v[36:39], a[20:23]
    ds_read_b128 v[56:59], v18 offset:36864
    v_mfma_f32_16x16x32_bf16 a[24:27], v[68:71], v[40:43], a[24:27]
    ds_read_b128 v[92:95], v22 offset:37376
    v_mfma_f32_16x16x32_bf16 a[28:31], v[68:71], v[44:47], a[28:31]
    ds_read_b128 v[60:63], v18 offset:38912
    v_mfma_f32_16x16x32_bf16 a[32:35], v[72:75], v[32:35], a[32:35]
    v_mfma_f32_16x16x32_bf16 a[36:39], v[72:75], v[36:39], a[36:39]
    v_mfma_f32_16x16x32_bf16 a[40:43], v[72:75], v[40:43], a[40:43]
    v_mfma_f32_16x16x32_bf16 a[44:47], v[72:75], v[44:47], a[44:47]
    v_mfma_f32_16x16x32_bf16 a[48:51], v[76:79], v[32:35], a[48:51]
    v_mfma_f32_16x16x32_bf16 a[52:55], v[76:79], v[36:39], a[52:55]
    v_mfma_f32_16x16x32_bf16 a[56:59], v[76:79], v[40:43], a[56:59]
    v_mfma_f32_16x16x32_bf16 a[60:63], v[76:79], v[44:47], a[60:63]
    s_waitcnt lgkmcnt(0)
    s_barrier
    v_mfma_f32_16x16x32_bf16 a[0:3], v[80:83], v[48:51], a[0:3]
    ds_read_b128 v[64:67], v23 offset:0
    v_mfma_f32_16x16x32_bf16 a[4:7], v[80:83], v[52:55], a[4:7]
    ds_read_b128 v[32:35], v19 offset:0
    v_mfma_f32_16x16x32_bf16 a[8:11], v[80:83], v[56:59], a[8:11]
    ds_read_b128 v[68:71], v23 offset:512
    v_mfma_f32_16x16x32_bf16 a[12:15], v[80:83], v[60:63], a[12:15]
    ds_read_b128 v[36:39], v19 offset:2048
    v_mfma_f32_16x16x32_bf16 a[16:19], v[84:87], v[48:51], a[16:19]
    ds_read_b128 v[72:75], v23 offset:4096
    v_mfma_f32_16x16x32_bf16 a[20:23], v[84:87], v[52:55], a[20:23]
    ds_read_b128 v[40:43], v19 offset:4096
    v_mfma_f32_16x16x32_bf16 a[24:27], v[84:87], v[56:59], a[24:27]
    ds_read_b128 v[76:79], v23 offset:4608
    v_mfma_f32_16x16x32_bf16 a[28:31], v[84:87], v[60:63], a[28:31]
    ds_read_b128 v[44:47], v19 offset:6144
    v_mfma_f32_16x16x32_bf16 a[32:35], v[88:91], v[48:51], a[32:35]
    v_mfma_f32_16x16x32_bf16 a[36:39], v[88:91], v[52:55], a[36:39]
    v_mfma_f32_16x16x32_bf16 a[40:43], v[88:91], v[56:59], a[40:43]
    v_mfma_f32_16x16x32_bf16 a[44:47], v[88:91], v[60:63], a[44:47]
    v_mfma_f32_16x16x32_bf16 a[48:51], v[92:95], v[48:51], a[48:51]
    v_mfma_f32_16x16x32_bf16 a[52:55], v[92:95], v[52:55], a[52:55]
    v_mfma_f32_16x16x32_bf16 a[56:59], v[92:95], v[56:59], a[56:59]
    v_mfma_f32_16x16x32_bf16 a[60:63], v[92:95], v[60:63], a[60:63]
    s_waitcnt lgkmcnt(0)
    v_mfma_f32_16x16x32_bf16 a[0:3], v[64:67], v[32:35], a[0:3]
    ds_read_b128 v[80:83], v24 offset:0
    v_mfma_f32_16x16x32_bf16 a[4:7], v[64:67], v[36:39], a[4:7]
    ds_read_b128 v[48:51], v20 offset:0
    v_mfma_f32_16x16x32_bf16 a[8:11], v[64:67], v[40:43], a[8:11]
    ds_read_b128 v[84:87], v24 offset:512
    v_mfma_f32_16x16x32_bf16 a[12:15], v[64:67], v[44:47], a[12:15]
    ds_read_b128 v[52:55], v20 offset:2048
    v_mfma_f32_16x16x32_bf16 a[16:19], v[68:71], v[32:35], a[16:19]
    ds_read_b128 v[88:91], v24 offset:4096
    v_mfma_f32_16x16x32_bf16 a[20:23], v[68:71], v[36:39], a[20:23]
    ds_read_b128 v[56:59], v20 offset:4096
    v_mfma_f32_16x16x32_bf16 a[24:27], v[68:71], v[40:43], a[24:27]
    ds_read_b128 v[92:95], v24 offset:4608
    v_mfma_f32_16x16x32_bf16 a[28:31], v[68:71], v[44:47], a[28:31]
    ds_read_b128 v[60:63], v20 offset:6144
    v_mfma_f32_16x16x32_bf16 a[32:35], v[72:75], v[32:35], a[32:35]
    v_mfma_f32_16x16x32_bf16 a[36:39], v[72:75], v[36:39], a[36:39]
    v_mfma_f32_16x16x32_bf16 a[40:43], v[72:75], v[40:43], a[40:43]
    v_mfma_f32_16x16x32_bf16 a[44:47], v[72:75], v[44:47], a[44:47]
    v_mfma_f32_16x16x32_bf16 a[48:51], v[76:79], v[32:35], a[48:51]
    v_mfma_f32_16x16x32_bf16 a[52:55], v[76:79], v[36:39], a[52:55]
    v_mfma_f32_16x16x32_bf16 a[56:59], v[76:79], v[40:43], a[56:59]
    v_mfma_f32_16x16x32_bf16 a[60:63], v[76:79], v[44:47], a[60:63]
    s_waitcnt lgkmcnt(0)
    s_barrier
    v_mfma_f32_16x16x32_bf16 a[0:3], v[80:83], v[48:51], a[0:3]
    ds_read_b128 v[64:67], v23 offset:32768
    v_mfma_f32_16x16x32_bf16 a[4:7], v[80:83], v[52:55], a[4:7]
    ds_read_b128 v[32:35], v19 offset:32768
    v_mfma_f32_16x16x32_bf16 a[8:11], v[80:83], v[56:59], a[8:11]
    ds_read_b128 v[68:71], v23 offset:33280
    v_mfma_f32_16x16x32_bf16 a[12:15], v[80:83], v[60:63], a[12:15]
    ds_read_b128 v[36:39], v19 offset:34816
    v_mfma_f32_16x16x32_bf16 a[16:19], v[84:87], v[48:51], a[16:19]
    ds_read_b128 v[72:75], v23 offset:36864
    v_mfma_f32_16x16x32_bf16 a[20:23], v[84:87], v[52:55], a[20:23]
    ds_read_b128 v[40:43], v19 offset:36864
    v_mfma_f32_16x16x32_bf16 a[24:27], v[84:87], v[56:59], a[24:27]
    ds_read_b128 v[76:79], v23 offset:37376
    v_mfma_f32_16x16x32_bf16 a[28:31], v[84:87], v[60:63], a[28:31]
    ds_read_b128 v[44:47], v19 offset:38912
    v_mfma_f32_16x16x32_bf16 a[32:35], v[88:91], v[48:51], a[32:35]
    v_mfma_f32_16x16x32_bf16 a[36:39], v[88:91], v[52:55], a[36:39]
    v_mfma_f32_16x16x32_bf16 a[40:43], v[88:91], v[56:59], a[40:43]
    v_mfma_f32_16x16x32_bf16 a[44:47], v[88:91], v[60:63], a[44:47]
    v_mfma_f32_16x16x32_bf16 a[48:51], v[92:95], v[48:51], a[48:51]
    v_mfma_f32_16x16x32_bf16 a[52:55], v[92:95], v[52:55], a[52:55]
    v_mfma_f32_16x16x32_bf16 a[56:59], v[92:95], v[56:59], a[56:59]
    v_mfma_f32_16x16x32_bf16 a[60:63], v[92:95], v[60:63], a[60:63]
    s_waitcnt lgkmcnt(0)
    v_mfma_f32_16x16x32_bf16 a[0:3], v[64:67], v[32:35], a[0:3]
    ds_read_b128 v[80:83], v24 offset:32768
    v_mfma_f32_16x16x32_bf16 a[4:7], v[64:67], v[36:39], a[4:7]
    ds_read_b128 v[48:51], v20 offset:32768
    v_mfma_f32_16x16x32_bf16 a[8:11], v[64:67], v[40:43], a[8:11]
    ds_read_b128 v[84:87], v24 offset:33280
    v_mfma_f32_16x16x32_bf16 a[12:15], v[64:67], v[44:47], a[12:15]
    ds_read_b128 v[52:55], v20 offset:34816
    v_mfma_f32_16x16x32_bf16 a[16:19], v[68:71], v[32:35], a[16:19]
    ds_read_b128 v[88:91], v24 offset:36864
    v_mfma_f32_16x16x32_bf16 a[20:23], v[68:71], v[36:39], a[20:23]
    ds_read_b128 v[56:59], v20 offset:36864
    v_mfma_f32_16x16x32_bf16 a[24:27], v[68:71], v[40:43], a[24:27]
    ds_read_b128 v[92:95], v24 offset:37376
    v_mfma_f32_16x16x32_bf16 a[28:31], v[68:71], v[44:47], a[28:31]
    ds_read_b128 v[60:63], v20 offset:38912
    v_mfma_f32_16x16x32_bf16 a[32:35], v[72:75], v[32:35], a[32:35]
    v_mfma_f32_16x16x32_bf16 a[36:39], v[72:75], v[36:39], a[36:39]
    v_mfma_f32_16x16x32_bf16 a[40:43], v[72:75], v[40:43], a[40:43]
    v_mfma_f32_16x16x32_bf16 a[44:47], v[72:75], v[44:47], a[44:47]
    v_mfma_f32_16x16x32_bf16 a[48:51], v[76:79], v[32:35], a[48:51]
    v_mfma_f32_16x16x32_bf16 a[52:55], v[76:79], v[36:39], a[52:55]
    v_mfma_f32_16x16x32_bf16 a[56:59], v[76:79], v[40:43], a[56:59]
    v_mfma_f32_16x16x32_bf16 a[60:63], v[76:79], v[44:47], a[60:63]
    s_waitcnt lgkmcnt(0)
    s_barrier
    v_mfma_f32_16x16x32_bf16 a[0:3], v[80:83], v[48:51], a[0:3]
    ds_read_b128 v[64:67], v21 offset:0
    v_mfma_f32_16x16x32_bf16 a[4:7], v[80:83], v[52:55], a[4:7]
    ds_read_b128 v[32:35], v17 offset:0
    v_mfma_f32_16x16x32_bf16 a[8:11], v[80:83], v[56:59], a[8:11]
    ds_read_b128 v[68:71], v21 offset:512
    v_mfma_f32_16x16x32_bf16 a[12:15], v[80:83], v[60:63], a[12:15]
    ds_read_b128 v[36:39], v17 offset:2048
    v_mfma_f32_16x16x32_bf16 a[16:19], v[84:87], v[48:51], a[16:19]
    ds_read_b128 v[72:75], v21 offset:4096
    v_mfma_f32_16x16x32_bf16 a[20:23], v[84:87], v[52:55], a[20:23]
    ds_read_b128 v[40:43], v17 offset:4096
    v_mfma_f32_16x16x32_bf16 a[24:27], v[84:87], v[56:59], a[24:27]
    ds_read_b128 v[76:79], v21 offset:4608
    v_mfma_f32_16x16x32_bf16 a[28:31], v[84:87], v[60:63], a[28:31]
    ds_read_b128 v[44:47], v17 offset:6144
    v_mfma_f32_16x16x32_bf16 a[32:35], v[88:91], v[48:51], a[32:35]
    v_mfma_f32_16x16x32_bf16 a[36:39], v[88:91], v[52:55], a[36:39]
    v_mfma_f32_16x16x32_bf16 a[40:43], v[88:91], v[56:59], a[40:43]
    v_mfma_f32_16x16x32_bf16 a[44:47], v[88:91], v[60:63], a[44:47]
    v_mfma_f32_16x16x32_bf16 a[48:51], v[92:95], v[48:51], a[48:51]
    v_mfma_f32_16x16x32_bf16 a[52:55], v[92:95], v[52:55], a[52:55]
    v_mfma_f32_16x16x32_bf16 a[56:59], v[92:95], v[56:59], a[56:59]
    v_mfma_f32_16x16x32_bf16 a[60:63], v[92:95], v[60:63], a[60:63]
    s_sub_u32 s28, s28, 1
    s_cmp_lg_u32 s28, 0
    s_cbranch_scc1 gemm_a2_kernel_loop
    s_waitcnt lgkmcnt(0)
    v_mfma_f32_16x16x32_bf16 a[0:3], v[64:67], v[32:35], a[0:3]
    ds_read_b128 v[80:83], v22 offset:0
    v_mfma_f32_16x16x32_bf16 a[4:7], v[64:67], v[36:39], a[4:7]
    ds_read_b128 v[48:51], v18 offset:0
    v_mfma_f32_16x16x32_bf16 a[8:11], v[64:67], v[40:43], a[8:11]
    ds_read_b128 v[84:87], v22 offset:512
    v_mfma_f32_16x16x32_bf16 a[12:15], v[64:67], v[44:47], a[12:15]
    ds_read_b128 v[52:55], v18 offset:2048
    v_mfma_f32_16x16x32_bf16 a[16:19], v[68:71], v[32:35], a[16:19]
    ds_read_b128 v[88:91], v22 offset:4096
    v_mfma_f32_16x16x32_bf16 a[20:23], v[68:71], v[36:39], a[20:23]
    ds_read_b128 v[56:59], v18 offset:4096
    v_mfma_f32_16x16x32_bf16 a[24:27], v[68:71], v[40:43], a[24:27]
    ds_read_b128 v[92:95], v22 offset:4608
    v_mfma_f32_16x16x32_bf16 a[28:31], v[68:71], v[44:47], a[28:31]
    ds_read_b128 v[60:63], v18 offset:6144
    v_mfma_f32_16x16x32_bf16 a[32:35], v[72:75], v[32:35], a[32:35]
    v_mfma_f32_16x16x32_bf16 a[36:39], v[72:75], v[36:39], a[36:39]
    v_mfma_f32_16x16x32_bf16 a[40:43], v[72:75], v[40:43], a[40:43]
    v_mfma_f32_16x16x32_bf16 a[44:47], v[72:75], v[44:47], a[44:47]
    v_mfma_f32_16x16x32_bf16 a[48:51], v[76:79], v[32:35], a[48:51]
    v_mfma_f32_16x16x32_bf16 a[52:55], v[76:79], v[36:39], a[52:55]
    v_mfma_f32_16x16x32_bf16 a[56:59], v[76:79], v[40:43], a[56:59]
    v_mfma_f32_16x16x32_bf16 a[60:63], v[76:79], v[44:47], a[60:63]
    s_waitcnt lgkmcnt(0)
    s_barrier
    v_mfma_f32_16x16x32_bf16 a[0:3], v[80:83], v[48:51], a[0:3]
    ds_read_b128 v[64:67], v21 offset:32768
    v_mfma_f32_16x16x32_bf16 a[4:7], v[80:83], v[52:55], a[4:7]
    ds_read_b128 v[32:35], v17 offset:32768
    v_mfma_f32_16x16x32_bf16 a[8:11], v[80:83], v[56:59], a[8:11]
    ds_read_b128 v[68:71], v21 offset:33280
    v_mfma_f32_16x16x32_bf16 a[12:15], v[80:83], v[60:63], a[12:15]
    ds_read_b128 v[36:39], v17 offset:34816
    v_mfma_f32_16x16x32_bf16 a[16:19], v[84:87], v[48:51], a[16:19]
    ds_read_b128 v[72:75], v21 offset:36864
    v_mfma_f32_16x16x32_bf16 a[20:23], v[84:87], v[52:55], a[20:23]
    ds_read_b128 v[40:43], v17 offset:36864
    v_mfma_f32_16x16x32_bf16 a[24:27], v[84:87], v[56:59], a[24:27]
    ds_read_b128 v[76:79], v21 offset:37376
    v_mfma_f32_16x16x32_bf16 a[28:31], v[84:87], v[60:63], a[28:31]
    ds_read_b128 v[44:47], v17 offset:38912
    v_mfma_f32_16x16x32_bf16 a[32:35], v[88:91], v[48:51], a[32:35]
    v_mfma_f32_16x16x32_bf16 a[36:39], v[88:91], v[52:55], a[36:39]
    v_mfma_f32_16x16x32_bf16 a[40:43], v[88:91], v[56:59], a[40:43]
    v_mfma_f32_16x16x32_bf16 a[44:47], v[88:91], v[60:63], a[44:47]
    v_mfma_f32_16x16x32_bf16 a[48:51], v[92:95], v[48:51], a[48:51]
    v_mfma_f32_16x16x32_bf16 a[52:55], v[92:95], v[52:55], a[52:55]
    v_mfma_f32_16x16x32_bf16 a[56:59], v[92:95], v[56:59], a[56:59]
    v_mfma_f32_16x16x32_bf16 a[60:63], v[92:95], v[60:63], a[60:63]
    s_waitcnt lgkmcnt(0)
    v_mfma_f32_16x16x32_bf16 a[0:3], v[64:67], v[32:35], a[0:3]
    ds_read_b128 v[80:83], v22 offset:32768
    v_mfma_f32_16x16x32_bf16 a[4:7], v[64:67], v[36:39], a[4:7]
    ds_read_b128 v[48:51], v18 offset:32768
    v_mfma_f32_16x16x32_bf16 a[8:11], v[64:67], v[40:43], a[8:11]
    ds_read_b128 v[84:87], v22 offset:33280
    v_mfma_f32_16x16x32_bf16 a[12:15], v[64:67], v[44:47], a[12:15]
    ds_read_b128 v[52:55], v18 offset:34816
    v_mfma_f32_16x16x32_bf16 a[16:19], v[68:71], v[32:35], a[16:19]
    ds_read_b128 v[88:91], v22 offset:36864
    v_mfma_f32_16x16x32_bf16 a[20:23], v[68:71], v[36:39], a[20:23]
    ds_read_b128 v[56:59], v18 offset:36864
    v_mfma_f32_16x16x32_bf16 a[24:27], v[68:71], v[40:43], a[24:27]
    ds_read_b128 v[92:95], v22 offset:37376
    v_mfma_f32_16x16x32_bf16 a[28:31], v[68:71], v[44:47], a[28:31]
    ds_read_b128 v[60:63], v18 offset:38912
    v_mfma_f32_16x16x32_bf16 a[32:35], v[72:75], v[32:35], a[32:35]
    v_mfma_f32_16x16x32_bf16 a[36:39], v[72:75], v[36:39], a[36:39]
    v_mfma_f32_16x16x32_bf16 a[40:43], v[72:75], v[40:43], a[40:43]
    v_mfma_f32_16x16x32_bf16 a[44:47], v[72:75], v[44:47], a[44:47]
    v_mfma_f32_16x16x32_bf16 a[48:51], v[76:79], v[32:35], a[48:51]
    v_mfma_f32_16x16x32_bf16 a[52:55], v[76:79], v[36:39], a[52:55]
    v_mfma_f32_16x16x32_bf16 a[56:59], v[76:79], v[40:43], a[56:59]
    v_mfma_f32_16x16x32_bf16 a[60:63], v[76:79], v[44:47], a[60:63]
    s_waitcnt lgkmcnt(0)
    s_barrier
    v_mfma_f32_16x16x32_bf16 a[0:3], v[80:83], v[48:51], a[0:3]
    ds_read_b128 v[64:67], v23 offset:0
    v_mfma_f32_16x16x32_bf16 a[4:7], v[80:83], v[52:55], a[4:7]
    ds_read_b128 v[32:35], v19 offset:0
    v_mfma_f32_16x16x32_bf16 a[8:11], v[80:83], v[56:59], a[8:11]
    ds_read_b128 v[68:71], v23 offset:512
    v_mfma_f32_16x16x32_bf16 a[12:15], v[80:83], v[60:63], a[12:15]
    ds_read_b128 v[36:39], v19 offset:2048
    v_mfma_f32_16x16x32_bf16 a[16:19], v[84:87], v[48:51], a[16:19]
    ds_read_b128 v[72:75], v23 offset:4096
    v_mfma_f32_16x16x32_bf16 a[20:23], v[84:87], v[52:55], a[20:23]
    ds_read_b128 v[40:43], v19 offset:4096
    v_mfma_f32_16x16x32_bf16 a[24:27], v[84:87], v[56:59], a[24:27]
    ds_read_b128 v[76:79], v23 offset:4608
    v_mfma_f32_16x16x32_bf16 a[28:31], v[84:87], v[60:63], a[28:31]
    ds_read_b128 v[44:47], v19 offset:6144
    v_mfma_f32_16x16x32_bf16 a[32:35], v[88:91], v[48:51], a[32:35]
    v_mfma_f32_16x16x32_bf16 a[36:39], v[88:91], v[52:55], a[36:39]
    v_mfma_f32_16x16x32_bf16 a[40:43], v[88:91], v[56:59], a[40:43]
    v_mfma_f32_16x16x32_bf16 a[44:47], v[88:91], v[60:63], a[44:47]
    v_mfma_f32_16x16x32_bf16 a[48:51], v[92:95], v[48:51], a[48:51]
    v_mfma_f32_16x16x32_bf16 a[52:55], v[92:95], v[52:55], a[52:55]
    v_mfma_f32_16x16x32_bf16 a[56:59], v[92:95], v[56:59], a[56:59]
    v_mfma_f32_16x16x32_bf16 a[60:63], v[92:95], v[60:63], a[60:63]
    s_waitcnt lgkmcnt(0)
    v_mfma_f32_16x16x32_bf16 a[0:3], v[64:67], v[32:35], a[0:3]
    ds_read_b128 v[80:83], v24 offset:0
    v_mfma_f32_16x16x32_bf16 a[4:7], v[64:67], v[36:39], a[4:7]
    ds_read_b128 v[48:51], v20 offset:0
    v_mfma_f32_16x16x32_bf16 a[8:11], v[64:67], v[40:43], a[8:11]
    ds_read_b128 v[84:87], v24 offset:512
    v_mfma_f32_16x16x32_bf16 a[12:15], v[64:67], v[44:47], a[12:15]
    ds_read_b128 v[52:55], v20 offset:2048
    v_mfma_f32_16x16x32_bf16 a[16:19], v[68:71], v[32:35], a[16:19]
    ds_read_b128 v[88:91], v24 offset:4096
    v_mfma_f32_16x16x32_bf16 a[20:23], v[68:71], v[36:39], a[20:23]
    ds_read_b128 v[56:59], v20 offset:4096
    v_mfma_f32_16x16x32_bf16 a[24:27], v[68:71], v[40:43], a[24:27]
    ds_read_b128 v[92:95], v24 offset:4608
    v_mfma_f32_16x16x32_bf16 a[28:31], v[68:71], v[44:47], a[28:31]
    ds_read_b128 v[60:63], v20 offset:6144
    v_mfma_f32_16x16x32_bf16 a[32:35], v[72:75], v[32:35], a[32:35]
    v_mfma_f32_16x16x32_bf16 a[36:39], v[72:75], v[36:39], a[36:39]
    v_mfma_f32_16x16x32_bf16 a[40:43], v[72:75], v[40:43], a[40:43]
    v_mfma_f32_16x16x32_bf16 a[44:47], v[72:75], v[44:47], a[44:47]
    v_mfma_f32_16x16x32_bf16 a[48:51], v[76:79], v[32:35], a[48:51]
    v_mfma_f32_16x16x32_bf16 a[52:55], v[76:79], v[36:39], a[52:55]
    v_mfma_f32_16x16x32_bf16 a[56:59], v[76:79], v[40:43], a[56:59]
    v_mfma_f32_16x16x32_bf16 a[60:63], v[76:79], v[44:47], a[60:63]
    s_waitcnt lgkmcnt(0)
    s_barrier
    v_mfma_f32_16x16x32_bf16 a[0:3], v[80:83], v[48:51], a[0:3]
    ds_read_b128 v[64:67], v23 offset:32768
    v_mfma_f32_16x16x32_bf16 a[4:7], v[80:83], v[52:55], a[4:7]
    ds_read_b128 v[32:35], v19 offset:32768
    v_mfma_f32_16x16x32_bf16 a[8:11], v[80:83], v[56:59], a[8:11]
    ds_read_b128 v[68:71], v23 offset:33280
    v_mfma_f32_16x16x32_bf16 a[12:15], v[80:83], v[60:63], a[12:15]
    ds_read_b128 v[36:39], v19 offset:34816
    v_mfma_f32_16x16x32_bf16 a[16:19], v[84:87], v[48:51], a[16:19]
    ds_read_b128 v[72:75], v23 offset:36864
    v_mfma_f32_16x16x32_bf16 a[20:23], v[84:87], v[52:55], a[20:23]
    ds_read_b128 v[40:43], v19 offset:36864
    v_mfma_f32_16x16x32_bf16 a[24:27], v[84:87], v[56:59], a[24:27]
    ds_read_b128 v[76:79], v23 offset:37376
    v_mfma_f32_16x16x32_bf16 a[28:31], v[84:87], v[60:63], a[28:31]
    ds_read_b128 v[44:47], v19 offset:38912
    v_mfma_f32_16x16x32_bf16 a[32:35], v[88:91], v[48:51], a[32:35]
    v_mfma_f32_16x16x32_bf16 a[36:39], v[88:91], v[52:55], a[36:39]
    v_mfma_f32_16x16x32_bf16 a[40:43], v[88:91], v[56:59], a[40:43]
    v_mfma_f32_16x16x32_bf16 a[44:47], v[88:91], v[60:63], a[44:47]
    v_mfma_f32_16x16x32_bf16 a[48:51], v[92:95], v[48:51], a[48:51]
    v_mfma_f32_16x16x32_bf16 a[52:55], v[92:95], v[52:55], a[52:55]
    v_mfma_f32_16x16x32_bf16 a[56:59], v[92:95], v[56:59], a[56:59]
    v_mfma_f32_16x16x32_bf16 a[60:63], v[92:95], v[60:63], a[60:63]
    s_waitcnt lgkmcnt(0)
    v_mfma_f32_16x16x32_bf16 a[0:3], v[64:67], v[32:35], a[0:3]
    ds_read_b128 v[80:83], v24 offset:32768
    v_mfma_f32_16x16x32_bf16 a[4:7], v[64:67], v[36:39], a[4:7]
    ds_read_b128 v[48:51], v20 offset:32768
    v_mfma_f32_16x16x32_bf16 a[8:11], v[64:67], v[40:43], a[8:11]
    ds_read_b128 v[84:87], v24 offset:33280
    v_mfma_f32_16x16x32_bf16 a[12:15], v[64:67], v[44:47], a[12:15]
    ds_read_b128 v[52:55], v20 offset:34816
    v_mfma_f32_16x16x32_bf16 a[16:19], v[68:71], v[32:35], a[16:19]
    ds_read_b128 v[88:91], v24 offset:36864
    v_mfma_f32_16x16x32_bf16 a[20:23], v[68:71], v[36:39], a[20:23]
    ds_read_b128 v[56:59], v20 offset:36864
    v_mfma_f32_16x16x32_bf16 a[24:27], v[68:71], v[40:43], a[24:27]
    ds_read_b128 v[92:95], v24 offset:37376
    v_mfma_f32_16x16x32_bf16 a[28:31], v[68:71], v[44:47], a[28:31]
    ds_read_b128 v[60:63], v20 offset:38912
    v_mfma_f32_16x16x32_bf16 a[32:35], v[72:75], v[32:35], a[32:35]
    v_mfma_f32_16x16x32_bf16 a[36:39], v[72:75], v[36:39], a[36:39]
    v_mfma_f32_16x16x32_bf16 a[40:43], v[72:75], v[40:43], a[40:43]
    v_mfma_f32_16x16x32_bf16 a[44:47], v[72:75], v[44:47], a[44:47]
    v_mfma_f32_16x16x32_bf16 a[48:51], v[76:79], v[32:35], a[48:51]
    v_mfma_f32_16x16x32_bf16 a[52:55], v[76:79], v[36:39], a[52:55]
    v_mfma_f32_16x16x32_bf16 a[56:59], v[76:79], v[40:43], a[56:59]
    v_mfma_f32_16x16x32_bf16 a[60:63], v[76:79], v[44:47], a[60:63]
    s_waitcnt lgkmcnt(0)
    v_mfma_f32_16x16x32_bf16 a[0:3], v[80:83], v[48:51], a[0:3]
    v_mfma_f32_16x16x32_bf16 a[4:7], v[80:83], v[52:55], a[4:7]
    v_mfma_f32_16x16x32_bf16 a[8:11], v[80:83], v[56:59], a[8:11]
    v_mfma_f32_16x16x32_bf16 a[12:15], v[80:83], v[60:63], a[12:15]
    v_mfma_f32_16x16x32_bf16 a[16:19], v[84:87], v[48:51], a[16:19]
    v_mfma_f32_16x16x32_bf16 a[20:23], v[84:87], v[52:55], a[20:23]
    v_mfma_f32_16x16x32_bf16 a[24:27], v[84:87], v[56:59], a[24:27]
    v_mfma_f32_16x16x32_bf16 a[28:31], v[84:87], v[60:63], a[28:31]
    v_mfma_f32_16x16x32_bf16 a[32:35], v[88:91], v[48:51], a[32:35]
    v_mfma_f32_16x16x32_bf16 a[36:39], v[88:91], v[52:55], a[36:39]
    v_mfma_f32_16x16x32_bf16 a[40:43], v[88:91], v[56:59], a[40:43]
    v_mfma_f32_16x16x32_bf16 a[44:47], v[88:91], v[60:63], a[44:47]
    v_mfma_f32_16x16x32_bf16 a[48:51], v[92:95], v[48:51], a[48:51]
    v_mfma_f32_16x16x32_bf16 a[52:55], v[92:95], v[52:55], a[52:55]
    v_mfma_f32_16x16x32_bf16 a[56:59], v[92:95], v[56:59], a[56:59]
    v_mfma_f32_16x16x32_bf16 a[60:63], v[92:95], v[60:63], a[60:63]
    s_nop 15
    s_nop 7
    v_accvgpr_read_b32 v32, a0
    v_accvgpr_read_b32 v36, a16
    v_accvgpr_read_b32 v33, a1
    v_accvgpr_read_b32 v37, a17
    v_accvgpr_read_b32 v34, a2
    v_accvgpr_read_b32 v38, a18
    v_accvgpr_read_b32 v35, a3
    v_accvgpr_read_b32 v39, a19
    v_cvt_pk_bf16_f32 v40, v32, v33
    v_cvt_pk_bf16_f32 v41, v34, v35
    v_cvt_pk_bf16_f32 v42, v36, v37
    v_cvt_pk_bf16_f32 v43, v38, v39
    s_mov_b32 s29, 0
    buffer_store_dwordx4 v[40:43], v26, s[16:19], s29 offen
    v_accvgpr_read_b32 v48, a32
    v_accvgpr_read_b32 v52, a48
    v_accvgpr_read_b32 v49, a33
    v_accvgpr_read_b32 v53, a49
    v_accvgpr_read_b32 v50, a34
    v_accvgpr_read_b32 v54, a50
    v_accvgpr_read_b32 v51, a35
    v_accvgpr_read_b32 v55, a51
    v_cvt_pk_bf16_f32 v56, v48, v49
    v_cvt_pk_bf16_f32 v57, v50, v51
    v_cvt_pk_bf16_f32 v58, v52, v53
    v_cvt_pk_bf16_f32 v59, v54, v55
    s_mov_b32 s29, 64
    buffer_store_dwordx4 v[56:59], v26, s[16:19], s29 offen
    v_accvgpr_read_b32 v64, a4
    v_accvgpr_read_b32 v68, a20
    v_accvgpr_read_b32 v65, a5
    v_accvgpr_read_b32 v69, a21
    v_accvgpr_read_b32 v66, a6
    v_accvgpr_read_b32 v70, a22
    v_accvgpr_read_b32 v67, a7
    v_accvgpr_read_b32 v71, a23
    v_cvt_pk_bf16_f32 v72, v64, v65
    v_cvt_pk_bf16_f32 v73, v66, v67
    v_cvt_pk_bf16_f32 v74, v68, v69
    v_cvt_pk_bf16_f32 v75, v70, v71
    s_mov_b32 s29, 32768
    buffer_store_dwordx4 v[72:75], v26, s[16:19], s29 offen
    v_accvgpr_read_b32 v80, a36
    v_accvgpr_read_b32 v84, a52
    v_accvgpr_read_b32 v81, a37
    v_accvgpr_read_b32 v85, a53
    v_accvgpr_read_b32 v82, a38
    v_accvgpr_read_b32 v86, a54
    v_accvgpr_read_b32 v83, a39
    v_accvgpr_read_b32 v87, a55
    v_cvt_pk_bf16_f32 v88, v80, v81
    v_cvt_pk_bf16_f32 v89, v82, v83
    v_cvt_pk_bf16_f32 v90, v84, v85
    v_cvt_pk_bf16_f32 v91, v86, v87
    s_mov_b32 s29, 32832
    buffer_store_dwordx4 v[88:91], v26, s[16:19], s29 offen
    v_accvgpr_read_b32 v32, a8
    v_accvgpr_read_b32 v36, a24
    v_accvgpr_read_b32 v33, a9
    v_accvgpr_read_b32 v37, a25
    v_accvgpr_read_b32 v34, a10
    v_accvgpr_read_b32 v38, a26
    v_accvgpr_read_b32 v35, a11
    v_accvgpr_read_b32 v39, a27
    v_cvt_pk_bf16_f32 v40, v32, v33
    v_cvt_pk_bf16_f32 v41, v34, v35
    v_cvt_pk_bf16_f32 v42, v36, v37
    v_cvt_pk_bf16_f32 v43, v38, v39
    s_mov_b32 s29, 65536
    buffer_store_dwordx4 v[40:43], v26, s[16:19], s29 offen
    v_accvgpr_read_b32 v48, a40
    v_accvgpr_read_b32 v52, a56
    v_accvgpr_read_b32 v49, a41
    v_accvgpr_read_b32 v53, a57
    v_accvgpr_read_b32 v50, a42
    v_accvgpr_read_b32 v54, a58
    v_accvgpr_read_b32 v51, a43
    v_accvgpr_read_b32 v55, a59
    v_cvt_pk_bf16_f32 v56, v48, v49
    v_cvt_pk_bf16_f32 v57, v50, v51
    v_cvt_pk_bf16_f32 v58, v52, v53
    v_cvt_pk_bf16_f32 v59, v54, v55
    s_mov_b32 s29, 65600
    buffer_store_dwordx4 v[56:59], v26, s[16:19], s29 offen
    v_accvgpr_read_b32 v64, a12
    v_accvgpr_read_b32 v68, a28
    v_accvgpr_read_b32 v65, a13
    v_accvgpr_read_b32 v69, a29
    v_accvgpr_read_b32 v66, a14
    v_accvgpr_read_b32 v70, a30
    v_accvgpr_read_b32 v67, a15
    v_accvgpr_read_b32 v71, a31
    v_cvt_pk_bf16_f32 v72, v64, v65
    v_cvt_pk_bf16_f32 v73, v66, v67
    v_cvt_pk_bf16_f32 v74, v68, v69
    v_cvt_pk_bf16_f32 v75, v70, v71
    s_mov_b32 s29, 98304
    buffer_store_dwordx4 v[72:75], v26, s[16:19], s29 offen
    v_accvgpr_read_b32 v80, a44
    v_accvgpr_read_b32 v84, a60
    v_accvgpr_read_b32 v81, a45
    v_accvgpr_read_b32 v85, a61
    v_accvgpr_read_b32 v82, a46
    v_accvgpr_read_b32 v86, a62
    v_accvgpr_read_b32 v83, a47
    v_accvgpr_read_b32 v87, a63
    v_cvt_pk_bf16_f32 v88, v80, v81
    v_cvt_pk_bf16_f32 v89, v82, v83
    v_cvt_pk_bf16_f32 v90, v84, v85
    v_cvt_pk_bf16_f32 v91, v86, v87
    s_mov_b32 s29, 98368
    buffer_store_dwordx4 v[88:91], v26, s[16:19], s29 offen
gemm_a2_kernel_end:
    s_endpgm
.section .rodata,"a"
.p2align 6
.amdhsa_kernel gemm_a2_kernel
  .amdhsa_next_free_vgpr 160
  .amdhsa_next_free_sgpr 48
  .amdhsa_accum_offset 96
  .amdhsa_group_segment_fixed_size 0
  .amdhsa_kernarg_size 96
  .amdhsa_user_sgpr_count 2
  .amdhsa_user_sgpr_kernarg_segment_ptr 1
  .amdhsa_system_sgpr_workgroup_id_x 1
  .amdhsa_float_denorm_mode_32 3
  .amdhsa_float_denorm_mode_16_64 3
.end_amdhsa_kernel

.text
.globl gemm_b1_kernel
.p2align 8
.type gemm_b1_kernel,@function
gemm_b1_kernel:
    s_cmp_ge_u32 s2, 256
    s_cbranch_scc1 gemm_b1_kernel_end
    s_load_dwordx2 s[36:37], s[0:1], 88
    s_load_dwordx2 s[4:5], s[0:1], 48
    s_load_dwordx2 s[6:7], s[0:1], 56
    s_and_b32 s31, s2, 7
    s_lshr_b32 s34, s2, 3
    s_waitcnt lgkmcnt(0)
    s_and_b32 s29, s31, 1
    s_lshl_b32 s29, s29, 2
    s_and_b32 s30, s34, 3
    s_add_u32 s20, s29, s30
    s_lshr_b32 s29, s31, 1
    s_lshl_b32 s29, s29, 3
    s_lshr_b32 s30, s34, 2
    s_add_u32 s21, s29, s30
    s_mov_b32 s38, s36
    s_mov_b32 s39, s37
    s_mul_i32 s29, s20, 524288
    s_add_u32 s8, s38, s29
    s_addc_u32 s9, s39, 0
    s_sub_u32 s10, 4194304, s29
    s_mov_b32 s11, 0x20000
    s_mul_i32 s29, s21, 224
    s_add_u32 s12, s4, s29
    s_addc_u32 s13, s5, 0
    s_sub_u32 s14, 7340032, s29
    s_mov_b32 s15, 0x20000
    s_add_u32 s44, s6, s29
    s_addc_u32 s45, s7, 0
    s_sub_u32 s46, 7340032, s29
    s_mov_b32 s47, 0x20000
    s_add_u32 s38, s36, 25165824
    s_addc_u32 s39, s37, 0
    s_mul_i32 s29, s20, 1835008
    s_mul_i32 s30, s21, 224
    s_add_u32 s29, s29, s30
    s_add_u32 s16, s38, s29
    s_addc_u32 s17, s39, 0
    s_sub_u32 s18, 14680064, s29
    s_mov_b32 s19, 0x20000
    v_and_b32 v1, 63, v0
    v_lshrrev_b32 v2, 6, v0
    s_nop 0
    v_readfirstlane_b32 s24, v2
    v_lshrrev_b32 v3, 3, v1
    v_and_b32 v4, 7, v1
    v_mul_u32_u24 v5, 32, v2
    v_add_u32 v5, v5, v3
    v_and_b32 v6, 3, v5
    v_lshrrev_b32 v7, 1, v5
    v_and_or_b32 v6, v7, 4, v6
    v_xor_b32 v6, v6, v4
    v_lshlrev_b32 v6, 4, v6
    v_mul_u32_u24 v9, 2048, v5
    v_add_u32 v9, v9, v6
    v_mul_u32_u24 v5, 32, v2
    v_add_u32 v5, v5, v3
    v_add_u32 v5, 8, v5
    v_and_b32 v6, 3, v5
    v_lshrrev_b32 v7, 1, v5
    v_and_or_b32 v6, v7, 4, v6
    v_xor_b32 v6, v6, v4
    v_lshlrev_b32 v6, 4, v6
    v_mul_u32_u24 v10, 2048, v5
    v_add_u32 v10, v10, v6
    v_mul_u32_u24 v5, 32, v2
    v_add_u32 v5, v5, v3
    v_add_u32 v5, 16, v5
    v_and_b32 v6, 3, v5
    v_lshrrev_b32 v7, 1, v5
    v_and_or_b32 v6, v7, 4, v6
    v_xor_b32 v6, v6, v4
    v_lshlrev_b32 v6, 4, v6
    v_mul_u32_u24 v11, 2048, v5
    v_add_u32 v11, v11, v6
    v_mul_u32_u24 v5, 32, v2
    v_add_u32 v5, v5, v3
    v_add_u32 v5, 24, v5
    v_and_b32 v6, 3, v5
    v_lshrrev_b32 v7, 1, v5
    v_and_or_b32 v6, v7, 4, v6
    v_xor_b32 v6, v6, v4
    v_lshlrev_b32 v6, 4, v6
    v_mul_u32_u24 v12, 2048, v5
    v_add_u32 v12, v12, v6
    v_lshrrev_b32 v3, 4, v1
    v_and_b32 v4, 15, v1
    v_mul_u32_u24 v5, 8, v2
    v_add_u32 v5, v5, v3
    v_and_b32 v6, 3, v5
    v_lshrrev_b32 v7, 1, v5
    v_and_or_b32 v6, v7, 4, v6
    v_lshlrev_b32 v6, 1, v6
    v_xor_b32 v6, v6, v4
    v_lshlrev_b32 v6, 4, v6
    v_mul_u32_u24 v13, 7168, v5
    v_add_u32 v13, v13, v6
    v_mul_u32_u24 v5, 8, v2
    v_add_u32 v5, v5, v3
    v_add_u32 v5, 4, v5
    v_and_b32 v6, 3, v5
    v_lshrrev_b32 v7, 1, v5
    v_and_or_b32 v6, v7, 4, v6
    v_lshlrev_b32 v6, 1, v6
    v_xor_b32 v6, v6, v4
    v_lshlrev_b32 v6, 4, v6
    v_mul_u32_u24 v14, 7168, v5
    v_add_u32 v14, v14, v6
    s_mul_i32 s25, s24, 4096
    s_mul_i32 s26, s24, 2048
    s_add_u32 s26, s26, 32768
    s_mov_b32 s27, 0
    s_mov_b32 s42, 0
    s_add_u32 m0, s25, 0
    s_nop 0
    buffer_load_dwordx4 v9, s[8:11], s27 offen lds
    s_add_u32 m0, s25, 1024
    s_nop 0
    buffer_load_dwordx4 v10, s[8:11], s27 offen lds
    s_add_u32 m0, s25, 2048
    s_nop 0
    buffer_load_dwordx4 v11, s[8:11], s27 offen lds
    s_add_u32 m0, s25, 3072
    s_nop 0
    buffer_load_dwordx4 v12, s[8:11], s27 offen lds
    s_add_u32 m0, s26, 0
    s_nop 0
    buffer_load_dwordx4 v13, s[12:15], s42 offen lds
    s_add_u32 m0, s26, 1024
    s_nop 0
    buffer_load_dwordx4 v14, s[12:15], s42 offen lds
    s_add_u32 m0, s26, 16384
    s_nop 0
    buffer_load_dwordx4 v13, s[44:47], s42 offen lds
    s_add_u32 m0, s26, 17408
    s_nop 0
    buffer_load_dwordx4 v14, s[44:47], s42 offen lds
    s_add_u32 s27, s27, 128
    s_add_u32 s42, s42, 458752
    s_add_u32 m0, s25, 65536
    s_nop 0
    buffer_load_dwordx4 v9, s[8:11], s27 offen lds
    s_add_u32 m0, s25, 66560
    s_nop 0
    buffer_load_dwordx4 v10, s[8:11], s27 offen lds
    s_add_u32 m0, s25, 67584
    s_nop 0
    buffer_load_dwordx4 v11, s[8:11], s27 offen lds
    s_add_u32 m0, s25, 68608
    s_nop 0
    buffer_load_dwordx4 v12, s[8:11], s27 offen lds
    s_add_u32 m0, s26, 65536
    s_nop 0
    buffer_load_dwordx4 v13, s[12:15], s42 offen lds
    s_add_u32 m0, s26, 66560
    s_nop 0
    buffer_load_dwordx4 v14, s[12:15], s42 offen lds
    s_add_u32 m0, s26, 81920
    s_nop 0
    buffer_load_dwordx4 v13, s[44:47], s42 offen lds
    s_add_u32 m0, s26, 82944
    s_nop 0
    buffer_load_dwordx4 v14, s[44:47], s42 offen lds
    s_add_u32 s27, s27, 128
    s_add_u32 s42, s42, 458752
    v_and_b32 v3, 15, v1
    v_lshrrev_b32 v4, 4, v1
    v_and_b32 v5, 3, v2
    v_lshrrev_b32 v6, 2, v2
    v_and_b32 v7, 3, v3
    v_lshrrev_b32 v8, 1, v3
    v_and_or_b32 v7, v8, 4, v7
    v_xor_b32 v7, v7, v4
    v_lshlrev_b32 v7, 4, v7
    v_mul_u32_u24 v8, 64, v5
    v_add_u32 v8, v8, v3
    v_lshlrev_b32 v8, 7, v8
    v_add_u32 v15, v8, v7
    v_xor_b32 v16, 64, v15
    v_add_u32 v17, 0x10000, v15
    v_add_u32 v18, 0x10000, v16
    v_lshrrev_b32 v28, 2, v3
    v_and_b32 v29, 3, v3
    v_and_b32 v30, 1, v4
    v_lshl_or_b32 v30, v30, 2, v28
    v_lshl_add_u32 v27, v4, 3, v28
    v_lshlrev_b32 v27, 8, v27
    v_add_u32 v27, 32768, v27
    v_lshl_add_u32 v27, v6, 14, v27
    v_mov_b32 v7, 0
    v_add_u32 v7, 0, v7
    v_add_u32 v7, v7, v29
    v_lshlrev_b32 v8, 1, v30
    v_xor_b32 v7, v7, v8
    v_lshl_add_u32 v31, v7, 4, v27
    v_add_u32 v32, 0x10000, v31
    v_mov_b32 v7, 0
    v_add_u32 v7, 4, v7
    v_add_u32 v7, v7, v29
    v_lshlrev_b32 v8, 1, v30
    v_xor_b32 v7, v7, v8
    v_lshl_add_u32 v33, v7, 4, v27
    v_add_u32 v34, 0x10000, v33
    v_mov_b32 v7, 0
    v_add_u32 v7, 8, v7
    v_add_u32 v7, v7, v29
    v_lshlrev_b32 v8, 1, v30
    v_xor_b32 v7, v7, v8
    v_lshl_add_u32 v35, v7, 4, v27
    v_add_u32 v36, 0x10000, v35
    v_mov_b32 v7, 0
    v_add_u32 v7, 6, v7
    v_xor_b32 v7, v7, v30
    v_lshl_add_u32 v37, v7, 5, v27
    v_lshl_add_u32 v37, v29, 3, v37
    v_add_u32 v38, 0x10000, v37
    v_mul_u32_u24 v7, 64, v5
    v_add_u32 v7, v7, v3
    v_mul_u32_u24 v7, 7168, v7
    v_lshlrev_b32 v41, 4, v1
    v_lshl_add_u32 v41, v5, 14, v41
    v_lshl_add_u32 v39, v4, 4, v7
    v_lshl_add_u32 v40, v4, 3, v7
    v_accvgpr_write_b32 a0, 0
    v_accvgpr_write_b32 a1, 0
    v_accvgpr_write_b32 a2, 0
    v_accvgpr_write_b32 a3, 0
    v_accvgpr_write_b32 a4, 0
    v_accvgpr_write_b32 a5, 0
    v_accvgpr_write_b32 a6, 0
    v_accvgpr_write_b32 a7, 0
    v_accvgpr_write_b32 a8, 0
    v_accvgpr_write_b32 a9, 0
    v_accvgpr_write_b32 a10, 0
    v_accvgpr_write_b32 a11, 0
    v_accvgpr_write_b32 a12, 0
    v_accvgpr_write_b32 a13, 0
    v_accvgpr_write_b32 a14, 0
    v_accvgpr_write_b32 a15, 0
    v_accvgpr_write_b32 a16, 0
    v_accvgpr_write_b32 a17, 0
    v_accvgpr_write_b32 a18, 0
    v_accvgpr_write_b32 a19, 0
    v_accvgpr_write_b32 a20, 0
    v_accvgpr_write_b32 a21, 0
    v_accvgpr_write_b32 a22, 0
    v_accvgpr_write_b32 a23, 0
    v_accvgpr_write_b32 a24, 0
    v_accvgpr_write_b32 a25, 0
    v_accvgpr_write_b32 a26, 0
    v_accvgpr_write_b32 a27, 0
    v_accvgpr_write_b32 a28, 0
    v_accvgpr_write_b32 a29, 0
    v_accvgpr_write_b32 a30, 0
    v_accvgpr_write_b32 a31, 0
    v_accvgpr_write_b32 a32, 0
    v_accvgpr_write_b32 a33, 0
    v_accvgpr_write_b32 a34, 0
    v_accvgpr_write_b32 a35, 0
    v_accvgpr_write_b32 a36, 0
    v_accvgpr_write_b32 a37, 0
    v_accvgpr_write_b32 a38, 0
    v_accvgpr_write_b32 a39, 0
    v_accvgpr_write_b32 a40, 0
    v_accvgpr_write_b32 a41, 0
    v_accvgpr_write_b32 a42, 0
    v_accvgpr_write_b32 a43, 0
    v_accvgpr_write_b32 a44, 0
    v_accvgpr_write_b32 a45, 0
    v_accvgpr_write_b32 a46, 0
    v_accvgpr_write_b32 a47, 0
    v_accvgpr_write_b32 a48, 0
    v_accvgpr_write_b32 a49, 0
    v_accvgpr_write_b32 a50, 0
    v_accvgpr_write_b32 a51, 0
    v_accvgpr_write_b32 a52, 0
    v_accvgpr_write_b32 a53, 0
    v_accvgpr_write_b32 a54, 0
    v_accvgpr_write_b32 a55, 0
    v_accvgpr_write_b32 a56, 0
    v_accvgpr_write_b32 a57, 0
    v_accvgpr_write_b32 a58, 0
    v_accvgpr_write_b32 a59, 0
    v_accvgpr_write_b32 a60, 0
    v_accvgpr_write_b32 a61, 0
    v_accvgpr_write_b32 a62, 0
    v_accvgpr_write_b32 a63, 0
    v_accvgpr_write_b32 a64, 0
    v_accvgpr_write_b32 a65, 0
    v_accvgpr_write_b32 a66, 0
    v_accvgpr_write_b32 a67, 0
    v_accvgpr_write_b32 a68, 0
    v_accvgpr_write_b32 a69, 0
    v_accvgpr_write_b32 a70, 0
    v_accvgpr_write_b32 a71, 0
    v_accvgpr_write_b32 a72, 0
    v_accvgpr_write_b32 a73, 0
    v_accvgpr_write_b32 a74, 0
    v_accvgpr_write_b32 a75, 0
    v_accvgpr_write_b32 a76, 0
    v_accvgpr_write_b32 a77, 0
    v_accvgpr_write_b32 a78, 0
    v_accvgpr_write_b32 a79, 0
    v_accvgpr_write_b32 a80, 0
    v_accvgpr_write_b32 a81, 0
    v_accvgpr_write_b32 a82, 0
    v_accvgpr_write_b32 a83, 0
    v_accvgpr_write_b32 a84, 0
    v_accvgpr_write_b32 a85, 0
    v_accvgpr_write_b32 a86, 0
    v_accvgpr_write_b32 a87, 0
    v_accvgpr_write_b32 a88, 0
    v_accvgpr_write_b32 a89, 0
    v_accvgpr_write_b32 a90, 0
    v_accvgpr_write_b32 a91, 0
    v_accvgpr_write_b32 a92, 0
    v_accvgpr_write_b32 a93, 0
    v_accvgpr_write_b32 a94, 0
    v_accvgpr_write_b32 a95, 0
    v_accvgpr_write_b32 a96, 0
    v_accvgpr_write_b32 a97, 0
    v_accvgpr_write_b32 a98, 0
    v_accvgpr_write_b32 a99, 0
    v_accvgpr_write_b32 a100, 0
    v_accvgpr_write_b32 a101, 0
    v_accvgpr_write_b32 a102, 0
    v_accvgpr_write_b32 a103, 0
    v_accvgpr_write_b32 a104, 0
    v_accvgpr_write_b32 a105, 0
    v_accvgpr_write_b32 a106, 0
    v_accvgpr_write_b32 a107, 0
    v_accvgpr_write_b32 a108, 0
    v_accvgpr_write_b32 a109, 0
    v_accvgpr_write_b32 a110, 0
    v_accvgpr_write_b32 a111, 0
    s_waitcnt vmcnt(8)
    s_barrier
    ds_read_b64_tr_b16 v[76:77], v31 offset:0
    ds_read_b128 v[44:47], v15 offset:0
    ds_read_b64_tr_b16 v[78:79], v31 offset:1024
    ds_read_b128 v[48:51], v15 offset:2048
    ds_read_b64_tr_b16 v[80:81], v31 offset:8
    ds_read_b128 v[52:55], v15 offset:4096
    ds_read_b64_tr_b16 v[82:83], v31 offset:1032
    ds_read_b128 v[56:59], v15 offset:6144
    ds_read_b64_tr_b16 v[84:85], v33 offset:0
    ds_read_b64_tr_b16 v[86:87], v33 offset:1024
    ds_read_b64_tr_b16 v[88:89], v33 offset:8
    ds_read_b64_tr_b16 v[90:91], v33 offset:1032
    ds_read_b64_tr_b16 v[92:93], v35 offset:0
    ds_read_b64_tr_b16 v[94:95], v35 offset:1024
    ds_read_b64_tr_b16 v[96:97], v35 offset:8
    ds_read_b64_tr_b16 v[98:99], v35 offset:1032
    ds_read_b64_tr_b16 v[100:101], v37 offset:0
    ds_read_b64_tr_b16 v[102:103], v37 offset:1024
    s_mov_b32 s28, 7
gemm_b1_kernel_loop:
    s_waitcnt lgkmcnt(0)
    v_mfma_f32_16x16x32_bf16 a[0:3], v[76:79], v[44:47], a[0:3]
    ds_read_b64_tr_b16 v[104:105], v31 offset:8192
    ds_read_b128 v[60:63], v16 offset:0
    v_mfma_f32_16x16x32_bf16 a[4:7], v[76:79], v[48:51], a[4:7]
    ds_read_b64_tr_b16 v[106:107], v31 offset:9216
    ds_read_b128 v[64:67], v16 offset:2048
    v_mfma_f32_16x16x32_bf16 a[8:11], v[76:79], v[52:55], a[8:11]
    ds_read_b64_tr_b16 v[108:109], v31 offset:8200
    ds_read_b128 v[68:71], v16 offset:4096
    v_mfma_f32_16x16x32_bf16 a[12:15], v[76:79], v[56:59], a[12:15]
    ds_read_b64_tr_b16 v[110:111], v31 offset:9224
    ds_read_b128 v[72:75], v16 offset:6144
    v_mfma_f32_16x16x32_bf16 a[16:19], v[80:83], v[44:47], a[16:19]
    ds_read_b64_tr_b16 v[112:113], v33 offset:8192
    ds_read_b64_tr_b16 v[114:115], v33 offset:9216
    v_mfma_f32_16x16x32_bf16 a[20:23], v[80:83], v[48:51], a[20:23]
    ds_read_b64_tr_b16 v[116:117], v33 offset:8200
    ds_read_b64_tr_b16 v[118:119], v33 offset:9224
    v_mfma_f32_16x16x32_bf16 a[24:27], v[80:83], v[52:55], a[24:27]
    ds_read_b64_tr_b16 v[120:121], v35 offset:8192
    ds_read_b64_tr_b16 v[122:123], v35 offset:9216
    v_mfma_f32_16x16x32_bf16 a[28:31], v[80:83], v[56:59], a[28:31]
    ds_read_b64_tr_b16 v[124:125], v35 offset:8200
    ds_read_b64_tr_b16 v[126:127], v35 offset:9224
    v_mfma_f32_16x16x32_bf16 a[32:35], v[84:87], v[44:47], a[32:35]
    ds_read_b64_tr_b16 v[128:129], v37 offset:8192
    ds_read_b64_tr_b16 v[130:131], v37 offset:9216
    v_mfma_f32_16x16x32_bf16 a[36:39], v[84:87], v[48:51], a[36:39]
    v_mfma_f32_16x16x32_bf16 a[40:43], v[84:87], v[52:55], a[40:43]
    v_mfma_f32_16x16x32_bf16 a[44:47], v[84:87], v[56:59], a[44:47]
    v_mfma_f32_16x16x32_bf16 a[48:51], v[88:91], v[44:47], a[48:51]
    v_mfma_f32_16x16x32_bf16 a[52:55], v[88:91], v[48:51], a[52:55]
    v_mfma_f32_16x16x32_bf16 a[56:59], v[88:91], v[52:55], a[56:59]
    v_mfma_f32_16x16x32_bf16 a[60:63], v[88:91], v[56:59], a[60:63]
    v_mfma_f32_16x16x32_bf16 a[64:67], v[92:95], v[44:47], a[64:67]
    v_mfma_f32_16x16x32_bf16 a[68:71], v[92:95], v[48:51], a[68:71]
    v_mfma_f32_16x16x32_bf16 a[72:75], v[92:95], v[52:55], a[72:75]
    v_mfma_f32_16x16x32_bf16 a[76:79], v[92:95], v[56:59], a[76:79]
    v_mfma_f32_16x16x32_bf16 a[80:83], v[96:99], v[44:47], a[80:83]
    v_mfma_f32_16x16x32_bf16 a[84:87], v[96:99], v[48:51], a[84:87]
    v_mfma_f32_16x16x32_bf16 a[88:91], v[96:99], v[52:55], a[88:91]
    v_mfma_f32_16x16x32_bf16 a[92:95], v[96:99], v[56:59], a[92:95]
    v_mfma_f32_16x16x32_bf16 a[96:99], v[100:103], v[44:47], a[96:99]
    v_mfma_f32_16x16x32_bf16 a[100:103], v[100:103], v[48:51], a[100:103]
    v_mfma_f32_16x16x32_bf16 a[104:107], v[100:103], v[52:55], a[104:107]
    v_mfma_f32_16x16x32_bf16 a[108:111], v[100:103], v[56:59], a[108:111]
    s_waitcnt lgkmcnt(0)
    s_waitcnt vmcnt(0)
    s_barrier
    v_mfma_f32_16x16x32_bf16 a[0:3], v[104:107], v[60:63], a[0:3]
    s_add_u32 m0, s25, 0
    ds_read_b64_tr_b16 v[76:77], v32 offset:0
    v_mfma_f32_16x16x32_bf16 a[4:7], v[104:107], v[64:67], a[4:7]
    buffer_load_dwordx4 v9, s[8:11], s27 offen lds
    s_add_u32 m0, s25, 1024
    v_mfma_f32_16x16x32_bf16 a[8:11], v[104:107], v[68:71], a[8:11]
    ds_read_b128 v[44:47], v17 offset:0
    buffer_load_dwordx4 v10, s[8:11], s27 offen lds
    v_mfma_f32_16x16x32_bf16 a[12:15], v[104:107], v[72:75], a[12:15]
    s_add_u32 m0, s25, 2048
    ds_read_b64_tr_b16 v[78:79], v32 offset:1024
    v_mfma_f32_16x16x32_bf16 a[16:19], v[108:111], v[60:63], a[16:19]
    buffer_load_dwordx4 v11, s[8:11], s27 offen lds
    s_add_u32 m0, s25, 3072
    v_mfma_f32_16x16x32_bf16 a[20:23], v[108:111], v[64:67], a[20:23]
    ds_read_b128 v[48:51], v17 offset:2048
    buffer_load_dwordx4 v12, s[8:11], s27 offen lds
    v_mfma_f32_16x16x32_bf16 a[24:27], v[108:111], v[68:71], a[24:27]
    s_add_u32 m0, s26, 0
    ds_read_b64_tr_b16 v[80:81], v32 offset:8
    v_mfma_f32_16x16x32_bf16 a[28:31], v[108:111], v[72:75], a[28:31]
    buffer_load_dwordx4 v13, s[12:15], s42 offen lds
    s_add_u32 m0, s26, 1024
    v_mfma_f32_16x16x32_bf16 a[32:35], v[112:115], v[60:63], a[32:35]
    ds_read_b128 v[52:55], v17 offset:4096
    buffer_load_dwordx4 v14, s[12:15], s42 offen lds
    v_mfma_f32_16x16x32_bf16 a[36:39], v[112:115], v[64:67], a[36:39]
    s_add_u32 m0, s26, 16384
    ds_read_b64_tr_b16 v[82:83], v32 offset:1032
    v_mfma_f32_16x16x32_bf16 a[40:43], v[112:115], v[68:71], a[40:43]
    buffer_load_dwordx4 v13, s[44:47], s42 offen lds
    s_add_u32 m0, s26, 17408
    v_mfma_f32_16x16x32_bf16 a[44:47], v[112:115], v[72:75], a[44:47]
    ds_read_b128 v[56:59], v17 offset:6144
    buffer_load_dwordx4 v14, s[44:47], s42 offen lds
    v_mfma_f32_16x16x32_bf16 a[48:51], v[116:119], v[60:63], a[48:51]
    ds_read_b64_tr_b16 v[84:85], v34 offset:0
    ds_read_b64_tr_b16 v[86:87], v34 offset:1024
    v_mfma_f32_16x16x32_bf16 a[52:55], v[116:119], v[64:67], a[52:55]
    ds_read_b64_tr_b16 v[88:89], v34 offset:8
    ds_read_b64_tr_b16 v[90:91], v34 offset:1032
    v_mfma_f32_16x16x32_bf16 a[56:59], v[116:119], v[68:71], a[56:59]
    ds_read_b64_tr_b16 v[92:93], v36 offset:0
    ds_read_b64_tr_b16 v[94:95], v36 offset:1024
    v_mfma_f32_16x16x32_bf16 a[60:63], v[116:119], v[72:75], a[60:63]
    ds_read_b64_tr_b16 v[96:97], v36 offset:8
    ds_read_b64_tr_b16 v[98:99], v36 offset:1032
    v_mfma_f32_16x16x32_bf16 a[64:67], v[120:123], v[60:63], a[64:67]
    ds_read_b64_tr_b16 v[100:101], v38 offset:0
    ds_read_b64_tr_b16 v[102:103], v38 offset:1024
    v_mfma_f32_16x16x32_bf16 a[68:71], v[120:123], v[64:67], a[68:71]
    s_add_u32 s27, s27, 128
    s_add_u32 s42, s42, 458752
    v_mfma_f32_16x16x32_bf16 a[72:75], v[120:123], v[68:71], a[72:75]
    v_mfma_f32_16x16x32_bf16 a[76:79], v[120:123], v[72:75], a[76:79]
    v_mfma_f32_16x16x32_bf16 a[80:83], v[124:127], v[60:63], a[80:83]
    v_mfma_f32_16x16x32_bf16 a[84:87], v[124:127], v[64:67], a[84:87]
    v_mfma_f32_16x16x32_bf16 a[88:91], v[124:127], v[68:71], a[88:91]
    v_mfma_f32_16x16x32_bf16 a[92:95], v[124:127], v[72:75], a[92:95]
    v_mfma_f32_16x16x32_bf16 a[96:99], v[128:131], v[60:63], a[96:99]
    v_mfma_f32_16x16x32_bf16 a[100:103], v[128:131], v[64:67], a[100:103]
    v_mfma_f32_16x16x32_bf16 a[104:107], v[128:131], v[68:71], a[104:107]
    v_mfma_f32_16x16x32_bf16 a[108:111], v[128:131], v[72:75], a[108:111]
    s_waitcnt lgkmcnt(0)
    v_mfma_f32_16x16x32_bf16 a[0:3], v[76:79], v[44:47], a[0:3]
    ds_read_b64_tr_b16 v[104:105], v32 offset:8192
    ds_read_b128 v[60:63], v18 offset:0
    v_mfma_f32_16x16x32_bf16 a[4:7], v[76:79], v[48:51], a[4:7]
    ds_read_b64_tr_b16 v[106:107], v32 offset:9216
    ds_read_b128 v[64:67], v18 offset:2048
    v_mfma_f32_16x16x32_bf16 a[8:11], v[76:79], v[52:55], a[8:11]
    ds_read_b64_tr_b16 v[108:109], v32 offset:8200
    ds_read_b128 v[68:71], v18 offset:4096
    v_mfma_f32_16x16x32_bf16 a[12:15], v[76:79], v[56:59], a[12:15]
    ds_read_b64_tr_b16 v[110:111], v32 offset:9224
    ds_read_b128 v[72:75], v18 offset:6144
    v_mfma_f32_16x16x32_bf16 a[16:19], v[80:83], v[44:47], a[16:19]
    ds_read_b64_tr_b16 v[112:113], v34 offset:8192
    ds_read_b64_tr_b16 v[114:115], v34 offset:9216
    v_mfma_f32_16x16x32_bf16 a[20:23], v[80:83], v[48:51], a[20:23]
    ds_read_b64_tr_b16 v[116:117], v34 offset:8200
    ds_read_b64_tr_b16 v[118:119], v34 offset:9224
    v_mfma_f32_16x16x32_bf16 a[24:27], v[80:83], v[52:55], a[24:27]
    ds_read_b64_tr_b16 v[120:121], v36 offset:8192
    ds_read_b64_tr_b16 v[122:123], v36 offset:9216
    v_mfma_f32_16x16x32_bf16 a[28:31], v[80:83], v[56:59], a[28:31]
    ds_read_b64_tr_b16 v[124:125], v36 offset:8200
    ds_read_b64_tr_b16 v[126:127], v36 offset:9224
    v_mfma_f32_16x16x32_bf16 a[32:35], v[84:87], v[44:47], a[32:35]
    ds_read_b64_tr_b16 v[128:129], v38 offset:8192
    ds_read_b64_tr_b16 v[130:131], v38 offset:9216
    v_mfma_f32_16x16x32_bf16 a[36:39], v[84:87], v[48:51], a[36:39]
    v_mfma_f32_16x16x32_bf16 a[40:43], v[84:87], v[52:55], a[40:43]
    v_mfma_f32_16x16x32_bf16 a[44:47], v[84:87], v[56:59], a[44:47]
    v_mfma_f32_16x16x32_bf16 a[48:51], v[88:91], v[44:47], a[48:51]
    v_mfma_f32_16x16x32_bf16 a[52:55], v[88:91], v[48:51], a[52:55]
    v_mfma_f32_16x16x32_bf16 a[56:59], v[88:91], v[52:55], a[56:59]
    v_mfma_f32_16x16x32_bf16 a[60:63], v[88:91], v[56:59], a[60:63]
    v_mfma_f32_16x16x32_bf16 a[64:67], v[92:95], v[44:47], a[64:67]
    v_mfma_f32_16x16x32_bf16 a[68:71], v[92:95], v[48:51], a[68:71]
    v_mfma_f32_16x16x32_bf16 a[72:75], v[92:95], v[52:55], a[72:75]
    v_mfma_f32_16x16x32_bf16 a[76:79], v[92:95], v[56:59], a[76:79]
    v_mfma_f32_16x16x32_bf16 a[80:83], v[96:99], v[44:47], a[80:83]
    v_mfma_f32_16x16x32_bf16 a[84:87], v[96:99], v[48:51], a[84:87]
    v_mfma_f32_16x16x32_bf16 a[88:91], v[96:99], v[52:55], a[88:91]
    v_mfma_f32_16x16x32_bf16 a[92:95], v[96:99], v[56:59], a[92:95]
    v_mfma_f32_16x16x32_bf16 a[96:99], v[100:103], v[44:47], a[96:99]
    v_mfma_f32_16x16x32_bf16 a[100:103], v[100:103], v[48:51], a[100:103]
    v_mfma_f32_16x16x32_bf16 a[104:107], v[100:103], v[52:55], a[104:107]
    v_mfma_f32_16x16x32_bf16 a[108:111], v[100:103], v[56:59], a[108:111]
    s_waitcnt lgkmcnt(0)
    s_waitcnt vmcnt(0)
    s_barrier
    v_mfma_f32_16x16x32_bf16 a[0:3], v[104:107], v[60:63], a[0:3]
    s_add_u32 m0, s25, 65536
    ds_read_b64_tr_b16 v[76:77], v31 offset:0
    v_mfma_f32_16x16x32_bf16 a[4:7], v[104:107], v[64:67], a[4:7]
    buffer_load_dwordx4 v9, s[8:11], s27 offen lds
    s_add_u32 m0, s25, 66560
    v_mfma_f32_16x16x32_bf16 a[8:11], v[104:107], v[68:71], a[8:11]
    ds_read_b128 v[44:47], v15 offset:0
    buffer_load_dwordx4 v10, s[8:11], s27 offen lds
    v_mfma_f32_16x16x32_bf16 a[12:15], v[104:107], v[72:75], a[12:15]
    s_add_u32 m0, s25, 67584
    ds_read_b64_tr_b16 v[78:79], v31 offset:1024
    v_mfma_f32_16x16x32_bf16 a[16:19], v[108:111], v[60:63], a[16:19]
    buffer_load_dwordx4 v11, s[8:11], s27 offen lds
    s_add_u32 m0, s25, 68608
    v_mfma_f32_16x16x32_bf16 a[20:23], v[108:111], v[64:67], a[20:23]
    ds_read_b128 v[48:51], v15 offset:2048
    buffer_load_dwordx4 v12, s[8:11], s27 offen lds
    v_mfma_f32_16x16x32_bf16 a[24:27], v[108:111], v[68:71], a[24:27]
    s_add_u32 m0, s26, 65536
    ds_read_b64_tr_b16 v[80:81], v31 offset:8
    v_mfma_f32_16x16x32_bf16 a[28:31], v[108:111], v[72:75], a[28:31]
    buffer_load_dwordx4 v13, s[12:15], s42 offen lds
    s_add_u32 m0, s26, 66560
    v_mfma_f32_16x16x32_bf16 a[32:35], v[112:115], v[60:63], a[32:35]
    ds_read_b128 v[52:55], v15 offset:4096
    buffer_load_dwordx4 v14, s[12:15], s42 offen lds
    v_mfma_f32_16x16x32_bf16 a[36:39], v[112:115], v[64:67], a[36:39]
    s_add_u32 m0, s26, 81920
    ds_read_b64_tr_b16 v[82:83], v31 offset:1032
    v_mfma_f32_16x16x32_bf16 a[40:43], v[112:115], v[68:71], a[40:43]
    buffer_load_dwordx4 v13, s[44:47], s42 offen lds
    s_add_u32 m0, s26, 82944
    v_mfma_f32_16x16x32_bf16 a[44:47], v[112:115], v[72:75], a[44:47]
    ds_read_b128 v[56:59], v15 offset:6144
    buffer_load_dwordx4 v14, s[44:47], s42 offen lds
    v_mfma_f32_16x16x32_bf16 a[48:51], v[116:119], v[60:63], a[48:51]
    ds_read_b64_tr_b16 v[84:85], v33 offset:0
    ds_read_b64_tr_b16 v[86:87], v33 offset:1024
    v_mfma_f32_16x16x32_bf16 a[52:55], v[116:119], v[64:67], a[52:55]
    ds_read_b64_tr_b16 v[88:89], v33 offset:8
    ds_read_b64_tr_b16 v[90:91], v33 offset:1032
    v_mfma_f32_16x16x32_bf16 a[56:59], v[116:119], v[68:71], a[56:59]
    ds_read_b64_tr_b16 v[92:93], v35 offset:0
    ds_read_b64_tr_b16 v[94:95], v35 offset:1024
    v_mfma_f32_16x16x32_bf16 a[60:63], v[116:119], v[72:75], a[60:63]
    ds_read_b64_tr_b16 v[96:97], v35 offset:8
    ds_read_b64_tr_b16 v[98:99], v35 offset:1032
    v_mfma_f32_16x16x32_bf16 a[64:67], v[120:123], v[60:63], a[64:67]
    ds_read_b64_tr_b16 v[100:101], v37 offset:0
    ds_read_b64_tr_b16 v[102:103], v37 offset:1024
    v_mfma_f32_16x16x32_bf16 a[68:71], v[120:123], v[64:67], a[68:71]
    s_add_u32 s27, s27, 128
    s_add_u32 s42, s42, 458752
    v_mfma_f32_16x16x32_bf16 a[72:75], v[120:123], v[68:71], a[72:75]
    v_mfma_f32_16x16x32_bf16 a[76:79], v[120:123], v[72:75], a[76:79]
    v_mfma_f32_16x16x32_bf16 a[80:83], v[124:127], v[60:63], a[80:83]
    v_mfma_f32_16x16x32_bf16 a[84:87], v[124:127], v[64:67], a[84:87]
    v_mfma_f32_16x16x32_bf16 a[88:91], v[124:127], v[68:71], a[88:91]
    v_mfma_f32_16x16x32_bf16 a[92:95], v[124:127], v[72:75], a[92:95]
    v_mfma_f32_16x16x32_bf16 a[96:99], v[128:131], v[60:63], a[96:99]
    v_mfma_f32_16x16x32_bf16 a[100:103], v[128:131], v[64:67], a[100:103]
    v_mfma_f32_16x16x32_bf16 a[104:107], v[128:131], v[68:71], a[104:107]
    v_mfma_f32_16x16x32_bf16 a[108:111], v[128:131], v[72:75], a[108:111]
    s_sub_u32 s28, s28, 1
    s_cmp_lg_u32 s28, 0
    s_cbranch_scc1 gemm_b1_kernel_loop
    s_waitcnt lgkmcnt(0)
    v_mfma_f32_16x16x32_bf16 a[0:3], v[76:79], v[44:47], a[0:3]
    ds_read_b64_tr_b16 v[104:105], v31 offset:8192
    ds_read_b128 v[60:63], v16 offset:0
    v_mfma_f32_16x16x32_bf16 a[4:7], v[76:79], v[48:51], a[4:7]
    ds_read_b64_tr_b16 v[106:107], v31 offset:9216
    ds_read_b128 v[64:67], v16 offset:2048
    v_mfma_f32_16x16x32_bf16 a[8:11], v[76:79], v[52:55], a[8:11]
    ds_read_b64_tr_b16 v[108:109], v31 offset:8200
    ds_read_b128 v[68:71], v16 offset:4096
    v_mfma_f32_16x16x32_bf16 a[12:15], v[76:79], v[56:59], a[12:15]
    ds_read_b64_tr_b16 v[110:111], v31 offset:9224
    ds_read_b128 v[72:75], v16 offset:6144
    v_mfma_f32_16x16x32_bf16 a[16:19], v[80:83], v[44:47], a[16:19]
    ds_read_b64_tr_b16 v[112:113], v33 offset:8192
    ds_read_b64_tr_b16 v[114:115], v33 offset:9216
    v_mfma_f32_16x16x32_bf16 a[20:23], v[80:83], v[48:51], a[20:23]
    ds_read_b64_tr_b16 v[116:117], v33 offset:8200
    ds_read_b64_tr_b16 v[118:119], v33 offset:9224
    v_mfma_f32_16x16x32_bf16 a[24:27], v[80:83], v[52:55], a[24:27]
    ds_read_b64_tr_b16 v[120:121], v35 offset:8192
    ds_read_b64_tr_b16 v[122:123], v35 offset:9216
    v_mfma_f32_16x16x32_bf16 a[28:31], v[80:83], v[56:59], a[28:31]
    ds_read_b64_tr_b16 v[124:125], v35 offset:8200
    ds_read_b64_tr_b16 v[126:127], v35 offset:9224
    v_mfma_f32_16x16x32_bf16 a[32:35], v[84:87], v[44:47], a[32:35]
    ds_read_b64_tr_b16 v[128:129], v37 offset:8192
    ds_read_b64_tr_b16 v[130:131], v37 offset:9216
    v_mfma_f32_16x16x32_bf16 a[36:39], v[84:87], v[48:51], a[36:39]
    v_mfma_f32_16x16x32_bf16 a[40:43], v[84:87], v[52:55], a[40:43]
    v_mfma_f32_16x16x32_bf16 a[44:47], v[84:87], v[56:59], a[44:47]
    v_mfma_f32_16x16x32_bf16 a[48:51], v[88:91], v[44:47], a[48:51]
    v_mfma_f32_16x16x32_bf16 a[52:55], v[88:91], v[48:51], a[52:55]
    v_mfma_f32_16x16x32_bf16 a[56:59], v[88:91], v[52:55], a[56:59]
    v_mfma_f32_16x16x32_bf16 a[60:63], v[88:91], v[56:59], a[60:63]
    v_mfma_f32_16x16x32_bf16 a[64:67], v[92:95], v[44:47], a[64:67]
    v_mfma_f32_16x16x32_bf16 a[68:71], v[92:95], v[48:51], a[68:71]
    v_mfma_f32_16x16x32_bf16 a[72:75], v[92:95], v[52:55], a[72:75]
    v_mfma_f32_16x16x32_bf16 a[76:79], v[92:95], v[56:59], a[76:79]
    v_mfma_f32_16x16x32_bf16 a[80:83], v[96:99], v[44:47], a[80:83]
    v_mfma_f32_16x16x32_bf16 a[84:87], v[96:99], v[48:51], a[84:87]
    v_mfma_f32_16x16x32_bf16 a[88:91], v[96:99], v[52:55], a[88:91]
    v_mfma_f32_16x16x32_bf16 a[92:95], v[96:99], v[56:59], a[92:95]
    v_mfma_f32_16x16x32_bf16 a[96:99], v[100:103], v[44:47], a[96:99]
    v_mfma_f32_16x16x32_bf16 a[100:103], v[100:103], v[48:51], a[100:103]
    v_mfma_f32_16x16x32_bf16 a[104:107], v[100:103], v[52:55], a[104:107]
    v_mfma_f32_16x16x32_bf16 a[108:111], v[100:103], v[56:59], a[108:111]
    s_waitcnt lgkmcnt(0)
    s_waitcnt vmcnt(0)
    s_barrier
    v_mfma_f32_16x16x32_bf16 a[0:3], v[104:107], v[60:63], a[0:3]
    ds_read_b64_tr_b16 v[76:77], v32 offset:0
    v_mfma_f32_16x16x32_bf16 a[4:7], v[104:107], v[64:67], a[4:7]
    ds_read_b128 v[44:47], v17 offset:0
    v_mfma_f32_16x16x32_bf16 a[8:11], v[104:107], v[68:71], a[8:11]
    ds_read_b64_tr_b16 v[78:79], v32 offset:1024
    v_mfma_f32_16x16x32_bf16 a[12:15], v[104:107], v[72:75], a[12:15]
    ds_read_b128 v[48:51], v17 offset:2048
    v_mfma_f32_16x16x32_bf16 a[16:19], v[108:111], v[60:63], a[16:19]
    ds_read_b64_tr_b16 v[80:81], v32 offset:8
    v_mfma_f32_16x16x32_bf16 a[20:23], v[108:111], v[64:67], a[20:23]
    ds_read_b128 v[52:55], v17 offset:4096
    v_mfma_f32_16x16x32_bf16 a[24:27], v[108:111], v[68:71], a[24:27]
    ds_read_b64_tr_b16 v[82:83], v32 offset:1032
    v_mfma_f32_16x16x32_bf16 a[28:31], v[108:111], v[72:75], a[28:31]
    ds_read_b128 v[56:59], v17 offset:6144
    v_mfma_f32_16x16x32_bf16 a[32:35], v[112:115], v[60:63], a[32:35]
    ds_read_b64_tr_b16 v[84:85], v34 offset:0
    v_mfma_f32_16x16x32_bf16 a[36:39], v[112:115], v[64:67], a[36:39]
    ds_read_b64_tr_b16 v[86:87], v34 offset:1024
    v_mfma_f32_16x16x32_bf16 a[40:43], v[112:115], v[68:71], a[40:43]
    ds_read_b64_tr_b16 v[88:89], v34 offset:8
    v_mfma_f32_16x16x32_bf16 a[44:47], v[112:115], v[72:75], a[44:47]
    ds_read_b64_tr_b16 v[90:91], v34 offset:1032
    v_mfma_f32_16x16x32_bf16 a[48:51], v[116:119], v[60:63], a[48:51]
    ds_read_b64_tr_b16 v[92:93], v36 offset:0
    v_mfma_f32_16x16x32_bf16 a[52:55], v[116:119], v[64:67], a[52:55]
    ds_read_b64_tr_b16 v[94:95], v36 offset:1024
    v_mfma_f32_16x16x32_bf16 a[56:59], v[116:119], v[68:71], a[56:59]
    ds_read_b64_tr_b16 v[96:97], v36 offset:8
    v_mfma_f32_16x16x32_bf16 a[60:63], v[116:119], v[72:75], a[60:63]
    ds_read_b64_tr_b16 v[98:99], v36 offset:1032
    v_mfma_f32_16x16x32_bf16 a[64:67], v[120:123], v[60:63], a[64:67]
    ds_read_b64_tr_b16 v[100:101], v38 offset:0
    v_mfma_f32_16x16x32_bf16 a[68:71], v[120:123], v[64:67], a[68:71]
    ds_read_b64_tr_b16 v[102:103], v38 offset:1024
    v_mfma_f32_16x16x32_bf16 a[72:75], v[120:123], v[68:71], a[72:75]
    v_mfma_f32_16x16x32_bf16 a[76:79], v[120:123], v[72:75], a[76:79]
    v_mfma_f32_16x16x32_bf16 a[80:83], v[124:127], v[60:63], a[80:83]
    v_mfma_f32_16x16x32_bf16 a[84:87], v[124:127], v[64:67], a[84:87]
    v_mfma_f32_16x16x32_bf16 a[88:91], v[124:127], v[68:71], a[88:91]
    v_mfma_f32_16x16x32_bf16 a[92:95], v[124:127], v[72:75], a[92:95]
    v_mfma_f32_16x16x32_bf16 a[96:99], v[128:131], v[60:63], a[96:99]
    v_mfma_f32_16x16x32_bf16 a[100:103], v[128:131], v[64:67], a[100:103]
    v_mfma_f32_16x16x32_bf16 a[104:107], v[128:131], v[68:71], a[104:107]
    v_mfma_f32_16x16x32_bf16 a[108:111], v[128:131], v[72:75], a[108:111]
    s_waitcnt lgkmcnt(0)
    v_mfma_f32_16x16x32_bf16 a[0:3], v[76:79], v[44:47], a[0:3]
    ds_read_b64_tr_b16 v[104:105], v32 offset:8192
    ds_read_b128 v[60:63], v18 offset:0
    v_mfma_f32_16x16x32_bf16 a[4:7], v[76:79], v[48:51], a[4:7]
    ds_read_b64_tr_b16 v[106:107], v32 offset:9216
    ds_read_b128 v[64:67], v18 offset:2048
    v_mfma_f32_16x16x32_bf16 a[8:11], v[76:79], v[52:55], a[8:11]
    ds_read_b64_tr_b16 v[108:109], v32 offset:8200
    ds_read_b128 v[68:71], v18 offset:4096
    v_mfma_f32_16x16x32_bf16 a[12:15], v[76:79], v[56:59], a[12:15]
    ds_read_b64_tr_b16 v[110:111], v32 offset:9224
    ds_read_b128 v[72:75], v18 offset:6144
    v_mfma_f32_16x16x32_bf16 a[16:19], v[80:83], v[44:47], a[16:19]
    ds_read_b64_tr_b16 v[112:113], v34 offset:8192
    ds_read_b64_tr_b16 v[114:115], v34 offset:9216
    v_mfma_f32_16x16x32_bf16 a[20:23], v[80:83], v[48:51], a[20:23]
    ds_read_b64_tr_b16 v[116:117], v34 offset:8200
    ds_read_b64_tr_b16 v[118:119], v34 offset:9224
    v_mfma_f32_16x16x32_bf16 a[24:27], v[80:83], v[52:55], a[24:27]
    ds_read_b64_tr_b16 v[120:121], v36 offset:8192
    ds_read_b64_tr_b16 v[122:123], v36 offset:9216
    v_mfma_f32_16x16x32_bf16 a[28:31], v[80:83], v[56:59], a[28:31]
    ds_read_b64_tr_b16 v[124:125], v36 offset:8200
    ds_read_b64_tr_b16 v[126:127], v36 offset:9224
    v_mfma_f32_16x16x32_bf16 a[32:35], v[84:87], v[44:47], a[32:35]
    ds_read_b64_tr_b16 v[128:129], v38 offset:8192
    ds_read_b64_tr_b16 v[130:131], v38 offset:9216
    v_mfma_f32_16x16x32_bf16 a[36:39], v[84:87], v[48:51], a[36:39]
    v_mfma_f32_16x16x32_bf16 a[40:43], v[84:87], v[52:55], a[40:43]
    v_mfma_f32_16x16x32_bf16 a[44:47], v[84:87], v[56:59], a[44:47]
    v_mfma_f32_16x16x32_bf16 a[48:51], v[88:91], v[44:47], a[48:51]
    v_mfma_f32_16x16x32_bf16 a[52:55], v[88:91], v[48:51], a[52:55]
    v_mfma_f32_16x16x32_bf16 a[56:59], v[88:91], v[52:55], a[56:59]
    v_mfma_f32_16x16x32_bf16 a[60:63], v[88:91], v[56:59], a[60:63]
    v_mfma_f32_16x16x32_bf16 a[64:67], v[92:95], v[44:47], a[64:67]
    v_mfma_f32_16x16x32_bf16 a[68:71], v[92:95], v[48:51], a[68:71]
    v_mfma_f32_16x16x32_bf16 a[72:75], v[92:95], v[52:55], a[72:75]
    v_mfma_f32_16x16x32_bf16 a[76:79], v[92:95], v[56:59], a[76:79]
    v_mfma_f32_16x16x32_bf16 a[80:83], v[96:99], v[44:47], a[80:83]
    v_mfma_f32_16x16x32_bf16 a[84:87], v[96:99], v[48:51], a[84:87]
    v_mfma_f32_16x16x32_bf16 a[88:91], v[96:99], v[52:55], a[88:91]
    v_mfma_f32_16x16x32_bf16 a[92:95], v[96:99], v[56:59], a[92:95]
    v_mfma_f32_16x16x32_bf16 a[96:99], v[100:103], v[44:47], a[96:99]
    v_mfma_f32_16x16x32_bf16 a[100:103], v[100:103], v[48:51], a[100:103]
    v_mfma_f32_16x16x32_bf16 a[104:107], v[100:103], v[52:55], a[104:107]
    v_mfma_f32_16x16x32_bf16 a[108:111], v[100:103], v[56:59], a[108:111]
    s_waitcnt lgkmcnt(0)
    v_mfma_f32_16x16x32_bf16 a[0:3], v[104:107], v[60:63], a[0:3]
    v_mfma_f32_16x16x32_bf16 a[4:7], v[104:107], v[64:67], a[4:7]
    v_mfma_f32_16x16x32_bf16 a[8:11], v[104:107], v[68:71], a[8:11]
    v_mfma_f32_16x16x32_bf16 a[12:15], v[104:107], v[72:75], a[12:15]
    v_mfma_f32_16x16x32_bf16 a[16:19], v[108:111], v[60:63], a[16:19]
    v_mfma_f32_16x16x32_bf16 a[20:23], v[108:111], v[64:67], a[20:23]
    v_mfma_f32_16x16x32_bf16 a[24:27], v[108:111], v[68:71], a[24:27]
    v_mfma_f32_16x16x32_bf16 a[28:31], v[108:111], v[72:75], a[28:31]
    v_mfma_f32_16x16x32_bf16 a[32:35], v[112:115], v[60:63], a[32:35]
    v_mfma_f32_16x16x32_bf16 a[36:39], v[112:115], v[64:67], a[36:39]
    v_mfma_f32_16x16x32_bf16 a[40:43], v[112:115], v[68:71], a[40:43]
    v_mfma_f32_16x16x32_bf16 a[44:47], v[112:115], v[72:75], a[44:47]
    v_mfma_f32_16x16x32_bf16 a[48:51], v[116:119], v[60:63], a[48:51]
    v_mfma_f32_16x16x32_bf16 a[52:55], v[116:119], v[64:67], a[52:55]
    v_mfma_f32_16x16x32_bf16 a[56:59], v[116:119], v[68:71], a[56:59]
    v_mfma_f32_16x16x32_bf16 a[60:63], v[116:119], v[72:75], a[60:63]
    v_mfma_f32_16x16x32_bf16 a[64:67], v[120:123], v[60:63], a[64:67]
    v_mfma_f32_16x16x32_bf16 a[68:71], v[120:123], v[64:67], a[68:71]
    v_mfma_f32_16x16x32_bf16 a[72:75], v[120:123], v[68:71], a[72:75]
    v_mfma_f32_16x16x32_bf16 a[76:79], v[120:123], v[72:75], a[76:79]
    v_mfma_f32_16x16x32_bf16 a[80:83], v[124:127], v[60:63], a[80:83]
    v_mfma_f32_16x16x32_bf16 a[84:87], v[124:127], v[64:67], a[84:87]
    v_mfma_f32_16x16x32_bf16 a[88:91], v[124:127], v[68:71], a[88:91]
    v_mfma_f32_16x16x32_bf16 a[92:95], v[124:127], v[72:75], a[92:95]
    v_mfma_f32_16x16x32_bf16 a[96:99], v[128:131], v[60:63], a[96:99]
    v_mfma_f32_16x16x32_bf16 a[100:103], v[128:131], v[64:67], a[100:103]
    v_mfma_f32_16x16x32_bf16 a[104:107], v[128:131], v[68:71], a[104:107]
    v_mfma_f32_16x16x32_bf16 a[108:111], v[128:131], v[72:75], a[108:111]
    s_nop 15
    s_nop 7
    s_mov_b32 s30, 0xbfb8aa3b
    s_mov_b32 s31, 0xffff0000
    s_barrier
    s_cmp_lt_u32 s24, 4
    s_cbranch_scc1 gemm_b1_kernel_gate
    v_accvgpr_read_b32 v44, a0
    v_accvgpr_read_b32 v45, a1
    v_accvgpr_read_b32 v46, a2
    v_accvgpr_read_b32 v47, a3
    v_accvgpr_read_b32 v48, a16
    v_accvgpr_read_b32 v49, a17
    v_accvgpr_read_b32 v50, a18
    v_accvgpr_read_b32 v51, a19
    v_cvt_pk_bf16_f32 v52, v44, v45
    v_cvt_pk_bf16_f32 v53, v46, v47
    v_cvt_pk_bf16_f32 v54, v48, v49
    v_cvt_pk_bf16_f32 v55, v50, v51
    ds_write_b128 v41, v[52:55] offset:0
    v_accvgpr_read_b32 v60, a32
    v_accvgpr_read_b32 v61, a33
    v_accvgpr_read_b32 v62, a34
    v_accvgpr_read_b32 v63, a35
    v_accvgpr_read_b32 v64, a48
    v_accvgpr_read_b32 v65, a49
    v_accvgpr_read_b32 v66, a50
    v_accvgpr_read_b32 v67, a51
    v_cvt_pk_bf16_f32 v68, v60, v61
    v_cvt_pk_bf16_f32 v69, v62, v63
    v_cvt_pk_bf16_f32 v70, v64, v65
    v_cvt_pk_bf16_f32 v71, v66, v67
    ds_write_b128 v41, v[68:71] offset:1024
    v_accvgpr_read_b32 v76, a4
    v_accvgpr_read_b32 v77, a5
    v_accvgpr_read_b32 v78, a6
    v_accvgpr_read_b32 v79, a7
    v_accvgpr_read_b32 v80, a20
    v_accvgpr_read_b32 v81, a21
    v_accvgpr_read_b32 v82, a22
    v_accvgpr_read_b32 v83, a23
    v_cvt_pk_bf16_f32 v84, v76, v77
    v_cvt_pk_bf16_f32 v85, v78, v79
    v_cvt_pk_bf16_f32 v86, v80, v81
    v_cvt_pk_bf16_f32 v87, v82, v83
    ds_write_b128 v41, v[84:87] offset:4096
    v_accvgpr_read_b32 v92, a36
    v_accvgpr_read_b32 v93, a37
    v_accvgpr_read_b32 v94, a38
    v_accvgpr_read_b32 v95, a39
    v_accvgpr_read_b32 v96, a52
    v_accvgpr_read_b32 v97, a53
    v_accvgpr_read_b32 v98, a54
    v_accvgpr_read_b32 v99, a55
    v_cvt_pk_bf16_f32 v100, v92, v93
    v_cvt_pk_bf16_f32 v101, v94, v95
    v_cvt_pk_bf16_f32 v102, v96, v97
    v_cvt_pk_bf16_f32 v103, v98, v99
    ds_write_b128 v41, v[100:103] offset:5120
    v_accvgpr_read_b32 v44, a8
    v_accvgpr_read_b32 v45, a9
    v_accvgpr_read_b32 v46, a10
    v_accvgpr_read_b32 v47, a11
    v_accvgpr_read_b32 v48, a24
    v_accvgpr_read_b32 v49, a25
    v_accvgpr_read_b32 v50, a26
    v_accvgpr_read_b32 v51, a27
    v_cvt_pk_bf16_f32 v52, v44, v45
    v_cvt_pk_bf16_f32 v53, v46, v47
    v_cvt_pk_bf16_f32 v54, v48, v49
    v_cvt_pk_bf16_f32 v55, v50, v51
    ds_write_b128 v41, v[52:55] offset:8192
    v_accvgpr_read_b32 v60, a40
    v_accvgpr_read_b32 v61, a41
    v_accvgpr_read_b32 v62, a42
    v_accvgpr_read_b32 v63, a43
    v_accvgpr_read_b32 v64, a56
    v_accvgpr_read_b32 v65, a57
    v_accvgpr_read_b32 v66, a58
    v_accvgpr_read_b32 v67, a59
    v_cvt_pk_bf16_f32 v68, v60, v61
    v_cvt_pk_bf16_f32 v69, v62, v63
    v_cvt_pk_bf16_f32 v70, v64, v65
    v_cvt_pk_bf16_f32 v71, v66, v67
    ds_write_b128 v41, v[68:71] offset:9216
    v_accvgpr_read_b32 v76, a12
    v_accvgpr_read_b32 v77, a13
    v_accvgpr_read_b32 v78, a14
    v_accvgpr_read_b32 v79, a15
    v_accvgpr_read_b32 v80, a28
    v_accvgpr_read_b32 v81, a29
    v_accvgpr_read_b32 v82, a30
    v_accvgpr_read_b32 v83, a31
    v_cvt_pk_bf16_f32 v84, v76, v77
    v_cvt_pk_bf16_f32 v85, v78, v79
    v_cvt_pk_bf16_f32 v86, v80, v81
    v_cvt_pk_bf16_f32 v87, v82, v83
    ds_write_b128 v41, v[84:87] offset:12288
    v_accvgpr_read_b32 v92, a44
    v_accvgpr_read_b32 v93, a45
    v_accvgpr_read_b32 v94, a46
    v_accvgpr_read_b32 v95, a47
    v_accvgpr_read_b32 v96, a60
    v_accvgpr_read_b32 v97, a61
    v_accvgpr_read_b32 v98, a62
    v_accvgpr_read_b32 v99, a63
    v_cvt_pk_bf16_f32 v100, v92, v93
    v_cvt_pk_bf16_f32 v101, v94, v95
    v_cvt_pk_bf16_f32 v102, v96, v97
    v_cvt_pk_bf16_f32 v103, v98, v99
    ds_write_b128 v41, v[100:103] offset:13312
    s_waitcnt lgkmcnt(0)
    s_barrier
    ds_read_b128 v[68:71], v41 offset:2048
    v_accvgpr_read_b32 v52, a64
    v_accvgpr_read_b32 v53, a65
    v_accvgpr_read_b32 v54, a66
    v_accvgpr_read_b32 v55, a67
    v_accvgpr_read_b32 v56, a80
    v_accvgpr_read_b32 v57, a81
    v_accvgpr_read_b32 v58, a82
    v_accvgpr_read_b32 v59, a83
    v_cvt_pk_bf16_f32 v76, v52, v53
    v_cvt_pk_bf16_f32 v77, v54, v55
    v_cvt_pk_bf16_f32 v78, v56, v57
    v_cvt_pk_bf16_f32 v79, v58, v59
    v_lshlrev_b32 v52, 16, v76
    v_and_b32 v53, s31, v76
    v_lshlrev_b32 v54, 16, v77
    v_and_b32 v55, s31, v77
    v_lshlrev_b32 v56, 16, v78
    v_and_b32 v57, s31, v78
    v_lshlrev_b32 v58, 16, v79
    v_and_b32 v59, s31, v79
    s_waitcnt lgkmcnt(0)
    v_lshlrev_b32 v44, 16, v68
    v_and_b32 v45, s31, v68
    v_lshlrev_b32 v46, 16, v69
    v_and_b32 v47, s31, v69
    v_lshlrev_b32 v48, 16, v70
    v_and_b32 v49, s31, v70
    v_lshlrev_b32 v50, 16, v71
    v_and_b32 v51, s31, v71
    v_mul_f32 v60, s30, v44
    v_mul_f32 v61, s30, v45
    v_mul_f32 v62, s30, v46
    v_mul_f32 v63, s30, v47
    v_mul_f32 v64, s30, v48
    v_mul_f32 v65, s30, v49
    v_mul_f32 v66, s30, v50
    v_mul_f32 v67, s30, v51
    v_exp_f32 v60, v60
    v_exp_f32 v61, v61
    v_exp_f32 v62, v62
    v_exp_f32 v63, v63
    v_exp_f32 v64, v64
    v_exp_f32 v65, v65
    v_exp_f32 v66, v66
    v_exp_f32 v67, v67
    v_add_f32 v60, 1.0, v60
    v_add_f32 v61, 1.0, v61
    v_add_f32 v62, 1.0, v62
    v_add_f32 v63, 1.0, v63
    v_add_f32 v64, 1.0, v64
    v_add_f32 v65, 1.0, v65
    v_add_f32 v66, 1.0, v66
    v_add_f32 v67, 1.0, v67
    v_rcp_f32 v60, v60
    v_rcp_f32 v61, v61
    v_rcp_f32 v62, v62
    v_rcp_f32 v63, v63
    v_rcp_f32 v64, v64
    v_rcp_f32 v65, v65
    v_rcp_f32 v66, v66
    v_rcp_f32 v67, v67
    s_nop 0
    v_cvt_pk_bf16_f32 v68, v60, v61
    v_cvt_pk_bf16_f32 v69, v62, v63
    v_cvt_pk_bf16_f32 v70, v64, v65
    v_cvt_pk_bf16_f32 v71, v66, v67
    v_lshlrev_b32 v60, 16, v68
    v_and_b32 v61, s31, v68
    v_lshlrev_b32 v62, 16, v69
    v_and_b32 v63, s31, v69
    v_lshlrev_b32 v64, 16, v70
    v_and_b32 v65, s31, v70
    v_lshlrev_b32 v66, 16, v71
    v_and_b32 v67, s31, v71
    v_mul_f32 v60, v60, v52
    v_mul_f32 v61, v61, v53
    v_mul_f32 v62, v62, v54
    v_mul_f32 v63, v63, v55
    v_mul_f32 v64, v64, v56
    v_mul_f32 v65, v65, v57
    v_mul_f32 v66, v66, v58
    v_mul_f32 v67, v67, v59
    v_cvt_pk_bf16_f32 v76, v60, v61
    v_cvt_pk_bf16_f32 v77, v62, v63
    v_cvt_pk_bf16_f32 v78, v64, v65
    v_cvt_pk_bf16_f32 v79, v66, v67
    s_mov_b32 s29, 128
    buffer_store_dwordx4 v[76:79], v39, s[16:19], s29 offen
    ds_read_b64 v[108:109], v41 offset:3072
    v_accvgpr_read_b32 v92, a96
    v_accvgpr_read_b32 v93, a97
    v_accvgpr_read_b32 v94, a98
    v_accvgpr_read_b32 v95, a99
    v_cvt_pk_bf16_f32 v116, v92, v93
    v_cvt_pk_bf16_f32 v117, v94, v95
    v_lshlrev_b32 v92, 16, v116
    v_and_b32 v93, s31, v116
    v_lshlrev_b32 v94, 16, v117
    v_and_b32 v95, s31, v117
    s_waitcnt lgkmcnt(0)
    v_lshlrev_b32 v84, 16, v108
    v_and_b32 v85, s31, v108
    v_lshlrev_b32 v86, 16, v109
    v_and_b32 v87, s31, v109
    v_mul_f32 v100, s30, v84
    v_mul_f32 v101, s30, v85
    v_mul_f32 v102, s30, v86
    v_mul_f32 v103, s30, v87
    v_exp_f32 v100, v100
    v_exp_f32 v101, v101
    v_exp_f32 v102, v102
    v_exp_f32 v103, v103
    v_add_f32 v100, 1.0, v100
    v_add_f32 v101, 1.0, v101
    v_add_f32 v102, 1.0, v102
    v_add_f32 v103, 1.0, v103
    v_rcp_f32 v100, v100
    v_rcp_f32 v101, v101
    v_rcp_f32 v102, v102
    v_rcp_f32 v103, v103
    s_nop 0
    v_cvt_pk_bf16_f32 v108, v100, v101
    v_cvt_pk_bf16_f32 v109, v102, v103
    v_lshlrev_b32 v100, 16, v108
    v_and_b32 v101, s31, v108
    v_lshlrev_b32 v102, 16, v109
    v_and_b32 v103, s31, v109
    v_mul_f32 v100, v100, v92
    v_mul_f32 v101, v101, v93
    v_mul_f32 v102, v102, v94
    v_mul_f32 v103, v103, v95
    v_cvt_pk_bf16_f32 v116, v100, v101
    v_cvt_pk_bf16_f32 v117, v102, v103
    s_mov_b32 s29, 192
    buffer_store_dwordx2 v[116:117], v40, s[16:19], s29 offen
    ds_read_b128 v[68:71], v41 offset:6144
    v_accvgpr_read_b32 v52, a68
    v_accvgpr_read_b32 v53, a69
    v_accvgpr_read_b32 v54, a70
    v_accvgpr_read_b32 v55, a71
    v_accvgpr_read_b32 v56, a84
    v_accvgpr_read_b32 v57, a85
    v_accvgpr_read_b32 v58, a86
    v_accvgpr_read_b32 v59, a87
    v_cvt_pk_bf16_f32 v76, v52, v53
    v_cvt_pk_bf16_f32 v77, v54, v55
    v_cvt_pk_bf16_f32 v78, v56, v57
    v_cvt_pk_bf16_f32 v79, v58, v59
    v_lshlrev_b32 v52, 16, v76
    v_and_b32 v53, s31, v76
    v_lshlrev_b32 v54, 16, v77
    v_and_b32 v55, s31, v77
    v_lshlrev_b32 v56, 16, v78
    v_and_b32 v57, s31, v78
    v_lshlrev_b32 v58, 16, v79
    v_and_b32 v59, s31, v79
    s_waitcnt lgkmcnt(0)
    v_lshlrev_b32 v44, 16, v68
    v_and_b32 v45, s31, v68
    v_lshlrev_b32 v46, 16, v69
    v_and_b32 v47, s31, v69
    v_lshlrev_b32 v48, 16, v70
    v_and_b32 v49, s31, v70
    v_lshlrev_b32 v50, 16, v71
    v_and_b32 v51, s31, v71
    v_mul_f32 v60, s30, v44
    v_mul_f32 v61, s30, v45
    v_mul_f32 v62, s30, v46
    v_mul_f32 v63, s30, v47
    v_mul_f32 v64, s30, v48
    v_mul_f32 v65, s30, v49
    v_mul_f32 v66, s30, v50
    v_mul_f32 v67, s30, v51
    v_exp_f32 v60, v60
    v_exp_f32 v61, v61
    v_exp_f32 v62, v62
    v_exp_f32 v63, v63
    v_exp_f32 v64, v64
    v_exp_f32 v65, v65
    v_exp_f32 v66, v66
    v_exp_f32 v67, v67
    v_add_f32 v60, 1.0, v60
    v_add_f32 v61, 1.0, v61
    v_add_f32 v62, 1.0, v62
    v_add_f32 v63, 1.0, v63
    v_add_f32 v64, 1.0, v64
    v_add_f32 v65, 1.0, v65
    v_add_f32 v66, 1.0, v66
    v_add_f32 v67, 1.0, v67
    v_rcp_f32 v60, v60
    v_rcp_f32 v61, v61
    v_rcp_f32 v62, v62
    v_rcp_f32 v63, v63
    v_rcp_f32 v64, v64
    v_rcp_f32 v65, v65
    v_rcp_f32 v66, v66
    v_rcp_f32 v67, v67
    s_nop 0
    v_cvt_pk_bf16_f32 v68, v60, v61
    v_cvt_pk_bf16_f32 v69, v62, v63
    v_cvt_pk_bf16_f32 v70, v64, v65
    v_cvt_pk_bf16_f32 v71, v66, v67
    v_lshlrev_b32 v60, 16, v68
    v_and_b32 v61, s31, v68
    v_lshlrev_b32 v62, 16, v69
    v_and_b32 v63, s31, v69
    v_lshlrev_b32 v64, 16, v70
    v_and_b32 v65, s31, v70
    v_lshlrev_b32 v66, 16, v71
    v_and_b32 v67, s31, v71
    v_mul_f32 v60, v60, v52
    v_mul_f32 v61, v61, v53
    v_mul_f32 v62, v62, v54
    v_mul_f32 v63, v63, v55
    v_mul_f32 v64, v64, v56
    v_mul_f32 v65, v65, v57
    v_mul_f32 v66, v66, v58
    v_mul_f32 v67, v67, v59
    v_cvt_pk_bf16_f32 v76, v60, v61
    v_cvt_pk_bf16_f32 v77, v62, v63
    v_cvt_pk_bf16_f32 v78, v64, v65
    v_cvt_pk_bf16_f32 v79, v66, v67
    s_mov_b32 s29, 114816
    buffer_store_dwordx4 v[76:79], v39, s[16:19], s29 offen
    ds_read_b64 v[108:109], v41 offset:7168
    v_accvgpr_read_b32 v92, a100
    v_accvgpr_read_b32 v93, a101
    v_accvgpr_read_b32 v94, a102
    v_accvgpr_read_b32 v95, a103
    v_cvt_pk_bf16_f32 v116, v92, v93
    v_cvt_pk_bf16_f32 v117, v94, v95
    v_lshlrev_b32 v92, 16, v116
    v_and_b32 v93, s31, v116
    v_lshlrev_b32 v94, 16, v117
    v_and_b32 v95, s31, v117
    s_waitcnt lgkmcnt(0)
    v_lshlrev_b32 v84, 16, v108
    v_and_b32 v85, s31, v108
    v_lshlrev_b32 v86, 16, v109
    v_and_b32 v87, s31, v109
    v_mul_f32 v100, s30, v84
    v_mul_f32 v101, s30, v85
    v_mul_f32 v102, s30, v86
    v_mul_f32 v103, s30, v87
    v_exp_f32 v100, v100
    v_exp_f32 v101, v101
    v_exp_f32 v102, v102
    v_exp_f32 v103, v103
    v_add_f32 v100, 1.0, v100
    v_add_f32 v101, 1.0, v101
    v_add_f32 v102, 1.0, v102
    v_add_f32 v103, 1.0, v103
    v_rcp_f32 v100, v100
    v_rcp_f32 v101, v101
    v_rcp_f32 v102, v102
    v_rcp_f32 v103, v103
    s_nop 0
    v_cvt_pk_bf16_f32 v108, v100, v101
    v_cvt_pk_bf16_f32 v109, v102, v103
    v_lshlrev_b32 v100, 16, v108
    v_and_b32 v101, s31, v108
    v_lshlrev_b32 v102, 16, v109
    v_and_b32 v103, s31, v109
    v_mul_f32 v100, v100, v92
    v_mul_f32 v101, v101, v93
    v_mul_f32 v102, v102, v94
    v_mul_f32 v103, v103, v95
    v_cvt_pk_bf16_f32 v116, v100, v101
    v_cvt_pk_bf16_f32 v117, v102, v103
    s_mov_b32 s29, 114880
    buffer_store_dwordx2 v[116:117], v40, s[16:19], s29 offen
    ds_read_b128 v[68:71], v41 offset:10240
    v_accvgpr_read_b32 v52, a72
    v_accvgpr_read_b32 v53, a73
    v_accvgpr_read_b32 v54, a74
    v_accvgpr_read_b32 v55, a75
    v_accvgpr_read_b32 v56, a88
    v_accvgpr_read_b32 v57, a89
    v_accvgpr_read_b32 v58, a90
    v_accvgpr_read_b32 v59, a91
    v_cvt_pk_bf16_f32 v76, v52, v53
    v_cvt_pk_bf16_f32 v77, v54, v55
    v_cvt_pk_bf16_f32 v78, v56, v57
    v_cvt_pk_bf16_f32 v79, v58, v59
    v_lshlrev_b32 v52, 16, v76
    v_and_b32 v53, s31, v76
    v_lshlrev_b32 v54, 16, v77
    v_and_b32 v55, s31, v77
    v_lshlrev_b32 v56, 16, v78
    v_and_b32 v57, s31, v78
    v_lshlrev_b32 v58, 16, v79
    v_and_b32 v59, s31, v79
    s_waitcnt lgkmcnt(0)
    v_lshlrev_b32 v44, 16, v68
    v_and_b32 v45, s31, v68
    v_lshlrev_b32 v46, 16, v69
    v_and_b32 v47, s31, v69
    v_lshlrev_b32 v48, 16, v70
    v_and_b32 v49, s31, v70
    v_lshlrev_b32 v50, 16, v71
    v_and_b32 v51, s31, v71
    v_mul_f32 v60, s30, v44
    v_mul_f32 v61, s30, v45
    v_mul_f32 v62, s30, v46
    v_mul_f32 v63, s30, v47
    v_mul_f32 v64, s30, v48
    v_mul_f32 v65, s30, v49
    v_mul_f32 v66, s30, v50
    v_mul_f32 v67, s30, v51
    v_exp_f32 v60, v60
    v_exp_f32 v61, v61
    v_exp_f32 v62, v62
    v_exp_f32 v63, v63
    v_exp_f32 v64, v64
    v_exp_f32 v65, v65
    v_exp_f32 v66, v66
    v_exp_f32 v67, v67
    v_add_f32 v60, 1.0, v60
    v_add_f32 v61, 1.0, v61
    v_add_f32 v62, 1.0, v62
    v_add_f32 v63, 1.0, v63
    v_add_f32 v64, 1.0, v64
    v_add_f32 v65, 1.0, v65
    v_add_f32 v66, 1.0, v66
    v_add_f32 v67, 1.0, v67
    v_rcp_f32 v60, v60
    v_rcp_f32 v61, v61
    v_rcp_f32 v62, v62
    v_rcp_f32 v63, v63
    v_rcp_f32 v64, v64
    v_rcp_f32 v65, v65
    v_rcp_f32 v66, v66
    v_rcp_f32 v67, v67
    s_nop 0
    v_cvt_pk_bf16_f32 v68, v60, v61
    v_cvt_pk_bf16_f32 v69, v62, v63
    v_cvt_pk_bf16_f32 v70, v64, v65
    v_cvt_pk_bf16_f32 v71, v66, v67
    v_lshlrev_b32 v60, 16, v68
    v_and_b32 v61, s31, v68
    v_lshlrev_b32 v62, 16, v69
    v_and_b32 v63, s31, v69
    v_lshlrev_b32 v64, 16, v70
    v_and_b32 v65, s31, v70
    v_lshlrev_b32 v66, 16, v71
    v_and_b32 v67, s31, v71
    v_mul_f32 v60, v60, v52
    v_mul_f32 v61, v61, v53
    v_mul_f32 v62, v62, v54
    v_mul_f32 v63, v63, v55
    v_mul_f32 v64, v64, v56
    v_mul_f32 v65, v65, v57
    v_mul_f32 v66, v66, v58
    v_mul_f32 v67, v67, v59
    v_cvt_pk_bf16_f32 v76, v60, v61
    v_cvt_pk_bf16_f32 v77, v62, v63
    v_cvt_pk_bf16_f32 v78, v64, v65
    v_cvt_pk_bf16_f32 v79, v66, v67
    s_mov_b32 s29, 229504
    buffer_store_dwordx4 v[76:79], v39, s[16:19], s29 offen
    ds_read_b64 v[108:109], v41 offset:11264
    v_accvgpr_read_b32 v92, a104
    v_accvgpr_read_b32 v93, a105
    v_accvgpr_read_b32 v94, a106
    v_accvgpr_read_b32 v95, a107
    v_cvt_pk_bf16_f32 v116, v92, v93
    v_cvt_pk_bf16_f32 v117, v94, v95
    v_lshlrev_b32 v92, 16, v116
    v_and_b32 v93, s31, v116
    v_lshlrev_b32 v94, 16, v117
    v_and_b32 v95, s31, v117
    s_waitcnt lgkmcnt(0)
    v_lshlrev_b32 v84, 16, v108
    v_and_b32 v85, s31, v108
    v_lshlrev_b32 v86, 16, v109
    v_and_b32 v87, s31, v109
    v_mul_f32 v100, s30, v84
    v_mul_f32 v101, s30, v85
    v_mul_f32 v102, s30, v86
    v_mul_f32 v103, s30, v87
    v_exp_f32 v100, v100
    v_exp_f32 v101, v101
    v_exp_f32 v102, v102
    v_exp_f32 v103, v103
    v_add_f32 v100, 1.0, v100
    v_add_f32 v101, 1.0, v101
    v_add_f32 v102, 1.0, v102
    v_add_f32 v103, 1.0, v103
    v_rcp_f32 v100, v100
    v_rcp_f32 v101, v101
    v_rcp_f32 v102, v102
    v_rcp_f32 v103, v103
    s_nop 0
    v_cvt_pk_bf16_f32 v108, v100, v101
    v_cvt_pk_bf16_f32 v109, v102, v103
    v_lshlrev_b32 v100, 16, v108
    v_and_b32 v101, s31, v108
    v_lshlrev_b32 v102, 16, v109
    v_and_b32 v103, s31, v109
    v_mul_f32 v100, v100, v92
    v_mul_f32 v101, v101, v93
    v_mul_f32 v102, v102, v94
    v_mul_f32 v103, v103, v95
    v_cvt_pk_bf16_f32 v116, v100, v101
    v_cvt_pk_bf16_f32 v117, v102, v103
    s_mov_b32 s29, 229568
    buffer_store_dwordx2 v[116:117], v40, s[16:19], s29 offen
    ds_read_b128 v[68:71], v41 offset:14336
    v_accvgpr_read_b32 v52, a76
    v_accvgpr_read_b32 v53, a77
    v_accvgpr_read_b32 v54, a78
    v_accvgpr_read_b32 v55, a79
    v_accvgpr_read_b32 v56, a92
    v_accvgpr_read_b32 v57, a93
    v_accvgpr_read_b32 v58, a94
    v_accvgpr_read_b32 v59, a95
    v_cvt_pk_bf16_f32 v76, v52, v53
    v_cvt_pk_bf16_f32 v77, v54, v55
    v_cvt_pk_bf16_f32 v78, v56, v57
    v_cvt_pk_bf16_f32 v79, v58, v59
    v_lshlrev_b32 v52, 16, v76
    v_and_b32 v53, s31, v76
    v_lshlrev_b32 v54, 16, v77
    v_and_b32 v55, s31, v77
    v_lshlrev_b32 v56, 16, v78
    v_and_b32 v57, s31, v78
    v_lshlrev_b32 v58, 16, v79
    v_and_b32 v59, s31, v79
    s_waitcnt lgkmcnt(0)
    v_lshlrev_b32 v44, 16, v68
    v_and_b32 v45, s31, v68
    v_lshlrev_b32 v46, 16, v69
    v_and_b32 v47, s31, v69
    v_lshlrev_b32 v48, 16, v70
    v_and_b32 v49, s31, v70
    v_lshlrev_b32 v50, 16, v71
    v_and_b32 v51, s31, v71
    v_mul_f32 v60, s30, v44
    v_mul_f32 v61, s30, v45
    v_mul_f32 v62, s30, v46
    v_mul_f32 v63, s30, v47
    v_mul_f32 v64, s30, v48
    v_mul_f32 v65, s30, v49
    v_mul_f32 v66, s30, v50
    v_mul_f32 v67, s30, v51
    v_exp_f32 v60, v60
    v_exp_f32 v61, v61
    v_exp_f32 v62, v62
    v_exp_f32 v63, v63
    v_exp_f32 v64, v64
    v_exp_f32 v65, v65
    v_exp_f32 v66, v66
    v_exp_f32 v67, v67
    v_add_f32 v60, 1.0, v60
    v_add_f32 v61, 1.0, v61
    v_add_f32 v62, 1.0, v62
    v_add_f32 v63, 1.0, v63
    v_add_f32 v64, 1.0, v64
    v_add_f32 v65, 1.0, v65
    v_add_f32 v66, 1.0, v66
    v_add_f32 v67, 1.0, v67
    v_rcp_f32 v60, v60
    v_rcp_f32 v61, v61
    v_rcp_f32 v62, v62
    v_rcp_f32 v63, v63
    v_rcp_f32 v64, v64
    v_rcp_f32 v65, v65
    v_rcp_f32 v66, v66
    v_rcp_f32 v67, v67
    s_nop 0
    v_cvt_pk_bf16_f32 v68, v60, v61
    v_cvt_pk_bf16_f32 v69, v62, v63
    v_cvt_pk_bf16_f32 v70, v64, v65
    v_cvt_pk_bf16_f32 v71, v66, v67
    v_lshlrev_b32 v60, 16, v68
    v_and_b32 v61, s31, v68
    v_lshlrev_b32 v62, 16, v69
    v_and_b32 v63, s31, v69
    v_lshlrev_b32 v64, 16, v70
    v_and_b32 v65, s31, v70
    v_lshlrev_b32 v66, 16, v71
    v_and_b32 v67, s31, v71
    v_mul_f32 v60, v60, v52
    v_mul_f32 v61, v61, v53
    v_mul_f32 v62, v62, v54
    v_mul_f32 v63, v63, v55
    v_mul_f32 v64, v64, v56
    v_mul_f32 v65, v65, v57
    v_mul_f32 v66, v66, v58
    v_mul_f32 v67, v67, v59
    v_cvt_pk_bf16_f32 v76, v60, v61
    v_cvt_pk_bf16_f32 v77, v62, v63
    v_cvt_pk_bf16_f32 v78, v64, v65
    v_cvt_pk_bf16_f32 v79, v66, v67
    s_mov_b32 s29, 344192
    buffer_store_dwordx4 v[76:79], v39, s[16:19], s29 offen
    ds_read_b64 v[108:109], v41 offset:15360
    v_accvgpr_read_b32 v92, a108
    v_accvgpr_read_b32 v93, a109
    v_accvgpr_read_b32 v94, a110
    v_accvgpr_read_b32 v95, a111
    v_cvt_pk_bf16_f32 v116, v92, v93
    v_cvt_pk_bf16_f32 v117, v94, v95
    v_lshlrev_b32 v92, 16, v116
    v_and_b32 v93, s31, v116
    v_lshlrev_b32 v94, 16, v117
    v_and_b32 v95, s31, v117
    s_waitcnt lgkmcnt(0)
    v_lshlrev_b32 v84, 16, v108
    v_and_b32 v85, s31, v108
    v_lshlrev_b32 v86, 16, v109
    v_and_b32 v87, s31, v109
    v_mul_f32 v100, s30, v84
    v_mul_f32 v101, s30, v85
    v_mul_f32 v102, s30, v86
    v_mul_f32 v103, s30, v87
    v_exp_f32 v100, v100
    v_exp_f32 v101, v101
    v_exp_f32 v102, v102
    v_exp_f32 v103, v103
    v_add_f32 v100, 1.0, v100
    v_add_f32 v101, 1.0, v101
    v_add_f32 v102, 1.0, v102
    v_add_f32 v103, 1.0, v103
    v_rcp_f32 v100, v100
    v_rcp_f32 v101, v101
    v_rcp_f32 v102, v102
    v_rcp_f32 v103, v103
    s_nop 0
    v_cvt_pk_bf16_f32 v108, v100, v101
    v_cvt_pk_bf16_f32 v109, v102, v103
    v_lshlrev_b32 v100, 16, v108
    v_and_b32 v101, s31, v108
    v_lshlrev_b32 v102, 16, v109
    v_and_b32 v103, s31, v109
    v_mul_f32 v100, v100, v92
    v_mul_f32 v101, v101, v93
    v_mul_f32 v102, v102, v94
    v_mul_f32 v103, v103, v95
    v_cvt_pk_bf16_f32 v116, v100, v101
    v_cvt_pk_bf16_f32 v117, v102, v103
    s_mov_b32 s29, 344256
    buffer_store_dwordx2 v[116:117], v40, s[16:19], s29 offen
    s_branch gemm_b1_kernel_end
gemm_b1_kernel_gate:
    v_accvgpr_read_b32 v44, a64
    v_accvgpr_read_b32 v45, a65
    v_accvgpr_read_b32 v46, a66
    v_accvgpr_read_b32 v47, a67
    v_accvgpr_read_b32 v48, a80
    v_accvgpr_read_b32 v49, a81
    v_accvgpr_read_b32 v50, a82
    v_accvgpr_read_b32 v51, a83
    v_cvt_pk_bf16_f32 v52, v44, v45
    v_cvt_pk_bf16_f32 v53, v46, v47
    v_cvt_pk_bf16_f32 v54, v48, v49
    v_cvt_pk_bf16_f32 v55, v50, v51
    ds_write_b128 v41, v[52:55] offset:2048
    v_accvgpr_read_b32 v60, a96
    v_accvgpr_read_b32 v61, a97
    v_accvgpr_read_b32 v62, a98
    v_accvgpr_read_b32 v63, a99
    v_cvt_pk_bf16_f32 v68, v60, v61
    v_cvt_pk_bf16_f32 v69, v62, v63
    ds_write_b64 v41, v[68:69] offset:3072
    v_accvgpr_read_b32 v76, a68
    v_accvgpr_read_b32 v77, a69
    v_accvgpr_read_b32 v78, a70
    v_accvgpr_read_b32 v79, a71
    v_accvgpr_read_b32 v80, a84
    v_accvgpr_read_b32 v81, a85
    v_accvgpr_read_b32 v82, a86
    v_accvgpr_read_b32 v83, a87
    v_cvt_pk_bf16_f32 v84, v76, v77
    v_cvt_pk_bf16_f32 v85, v78, v79
    v_cvt_pk_bf16_f32 v86, v80, v81
    v_cvt_pk_bf16_f32 v87, v82, v83
    ds_write_b128 v41, v[84:87] offset:6144
    v_accvgpr_read_b32 v92, a100
    v_accvgpr_read_b32 v93, a101
    v_accvgpr_read_b32 v94, a102
    v_accvgpr_read_b32 v95, a103
    v_cvt_pk_bf16_f32 v100, v92, v93
    v_cvt_pk_bf16_f32 v101, v94, v95
    ds_write_b64 v41, v[100:101] offset:7168
    v_accvgpr_read_b32 v44, a72
    v_accvgpr_read_b32 v45, a73
    v_accvgpr_read_b32 v46, a74
    v_accvgpr_read_b32 v47, a75
    v_accvgpr_read_b32 v48, a88
    v_accvgpr_read_b32 v49, a89
    v_accvgpr_read_b32 v50, a90
    v_accvgpr_read_b32 v51, a91
    v_cvt_pk_bf16_f32 v52, v44, v45
    v_cvt_pk_bf16_f32 v53, v46, v47
    v_cvt_pk_bf16_f32 v54, v48, v49
    v_cvt_pk_bf16_f32 v55, v50, v51
    ds_write_b128 v41, v[52:55] offset:10240
    v_accvgpr_read_b32 v60, a104
    v_accvgpr_read_b32 v61, a105
    v_accvgpr_read_b32 v62, a106
    v_accvgpr_read_b32 v63, a107
    v_cvt_pk_bf16_f32 v68, v60, v61
    v_cvt_pk_bf16_f32 v69, v62, v63
    ds_write_b64 v41, v[68:69] offset:11264
    v_accvgpr_read_b32 v76, a76
    v_accvgpr_read_b32 v77, a77
    v_accvgpr_read_b32 v78, a78
    v_accvgpr_read_b32 v79, a79
    v_accvgpr_read_b32 v80, a92
    v_accvgpr_read_b32 v81, a93
    v_accvgpr_read_b32 v82, a94
    v_accvgpr_read_b32 v83, a95
    v_cvt_pk_bf16_f32 v84, v76, v77
    v_cvt_pk_bf16_f32 v85, v78, v79
    v_cvt_pk_bf16_f32 v86, v80, v81
    v_cvt_pk_bf16_f32 v87, v82, v83
    ds_write_b128 v41, v[84:87] offset:14336
    v_accvgpr_read_b32 v92, a108
    v_accvgpr_read_b32 v93, a109
    v_accvgpr_read_b32 v94, a110
    v_accvgpr_read_b32 v95, a111
    v_cvt_pk_bf16_f32 v100, v92, v93
    v_cvt_pk_bf16_f32 v101, v94, v95
    ds_write_b64 v41, v[100:101] offset:15360
    s_waitcnt lgkmcnt(0)
    s_barrier
    ds_read_b128 v[68:71], v41 offset:0
    v_accvgpr_read_b32 v44, a0
    v_accvgpr_read_b32 v45, a1
    v_accvgpr_read_b32 v46, a2
    v_accvgpr_read_b32 v47, a3
    v_accvgpr_read_b32 v48, a16
    v_accvgpr_read_b32 v49, a17
    v_accvgpr_read_b32 v50, a18
    v_accvgpr_read_b32 v51, a19
    v_cvt_pk_bf16_f32 v76, v44, v45
    v_cvt_pk_bf16_f32 v77, v46, v47
    v_cvt_pk_bf16_f32 v78, v48, v49
    v_cvt_pk_bf16_f32 v79, v50, v51
    v_lshlrev_b32 v44, 16, v76
    v_and_b32 v45, s31, v76
    v_lshlrev_b32 v46, 16, v77
    v_and_b32 v47, s31, v77
    v_lshlrev_b32 v48, 16, v78
    v_and_b32 v49, s31, v78
    v_lshlrev_b32 v50, 16, v79
    v_and_b32 v51, s31, v79
    s_waitcnt lgkmcnt(0)
    v_lshlrev_b32 v52, 16, v68
    v_and_b32 v53, s31, v68
    v_lshlrev_b32 v54, 16, v69
    v_and_b32 v55, s31, v69
    v_lshlrev_b32 v56, 16, v70
    v_and_b32 v57, s31, v70
    v_lshlrev_b32 v58, 16, v71
    v_and_b32 v59, s31, v71
    v_mul_f32 v60, s30, v44
    v_mul_f32 v61, s30, v45
    v_mul_f32 v62, s30, v46
    v_mul_f32 v63, s30, v47
    v_mul_f32 v64, s30, v48
    v_mul_f32 v65, s30, v49
    v_mul_f32 v66, s30, v50
    v_mul_f32 v67, s30, v51
    v_exp_f32 v60, v60
    v_exp_f32 v61, v61
    v_exp_f32 v62, v62
    v_exp_f32 v63, v63
    v_exp_f32 v64, v64
    v_exp_f32 v65, v65
    v_exp_f32 v66, v66
    v_exp_f32 v67, v67
    v_add_f32 v60, 1.0, v60
    v_add_f32 v61, 1.0, v61
    v_add_f32 v62, 1.0, v62
    v_add_f32 v63, 1.0, v63
    v_add_f32 v64, 1.0, v64
    v_add_f32 v65, 1.0, v65
    v_add_f32 v66, 1.0, v66
    v_add_f32 v67, 1.0, v67
    v_rcp_f32 v60, v60
    v_rcp_f32 v61, v61
    v_rcp_f32 v62, v62
    v_rcp_f32 v63, v63
    v_rcp_f32 v64, v64
    v_rcp_f32 v65, v65
    v_rcp_f32 v66, v66
    v_rcp_f32 v67, v67
    s_nop 0
    v_cvt_pk_bf16_f32 v68, v60, v61
    v_cvt_pk_bf16_f32 v69, v62, v63
    v_cvt_pk_bf16_f32 v70, v64, v65
    v_cvt_pk_bf16_f32 v71, v66, v67
    v_lshlrev_b32 v60, 16, v68
    v_and_b32 v61, s31, v68
    v_lshlrev_b32 v62, 16, v69
    v_and_b32 v63, s31, v69
    v_lshlrev_b32 v64, 16, v70
    v_and_b32 v65, s31, v70
    v_lshlrev_b32 v66, 16, v71
    v_and_b32 v67, s31, v71
    v_mul_f32 v60, v60, v52
    v_mul_f32 v61, v61, v53
    v_mul_f32 v62, v62, v54
    v_mul_f32 v63, v63, v55
    v_mul_f32 v64, v64, v56
    v_mul_f32 v65, v65, v57
    v_mul_f32 v66, v66, v58
    v_mul_f32 v67, v67, v59
    v_cvt_pk_bf16_f32 v76, v60, v61
    v_cvt_pk_bf16_f32 v77, v62, v63
    v_cvt_pk_bf16_f32 v78, v64, v65
    v_cvt_pk_bf16_f32 v79, v66, v67
    s_mov_b32 s29, 0
    buffer_store_dwordx4 v[76:79], v39, s[16:19], s29 offen
    ds_read_b128 v[108:111], v41 offset:1024
    v_accvgpr_read_b32 v84, a32
    v_accvgpr_read_b32 v85, a33
    v_accvgpr_read_b32 v86, a34
    v_accvgpr_read_b32 v87, a35
    v_accvgpr_read_b32 v88, a48
    v_accvgpr_read_b32 v89, a49
    v_accvgpr_read_b32 v90, a50
    v_accvgpr_read_b32 v91, a51
    v_cvt_pk_bf16_f32 v116, v84, v85
    v_cvt_pk_bf16_f32 v117, v86, v87
    v_cvt_pk_bf16_f32 v118, v88, v89
    v_cvt_pk_bf16_f32 v119, v90, v91
    v_lshlrev_b32 v84, 16, v116
    v_and_b32 v85, s31, v116
    v_lshlrev_b32 v86, 16, v117
    v_and_b32 v87, s31, v117
    v_lshlrev_b32 v88, 16, v118
    v_and_b32 v89, s31, v118
    v_lshlrev_b32 v90, 16, v119
    v_and_b32 v91, s31, v119
    s_waitcnt lgkmcnt(0)
    v_lshlrev_b32 v92, 16, v108
    v_and_b32 v93, s31, v108
    v_lshlrev_b32 v94, 16, v109
    v_and_b32 v95, s31, v109
    v_lshlrev_b32 v96, 16, v110
    v_and_b32 v97, s31, v110
    v_lshlrev_b32 v98, 16, v111
    v_and_b32 v99, s31, v111
    v_mul_f32 v100, s30, v84
    v_mul_f32 v101, s30, v85
    v_mul_f32 v102, s30, v86
    v_mul_f32 v103, s30, v87
    v_mul_f32 v104, s30, v88
    v_mul_f32 v105, s30, v89
    v_mul_f32 v106, s30, v90
    v_mul_f32 v107, s30, v91
    v_exp_f32 v100, v100
    v_exp_f32 v101, v101
    v_exp_f32 v102, v102
    v_exp_f32 v103, v103
    v_exp_f32 v104, v104
    v_exp_f32 v105, v105
    v_exp_f32 v106, v106
    v_exp_f32 v107, v107
    v_add_f32 v100, 1.0, v100
    v_add_f32 v101, 1.0, v101
    v_add_f32 v102, 1.0, v102
    v_add_f32 v103, 1.0, v103
    v_add_f32 v104, 1.0, v104
    v_add_f32 v105, 1.0, v105
    v_add_f32 v106, 1.0, v106
    v_add_f32 v107, 1.0, v107
    v_rcp_f32 v100, v100
    v_rcp_f32 v101, v101
    v_rcp_f32 v102, v102
    v_rcp_f32 v103, v103
    v_rcp_f32 v104, v104
    v_rcp_f32 v105, v105
    v_rcp_f32 v106, v106
    v_rcp_f32 v107, v107
    s_nop 0
    v_cvt_pk_bf16_f32 v108, v100, v101
    v_cvt_pk_bf16_f32 v109, v102, v103
    v_cvt_pk_bf16_f32 v110, v104, v105
    v_cvt_pk_bf16_f32 v111, v106, v107
    v_lshlrev_b32 v100, 16, v108
    v_and_b32 v101, s31, v108
    v_lshlrev_b32 v102, 16, v109
    v_and_b32 v103, s31, v109
    v_lshlrev_b32 v104, 16, v110
    v_and_b32 v105, s31, v110
    v_lshlrev_b32 v106, 16, v111
    v_and_b32 v107, s31, v111
    v_mul_f32 v100, v100, v92
    v_mul_f32 v101, v101, v93
    v_mul_f32 v102, v102, v94
    v_mul_f32 v103, v103, v95
    v_mul_f32 v104, v104, v96
    v_mul_f32 v105, v105, v97
    v_mul_f32 v106, v106, v98
    v_mul_f32 v107, v107, v99
    v_cvt_pk_bf16_f32 v116, v100, v101
    v_cvt_pk_bf16_f32 v117, v102, v103
    v_cvt_pk_bf16_f32 v118, v104, v105
    v_cvt_pk_bf16_f32 v119, v106, v107
    s_mov_b32 s29, 64
    buffer_store_dwordx4 v[116:119], v39, s[16:19], s29 offen
    ds_read_b128 v[68:71], v41 offset:4096
    v_accvgpr_read_b32 v44, a4
    v_accvgpr_read_b32 v45, a5
    v_accvgpr_read_b32 v46, a6
    v_accvgpr_read_b32 v47, a7
    v_accvgpr_read_b32 v48, a20
    v_accvgpr_read_b32 v49, a21
    v_accvgpr_read_b32 v50, a22
    v_accvgpr_read_b32 v51, a23
    v_cvt_pk_bf16_f32 v76, v44, v45
    v_cvt_pk_bf16_f32 v77, v46, v47
    v_cvt_pk_bf16_f32 v78, v48, v49
    v_cvt_pk_bf16_f32 v79, v50, v51
    v_lshlrev_b32 v44, 16, v76
    v_and_b32 v45, s31, v76
    v_lshlrev_b32 v46, 16, v77
    v_and_b32 v47, s31, v77
    v_lshlrev_b32 v48, 16, v78
    v_and_b32 v49, s31, v78
    v_lshlrev_b32 v50, 16, v79
    v_and_b32 v51, s31, v79
    s_waitcnt lgkmcnt(0)
    v_lshlrev_b32 v52, 16, v68
    v_and_b32 v53, s31, v68
    v_lshlrev_b32 v54, 16, v69
    v_and_b32 v55, s31, v69
    v_lshlrev_b32 v56, 16, v70
    v_and_b32 v57, s31, v70
    v_lshlrev_b32 v58, 16, v71
    v_and_b32 v59, s31, v71
    v_mul_f32 v60, s30, v44
    v_mul_f32 v61, s30, v45
    v_mul_f32 v62, s30, v46
    v_mul_f32 v63, s30, v47
    v_mul_f32 v64, s30, v48
    v_mul_f32 v65, s30, v49
    v_mul_f32 v66, s30, v50
    v_mul_f32 v67, s30, v51
    v_exp_f32 v60, v60
    v_exp_f32 v61, v61
    v_exp_f32 v62, v62
    v_exp_f32 v63, v63
    v_exp_f32 v64, v64
    v_exp_f32 v65, v65
    v_exp_f32 v66, v66
    v_exp_f32 v67, v67
    v_add_f32 v60, 1.0, v60
    v_add_f32 v61, 1.0, v61
    v_add_f32 v62, 1.0, v62
    v_add_f32 v63, 1.0, v63
    v_add_f32 v64, 1.0, v64
    v_add_f32 v65, 1.0, v65
    v_add_f32 v66, 1.0, v66
    v_add_f32 v67, 1.0, v67
    v_rcp_f32 v60, v60
    v_rcp_f32 v61, v61
    v_rcp_f32 v62, v62
    v_rcp_f32 v63, v63
    v_rcp_f32 v64, v64
    v_rcp_f32 v65, v65
    v_rcp_f32 v66, v66
    v_rcp_f32 v67, v67
    s_nop 0
    v_cvt_pk_bf16_f32 v68, v60, v61
    v_cvt_pk_bf16_f32 v69, v62, v63
    v_cvt_pk_bf16_f32 v70, v64, v65
    v_cvt_pk_bf16_f32 v71, v66, v67
    v_lshlrev_b32 v60, 16, v68
    v_and_b32 v61, s31, v68
    v_lshlrev_b32 v62, 16, v69
    v_and_b32 v63, s31, v69
    v_lshlrev_b32 v64, 16, v70
    v_and_b32 v65, s31, v70
    v_lshlrev_b32 v66, 16, v71
    v_and_b32 v67, s31, v71
    v_mul_f32 v60, v60, v52
    v_mul_f32 v61, v61, v53
    v_mul_f32 v62, v62, v54
    v_mul_f32 v63, v63, v55
    v_mul_f32 v64, v64, v56
    v_mul_f32 v65, v65, v57
    v_mul_f32 v66, v66, v58
    v_mul_f32 v67, v67, v59
    v_cvt_pk_bf16_f32 v76, v60, v61
    v_cvt_pk_bf16_f32 v77, v62, v63
    v_cvt_pk_bf16_f32 v78, v64, v65
    v_cvt_pk_bf16_f32 v79, v66, v67
    s_mov_b32 s29, 114688
    buffer_store_dwordx4 v[76:79], v39, s[16:19], s29 offen
    ds_read_b128 v[108:111], v41 offset:5120
    v_accvgpr_read_b32 v84, a36
    v_accvgpr_read_b32 v85, a37
    v_accvgpr_read_b32 v86, a38
    v_accvgpr_read_b32 v87, a39
    v_accvgpr_read_b32 v88, a52
    v_accvgpr_read_b32 v89, a53
    v_accvgpr_read_b32 v90, a54
    v_accvgpr_read_b32 v91, a55
    v_cvt_pk_bf16_f32 v116, v84, v85
    v_cvt_pk_bf16_f32 v117, v86, v87
    v_cvt_pk_bf16_f32 v118, v88, v89
    v_cvt_pk_bf16_f32 v119, v90, v91
    v_lshlrev_b32 v84, 16, v116
    v_and_b32 v85, s31, v116
    v_lshlrev_b32 v86, 16, v117
    v_and_b32 v87, s31, v117
    v_lshlrev_b32 v88, 16, v118
    v_and_b32 v89, s31, v118
    v_lshlrev_b32 v90, 16, v119
    v_and_b32 v91, s31, v119
    s_waitcnt lgkmcnt(0)
    v_lshlrev_b32 v92, 16, v108
    v_and_b32 v93, s31, v108
    v_lshlrev_b32 v94, 16, v109
    v_and_b32 v95, s31, v109
    v_lshlrev_b32 v96, 16, v110
    v_and_b32 v97, s31, v110
    v_lshlrev_b32 v98, 16, v111
    v_and_b32 v99, s31, v111
    v_mul_f32 v100, s30, v84
    v_mul_f32 v101, s30, v85
    v_mul_f32 v102, s30, v86
    v_mul_f32 v103, s30, v87
    v_mul_f32 v104, s30, v88
    v_mul_f32 v105, s30, v89
    v_mul_f32 v106, s30, v90
    v_mul_f32 v107, s30, v91
    v_exp_f32 v100, v100
    v_exp_f32 v101, v101
    v_exp_f32 v102, v102
    v_exp_f32 v103, v103
    v_exp_f32 v104, v104
    v_exp_f32 v105, v105
    v_exp_f32 v106, v106
    v_exp_f32 v107, v107
    v_add_f32 v100, 1.0, v100
    v_add_f32 v101, 1.0, v101
    v_add_f32 v102, 1.0, v102
    v_add_f32 v103, 1.0, v103
    v_add_f32 v104, 1.0, v104
    v_add_f32 v105, 1.0, v105
    v_add_f32 v106, 1.0, v106
    v_add_f32 v107, 1.0, v107
    v_rcp_f32 v100, v100
    v_rcp_f32 v101, v101
    v_rcp_f32 v102, v102
    v_rcp_f32 v103, v103
    v_rcp_f32 v104, v104
    v_rcp_f32 v105, v105
    v_rcp_f32 v106, v106
    v_rcp_f32 v107, v107
    s_nop 0
    v_cvt_pk_bf16_f32 v108, v100, v101
    v_cvt_pk_bf16_f32 v109, v102, v103
    v_cvt_pk_bf16_f32 v110, v104, v105
    v_cvt_pk_bf16_f32 v111, v106, v107
    v_lshlrev_b32 v100, 16, v108
    v_and_b32 v101, s31, v108
    v_lshlrev_b32 v102, 16, v109
    v_and_b32 v103, s31, v109
    v_lshlrev_b32 v104, 16, v110
    v_and_b32 v105, s31, v110
    v_lshlrev_b32 v106, 16, v111
    v_and_b32 v107, s31, v111
    v_mul_f32 v100, v100, v92
    v_mul_f32 v101, v101, v93
    v_mul_f32 v102, v102, v94
    v_mul_f32 v103, v103, v95
    v_mul_f32 v104, v104, v96
    v_mul_f32 v105, v105, v97
    v_mul_f32 v106, v106, v98
    v_mul_f32 v107, v107, v99
    v_cvt_pk_bf16_f32 v116, v100, v101
    v_cvt_pk_bf16_f32 v117, v102, v103
    v_cvt_pk_bf16_f32 v118, v104, v105
    v_cvt_pk_bf16_f32 v119, v106, v107
    s_mov_b32 s29, 114752
    buffer_store_dwordx4 v[116:119], v39, s[16:19], s29 offen
    ds_read_b128 v[68:71], v41 offset:8192
    v_accvgpr_read_b32 v44, a8
    v_accvgpr_read_b32 v45, a9
    v_accvgpr_read_b32 v46, a10
    v_accvgpr_read_b32 v47, a11
    v_accvgpr_read_b32 v48, a24
    v_accvgpr_read_b32 v49, a25
    v_accvgpr_read_b32 v50, a26
    v_accvgpr_read_b32 v51, a27
    v_cvt_pk_bf16_f32 v76, v44, v45
    v_cvt_pk_bf16_f32 v77, v46, v47
    v_cvt_pk_bf16_f32 v78, v48, v49
    v_cvt_pk_bf16_f32 v79, v50, v51
    v_lshlrev_b32 v44, 16, v76
    v_and_b32 v45, s31, v76
    v_lshlrev_b32 v46, 16, v77
    v_and_b32 v47, s31, v77
    v_lshlrev_b32 v48, 16, v78
    v_and_b32 v49, s31, v78
    v_lshlrev_b32 v50, 16, v79
    v_and_b32 v51, s31, v79
    s_waitcnt lgkmcnt(0)
    v_lshlrev_b32 v52, 16, v68
    v_and_b32 v53, s31, v68
    v_lshlrev_b32 v54, 16, v69
    v_and_b32 v55, s31, v69
    v_lshlrev_b32 v56, 16, v70
    v_and_b32 v57, s31, v70
    v_lshlrev_b32 v58, 16, v71
    v_and_b32 v59, s31, v71
    v_mul_f32 v60, s30, v44
    v_mul_f32 v61, s30, v45
    v_mul_f32 v62, s30, v46
    v_mul_f32 v63, s30, v47
    v_mul_f32 v64, s30, v48
    v_mul_f32 v65, s30, v49
    v_mul_f32 v66, s30, v50
    v_mul_f32 v67, s30, v51
    v_exp_f32 v60, v60
    v_exp_f32 v61, v61
    v_exp_f32 v62, v62
    v_exp_f32 v63, v63
    v_exp_f32 v64, v64
    v_exp_f32 v65, v65
    v_exp_f32 v66, v66
    v_exp_f32 v67, v67
    v_add_f32 v60, 1.0, v60
    v_add_f32 v61, 1.0, v61
    v_add_f32 v62, 1.0, v62
    v_add_f32 v63, 1.0, v63
    v_add_f32 v64, 1.0, v64
    v_add_f32 v65, 1.0, v65
    v_add_f32 v66, 1.0, v66
    v_add_f32 v67, 1.0, v67
    v_rcp_f32 v60, v60
    v_rcp_f32 v61, v61
    v_rcp_f32 v62, v62
    v_rcp_f32 v63, v63
    v_rcp_f32 v64, v64
    v_rcp_f32 v65, v65
    v_rcp_f32 v66, v66
    v_rcp_f32 v67, v67
    s_nop 0
    v_cvt_pk_bf16_f32 v68, v60, v61
    v_cvt_pk_bf16_f32 v69, v62, v63
    v_cvt_pk_bf16_f32 v70, v64, v65
    v_cvt_pk_bf16_f32 v71, v66, v67
    v_lshlrev_b32 v60, 16, v68
    v_and_b32 v61, s31, v68
    v_lshlrev_b32 v62, 16, v69
    v_and_b32 v63, s31, v69
    v_lshlrev_b32 v64, 16, v70
    v_and_b32 v65, s31, v70
    v_lshlrev_b32 v66, 16, v71
    v_and_b32 v67, s31, v71
    v_mul_f32 v60, v60, v52
    v_mul_f32 v61, v61, v53
    v_mul_f32 v62, v62, v54
    v_mul_f32 v63, v63, v55
    v_mul_f32 v64, v64, v56
    v_mul_f32 v65, v65, v57
    v_mul_f32 v66, v66, v58
    v_mul_f32 v67, v67, v59
    v_cvt_pk_bf16_f32 v76, v60, v61
    v_cvt_pk_bf16_f32 v77, v62, v63
    v_cvt_pk_bf16_f32 v78, v64, v65
    v_cvt_pk_bf16_f32 v79, v66, v67
    s_mov_b32 s29, 229376
    buffer_store_dwordx4 v[76:79], v39, s[16:19], s29 offen
    ds_read_b128 v[108:111], v41 offset:9216
    v_accvgpr_read_b32 v84, a40
    v_accvgpr_read_b32 v85, a41
    v_accvgpr_read_b32 v86, a42
    v_accvgpr_read_b32 v87, a43
    v_accvgpr_read_b32 v88, a56
    v_accvgpr_read_b32 v89, a57
    v_accvgpr_read_b32 v90, a58
    v_accvgpr_read_b32 v91, a59
    v_cvt_pk_bf16_f32 v116, v84, v85
    v_cvt_pk_bf16_f32 v117, v86, v87
    v_cvt_pk_bf16_f32 v118, v88, v89
    v_cvt_pk_bf16_f32 v119, v90, v91
    v_lshlrev_b32 v84, 16, v116
    v_and_b32 v85, s31, v116
    v_lshlrev_b32 v86, 16, v117
    v_and_b32 v87, s31, v117
    v_lshlrev_b32 v88, 16, v118
    v_and_b32 v89, s31, v118
    v_lshlrev_b32 v90, 16, v119
    v_and_b32 v91, s31, v119
    s_waitcnt lgkmcnt(0)
    v_lshlrev_b32 v92, 16, v108
    v_and_b32 v93, s31, v108
    v_lshlrev_b32 v94, 16, v109
    v_and_b32 v95, s31, v109
    v_lshlrev_b32 v96, 16, v110
    v_and_b32 v97, s31, v110
    v_lshlrev_b32 v98, 16, v111
    v_and_b32 v99, s31, v111
    v_mul_f32 v100, s30, v84
    v_mul_f32 v101, s30, v85
    v_mul_f32 v102, s30, v86
    v_mul_f32 v103, s30, v87
    v_mul_f32 v104, s30, v88
    v_mul_f32 v105, s30, v89
    v_mul_f32 v106, s30, v90
    v_mul_f32 v107, s30, v91
    v_exp_f32 v100, v100
    v_exp_f32 v101, v101
    v_exp_f32 v102, v102
    v_exp_f32 v103, v103
    v_exp_f32 v104, v104
    v_exp_f32 v105, v105
    v_exp_f32 v106, v106
    v_exp_f32 v107, v107
    v_add_f32 v100, 1.0, v100
    v_add_f32 v101, 1.0, v101
    v_add_f32 v102, 1.0, v102
    v_add_f32 v103, 1.0, v103
    v_add_f32 v104, 1.0, v104
    v_add_f32 v105, 1.0, v105
    v_add_f32 v106, 1.0, v106
    v_add_f32 v107, 1.0, v107
    v_rcp_f32 v100, v100
    v_rcp_f32 v101, v101
    v_rcp_f32 v102, v102
    v_rcp_f32 v103, v103
    v_rcp_f32 v104, v104
    v_rcp_f32 v105, v105
    v_rcp_f32 v106, v106
    v_rcp_f32 v107, v107
    s_nop 0
    v_cvt_pk_bf16_f32 v108, v100, v101
    v_cvt_pk_bf16_f32 v109, v102, v103
    v_cvt_pk_bf16_f32 v110, v104, v105
    v_cvt_pk_bf16_f32 v111, v106, v107
    v_lshlrev_b32 v100, 16, v108
    v_and_b32 v101, s31, v108
    v_lshlrev_b32 v102, 16, v109
    v_and_b32 v103, s31, v109
    v_lshlrev_b32 v104, 16, v110
    v_and_b32 v105, s31, v110
    v_lshlrev_b32 v106, 16, v111
    v_and_b32 v107, s31, v111
    v_mul_f32 v100, v100, v92
    v_mul_f32 v101, v101, v93
    v_mul_f32 v102, v102, v94
    v_mul_f32 v103, v103, v95
    v_mul_f32 v104, v104, v96
    v_mul_f32 v105, v105, v97
    v_mul_f32 v106, v106, v98
    v_mul_f32 v107, v107, v99
    v_cvt_pk_bf16_f32 v116, v100, v101
    v_cvt_pk_bf16_f32 v117, v102, v103
    v_cvt_pk_bf16_f32 v118, v104, v105
    v_cvt_pk_bf16_f32 v119, v106, v107
    s_mov_b32 s29, 229440
    buffer_store_dwordx4 v[116:119], v39, s[16:19], s29 offen
    ds_read_b128 v[68:71], v41 offset:12288
    v_accvgpr_read_b32 v44, a12
    v_accvgpr_read_b32 v45, a13
    v_accvgpr_read_b32 v46, a14
    v_accvgpr_read_b32 v47, a15
    v_accvgpr_read_b32 v48, a28
    v_accvgpr_read_b32 v49, a29
    v_accvgpr_read_b32 v50, a30
    v_accvgpr_read_b32 v51, a31
    v_cvt_pk_bf16_f32 v76, v44, v45
    v_cvt_pk_bf16_f32 v77, v46, v47
    v_cvt_pk_bf16_f32 v78, v48, v49
    v_cvt_pk_bf16_f32 v79, v50, v51
    v_lshlrev_b32 v44, 16, v76
    v_and_b32 v45, s31, v76
    v_lshlrev_b32 v46, 16, v77
    v_and_b32 v47, s31, v77
    v_lshlrev_b32 v48, 16, v78
    v_and_b32 v49, s31, v78
    v_lshlrev_b32 v50, 16, v79
    v_and_b32 v51, s31, v79
    s_waitcnt lgkmcnt(0)
    v_lshlrev_b32 v52, 16, v68
    v_and_b32 v53, s31, v68
    v_lshlrev_b32 v54, 16, v69
    v_and_b32 v55, s31, v69
    v_lshlrev_b32 v56, 16, v70
    v_and_b32 v57, s31, v70
    v_lshlrev_b32 v58, 16, v71
    v_and_b32 v59, s31, v71
    v_mul_f32 v60, s30, v44
    v_mul_f32 v61, s30, v45
    v_mul_f32 v62, s30, v46
    v_mul_f32 v63, s30, v47
    v_mul_f32 v64, s30, v48
    v_mul_f32 v65, s30, v49
    v_mul_f32 v66, s30, v50
    v_mul_f32 v67, s30, v51
    v_exp_f32 v60, v60
    v_exp_f32 v61, v61
    v_exp_f32 v62, v62
    v_exp_f32 v63, v63
    v_exp_f32 v64, v64
    v_exp_f32 v65, v65
    v_exp_f32 v66, v66
    v_exp_f32 v67, v67
    v_add_f32 v60, 1.0, v60
    v_add_f32 v61, 1.0, v61
    v_add_f32 v62, 1.0, v62
    v_add_f32 v63, 1.0, v63
    v_add_f32 v64, 1.0, v64
    v_add_f32 v65, 1.0, v65
    v_add_f32 v66, 1.0, v66
    v_add_f32 v67, 1.0, v67
    v_rcp_f32 v60, v60
    v_rcp_f32 v61, v61
    v_rcp_f32 v62, v62
    v_rcp_f32 v63, v63
    v_rcp_f32 v64, v64
    v_rcp_f32 v65, v65
    v_rcp_f32 v66, v66
    v_rcp_f32 v67, v67
    s_nop 0
    v_cvt_pk_bf16_f32 v68, v60, v61
    v_cvt_pk_bf16_f32 v69, v62, v63
    v_cvt_pk_bf16_f32 v70, v64, v65
    v_cvt_pk_bf16_f32 v71, v66, v67
    v_lshlrev_b32 v60, 16, v68
    v_and_b32 v61, s31, v68
    v_lshlrev_b32 v62, 16, v69
    v_and_b32 v63, s31, v69
    v_lshlrev_b32 v64, 16, v70
    v_and_b32 v65, s31, v70
    v_lshlrev_b32 v66, 16, v71
    v_and_b32 v67, s31, v71
    v_mul_f32 v60, v60, v52
    v_mul_f32 v61, v61, v53
    v_mul_f32 v62, v62, v54
    v_mul_f32 v63, v63, v55
    v_mul_f32 v64, v64, v56
    v_mul_f32 v65, v65, v57
    v_mul_f32 v66, v66, v58
    v_mul_f32 v67, v67, v59
    v_cvt_pk_bf16_f32 v76, v60, v61
    v_cvt_pk_bf16_f32 v77, v62, v63
    v_cvt_pk_bf16_f32 v78, v64, v65
    v_cvt_pk_bf16_f32 v79, v66, v67
    s_mov_b32 s29, 344064
    buffer_store_dwordx4 v[76:79], v39, s[16:19], s29 offen
    ds_read_b128 v[108:111], v41 offset:13312
    v_accvgpr_read_b32 v84, a44
    v_accvgpr_read_b32 v85, a45
    v_accvgpr_read_b32 v86, a46
    v_accvgpr_read_b32 v87, a47
    v_accvgpr_read_b32 v88, a60
    v_accvgpr_read_b32 v89, a61
    v_accvgpr_read_b32 v90, a62
    v_accvgpr_read_b32 v91, a63
    v_cvt_pk_bf16_f32 v116, v84, v85
    v_cvt_pk_bf16_f32 v117, v86, v87
    v_cvt_pk_bf16_f32 v118, v88, v89
    v_cvt_pk_bf16_f32 v119, v90, v91
    v_lshlrev_b32 v84, 16, v116
    v_and_b32 v85, s31, v116
    v_lshlrev_b32 v86, 16, v117
    v_and_b32 v87, s31, v117
    v_lshlrev_b32 v88, 16, v118
    v_and_b32 v89, s31, v118
    v_lshlrev_b32 v90, 16, v119
    v_and_b32 v91, s31, v119
    s_waitcnt lgkmcnt(0)
    v_lshlrev_b32 v92, 16, v108
    v_and_b32 v93, s31, v108
    v_lshlrev_b32 v94, 16, v109
    v_and_b32 v95, s31, v109
    v_lshlrev_b32 v96, 16, v110
    v_and_b32 v97, s31, v110
    v_lshlrev_b32 v98, 16, v111
    v_and_b32 v99, s31, v111
    v_mul_f32 v100, s30, v84
    v_mul_f32 v101, s30, v85
    v_mul_f32 v102, s30, v86
    v_mul_f32 v103, s30, v87
    v_mul_f32 v104, s30, v88
    v_mul_f32 v105, s30, v89
    v_mul_f32 v106, s30, v90
    v_mul_f32 v107, s30, v91
    v_exp_f32 v100, v100
    v_exp_f32 v101, v101
    v_exp_f32 v102, v102
    v_exp_f32 v103, v103
    v_exp_f32 v104, v104
    v_exp_f32 v105, v105
    v_exp_f32 v106, v106
    v_exp_f32 v107, v107
    v_add_f32 v100, 1.0, v100
    v_add_f32 v101, 1.0, v101
    v_add_f32 v102, 1.0, v102
    v_add_f32 v103, 1.0, v103
    v_add_f32 v104, 1.0, v104
    v_add_f32 v105, 1.0, v105
    v_add_f32 v106, 1.0, v106
    v_add_f32 v107, 1.0, v107
    v_rcp_f32 v100, v100
    v_rcp_f32 v101, v101
    v_rcp_f32 v102, v102
    v_rcp_f32 v103, v103
    v_rcp_f32 v104, v104
    v_rcp_f32 v105, v105
    v_rcp_f32 v106, v106
    v_rcp_f32 v107, v107
    s_nop 0
    v_cvt_pk_bf16_f32 v108, v100, v101
    v_cvt_pk_bf16_f32 v109, v102, v103
    v_cvt_pk_bf16_f32 v110, v104, v105
    v_cvt_pk_bf16_f32 v111, v106, v107
    v_lshlrev_b32 v100, 16, v108
    v_and_b32 v101, s31, v108
    v_lshlrev_b32 v102, 16, v109
    v_and_b32 v103, s31, v109
    v_lshlrev_b32 v104, 16, v110
    v_and_b32 v105, s31, v110
    v_lshlrev_b32 v106, 16, v111
    v_and_b32 v107, s31, v111
    v_mul_f32 v100, v100, v92
    v_mul_f32 v101, v101, v93
    v_mul_f32 v102, v102, v94
    v_mul_f32 v103, v103, v95
    v_mul_f32 v104, v104, v96
    v_mul_f32 v105, v105, v97
    v_mul_f32 v106, v106, v98
    v_mul_f32 v107, v107, v99
    v_cvt_pk_bf16_f32 v116, v100, v101
    v_cvt_pk_bf16_f32 v117, v102, v103
    v_cvt_pk_bf16_f32 v118, v104, v105
    v_cvt_pk_bf16_f32 v119, v106, v107
    s_mov_b32 s29, 344128
    buffer_store_dwordx4 v[116:119], v39, s[16:19], s29 offen
gemm_b1_kernel_end:
    s_endpgm
.section .rodata,"a"
.p2align 6
.amdhsa_kernel gemm_b1_kernel
  .amdhsa_next_free_vgpr 244
  .amdhsa_next_free_sgpr 48
  .amdhsa_accum_offset 132
  .amdhsa_group_segment_fixed_size 0
  .amdhsa_kernarg_size 96
  .amdhsa_user_sgpr_count 2
  .amdhsa_user_sgpr_kernarg_segment_ptr 1
  .amdhsa_system_sgpr_workgroup_id_x 1
  .amdhsa_float_denorm_mode_32 3
  .amdhsa_float_denorm_mode_16_64 3
.end_amdhsa_kernel

.text
.globl gemm_b2_kernel
.p2align 8
.type gemm_b2_kernel,@function
gemm_b2_kernel:
    s_cmp_ge_u32 s2, 256
    s_cbranch_scc1 gemm_b2_kernel_end
    s_load_dwordx2 s[36:37], s[0:1], 88
    s_load_dwordx2 s[4:5], s[0:1], 64
    s_and_b32 s31, s2, 7
    s_lshr_b32 s34, s2, 3
    s_waitcnt lgkmcnt(0)
    s_and_b32 s22, s31, 1
    s_lshr_b32 s29, s31, 1
    s_lshl_b32 s29, s29, 2
    s_and_b32 s30, s34, 3
    s_add_u32 s20, s29, s30
    s_lshr_b32 s21, s34, 2
    s_add_u32 s38, s36, 25165824
    s_addc_u32 s39, s37, 0
    s_mul_i32 s29, s20, 917504
    s_mul_i32 s30, s22, 3584
    s_add_u32 s29, s29, s30
    s_add_u32 s8, s38, s29
    s_addc_u32 s9, s39, 0
    s_sub_u32 s10, 14680064, s29
    s_mov_b32 s11, 0x20000
    s_mul_i32 s29, s22, 3670016
    s_mul_i32 s30, s21, 256
    s_add_u32 s29, s29, s30
    s_add_u32 s12, s4, s29
    s_addc_u32 s13, s5, 0
    s_sub_u32 s14, 7340032, s29
    s_mov_b32 s15, 0x20000
    s_add_u32 s38, s36, 41943040
    s_addc_u32 s39, s37, 0
    s_mul_i32 s29, s22, 8388608
    s_mul_i32 s30, s20, 524288
    s_add_u32 s29, s29, s30
    s_mul_i32 s30, s21, 512
    s_add_u32 s29, s29, s30
    s_add_u32 s16, s38, s29
    s_addc_u32 s17, s39, 0
    s_sub_u32 s18, 16777216, s29
    s_mov_b32 s19, 0x20000
    v_and_b32 v1, 63, v0
    v_lshrrev_b32 v2, 6, v0
    s_nop 0
    v_readfirstlane_b32 s24, v2
    s_nop 3
    s_cmp_lt_u32 s24, 4
    s_cbranch_scc1 gemm_b2_kernel_compute
    s_sub_u32 s24, s24, 4
    v_subrev_u32 v2, 4, v2
    v_lshrrev_b32 v3, 3, v1
    v_and_b32 v4, 7, v1
    v_mul_u32_u24 v5, 32, v2
    v_add_u32 v5, v5, v3
    v_and_b32 v6, 3, v5
    v_lshrrev_b32 v7, 1, v5
    v_and_or_b32 v6, v7, 4, v6
    v_xor_b32 v6, v6, v4
    v_lshlrev_b32 v6, 4, v6
    v_mul_u32_u24 v9, 7168, v5
    v_add_u32 v9, v9, v6
    v_mul_u32_u24 v5, 32, v2
    v_add_u32 v5, v5, v3
    v_add_u32 v5, 8, v5
    v_and_b32 v6, 3, v5
    v_lshrrev_b32 v7, 1, v5
    v_and_or_b32 v6, v7, 4, v6
    v_xor_b32 v6, v6, v4
    v_lshlrev_b32 v6, 4, v6
    v_mul_u32_u24 v10, 7168, v5
    v_add_u32 v10, v10, v6
    v_mul_u32_u24 v5, 32, v2
    v_add_u32 v5, v5, v3
    v_add_u32 v5, 16, v5
    v_and_b32 v6, 3, v5
    v_lshrrev_b32 v7, 1, v5
    v_and_or_b32 v6, v7, 4, v6
    v_xor_b32 v6, v6, v4
    v_lshlrev_b32 v6, 4, v6
    v_mul_u32_u24 v11, 7168, v5
    v_add_u32 v11, v11, v6
    v_mul_u32_u24 v5, 32, v2
    v_add_u32 v5, v5, v3
    v_add_u32 v5, 24, v5
    v_and_b32 v6, 3, v5
    v_lshrrev_b32 v7, 1, v5
    v_and_or_b32 v6, v7, 4, v6
    v_xor_b32 v6, v6, v4
    v_lshlrev_b32 v6, 4, v6
    v_mul_u32_u24 v12, 7168, v5
    v_add_u32 v12, v12, v6
    v_lshrrev_b32 v3, 4, v1
    v_and_b32 v4, 15, v1
    v_mul_u32_u24 v5, 16, v2
    v_add_u32 v5, v5, v3
    v_and_b32 v6, 3, v5
    v_lshrrev_b32 v7, 1, v5
    v_and_or_b32 v6, v7, 4, v6
    v_lshlrev_b32 v6, 1, v6
    v_xor_b32 v6, v6, v4
    v_lshlrev_b32 v6, 4, v6
    v_mul_u32_u24 v13, 2048, v5
    v_add_u32 v13, v13, v6
    v_mul_u32_u24 v5, 16, v2
    v_add_u32 v5, v5, v3
    v_add_u32 v5, 4, v5
    v_and_b32 v6, 3, v5
    v_lshrrev_b32 v7, 1, v5
    v_and_or_b32 v6, v7, 4, v6
    v_lshlrev_b32 v6, 1, v6
    v_xor_b32 v6, v6, v4
    v_lshlrev_b32 v6, 4, v6
    v_mul_u32_u24 v14, 2048, v5
    v_add_u32 v14, v14, v6
    v_mul_u32_u24 v5, 16, v2
    v_add_u32 v5, v5, v3
    v_add_u32 v5, 8, v5
    v_and_b32 v6, 3, v5
    v_lshrrev_b32 v7, 1, v5
    v_and_or_b32 v6, v7, 4, v6
    v_lshlrev_b32 v6, 1, v6
    v_xor_b32 v6, v6, v4
    v_lshlrev_b32 v6, 4, v6
    v_mul_u32_u24 v15, 2048, v5
    v_add_u32 v15, v15, v6
    v_mul_u32_u24 v5, 16, v2
    v_add_u32 v5, v5, v3
    v_add_u32 v5, 12, v5
    v_and_b32 v6, 3, v5
    v_lshrrev_b32 v7, 1, v5
    v_and_or_b32 v6, v7, 4, v6
    v_lshlrev_b32 v6, 1, v6
    v_xor_b32 v6, v6, v4
    v_lshlrev_b32 v6, 4, v6
    v_mul_u32_u24 v16, 2048, v5
    v_add_u32 v16, v16, v6
    s_mul_i32 s25, s24, 4096
    s_mul_i32 s26, s24, 4096
    s_add_u32 s26, s26, 16384
    s_mov_b32 s27, 0
    s_mov_b32 s42, 0
    s_add_u32 m0, s25, 0
    s_nop 0
    buffer_load_dwordx4 v9, s[8:11], s27 offen lds
    s_add_u32 m0, s25, 1024
    s_nop 0
    buffer_load_dwordx4 v10, s[8:11], s27 offen lds
    s_add_u32 m0, s25, 2048
    s_nop 0
    buffer_load_dwordx4 v11, s[8:11], s27 offen lds
    s_add_u32 m0, s25, 3072
    s_nop 0
    buffer_load_dwordx4 v12, s[8:11], s27 offen lds
    s_add_u32 m0, s26, 0
    s_nop 0
    buffer_load_dwordx4 v13, s[12:15], s42 offen lds
    s_add_u32 m0, s26, 1024
    s_nop 0
    buffer_load_dwordx4 v14, s[12:15], s42 offen lds
    s_add_u32 m0, s26, 2048
    s_nop 0
    buffer_load_dwordx4 v15, s[12:15], s42 offen lds
    s_add_u32 m0, s26, 3072
    s_nop 0
    buffer_load_dwordx4 v16, s[12:15], s42 offen lds
    s_add_u32 s27, s27, 128
    s_add_u32 s42, s42, 131072
    s_add_u32 m0, s25, 32768
    s_nop 0
    buffer_load_dwordx4 v9, s[8:11], s27 offen lds
    s_add_u32 m0, s25, 33792
    s_nop 0
    buffer_load_dwordx4 v10, s[8:11], s27 offen lds
    s_add_u32 m0, s25, 34816
    s_nop 0
    buffer_load_dwordx4 v11, s[8:11], s27 offen lds
    s_add_u32 m0, s25, 35840
    s_nop 0
    buffer_load_dwordx4 v12, s[8:11], s27 offen lds
    s_add_u32 m0, s26, 32768
    s_nop 0
    buffer_load_dwordx4 v13, s[12:15], s42 offen lds
    s_add_u32 m0, s26, 33792
    s_nop 0
    buffer_load_dwordx4 v14, s[12:15], s42 offen lds
    s_add_u32 m0, s26, 34816
    s_nop 0
    buffer_load_dwordx4 v15, s[12:15], s42 offen lds
    s_add_u32 m0, s26, 35840
    s_nop 0
    buffer_load_dwordx4 v16, s[12:15], s42 offen lds
    s_add_u32 s27, s27, 128
    s_add_u32 s42, s42, 131072
    s_add_u32 m0, s25, 65536
    s_nop 0
    buffer_load_dwordx4 v9, s[8:11], s27 offen lds
    s_add_u32 m0, s25, 66560
    s_nop 0
    buffer_load_dwordx4 v10, s[8:11], s27 offen lds
    s_add_u32 m0, s25, 67584
    s_nop 0
    buffer_load_dwordx4 v11, s[8:11], s27 offen lds
    s_add_u32 m0, s25, 68608
    s_nop 0
    buffer_load_dwordx4 v12, s[8:11], s27 offen lds
    s_add_u32 m0, s26, 65536
    s_nop 0
    buffer_load_dwordx4 v13, s[12:15], s42 offen lds
    s_add_u32 m0, s26, 66560
    s_nop 0
    buffer_load_dwordx4 v14, s[12:15], s42 offen lds
    s_add_u32 m0, s26, 67584
    s_nop 0
    buffer_load_dwordx4 v15, s[12:15], s42 offen lds
    s_add_u32 m0, s26, 68608
    s_nop 0
    buffer_load_dwordx4 v16, s[12:15], s42 offen lds
    s_add_u32 s27, s27, 128
    s_add_u32 s42, s42, 131072
    s_add_u32 m0, s25, 98304
    s_nop 0
    buffer_load_dwordx4 v9, s[8:11], s27 offen lds
    s_add_u32 m0, s25, 99328
    s_nop 0
    buffer_load_dwordx4 v10, s[8:11], s27 offen lds
    s_add_u32 m0, s25, 100352
    s_nop 0
    buffer_load_dwordx4 v11, s[8:11], s27 offen lds
    s_add_u32 m0, s25, 101376
    s_nop 0
    buffer_load_dwordx4 v12, s[8:11], s27 offen lds
    s_add_u32 m0, s26, 98304
    s_nop 0
    buffer_load_dwordx4 v13, s[12:15], s42 offen lds
    s_add_u32 m0, s26, 99328
    s_nop 0
    buffer_load_dwordx4 v14, s[12:15], s42 offen lds
    s_add_u32 m0, s26, 100352
    s_nop 0
    buffer_load_dwordx4 v15, s[12:15], s42 offen lds
    s_add_u32 m0, s26, 101376
    s_nop 0
    buffer_load_dwordx4 v16, s[12:15], s42 offen lds
    s_add_u32 s27, s27, 128
    s_add_u32 s42, s42, 131072
    s_waitcnt vmcnt(24)
    s_barrier
    s_mov_b32 s28, 6
gemm_b2_kernel_lloop:
    s_waitcnt vmcnt(16)
    s_barrier
    s_add_u32 m0, s25, 0
    s_nop 0
    buffer_load_dwordx4 v9, s[8:11], s27 offen lds
    s_add_u32 m0, s25, 1024
    s_nop 0
    buffer_load_dwordx4 v10, s[8:11], s27 offen lds
    s_add_u32 m0, s25, 2048
    s_nop 0
    buffer_load_dwordx4 v11, s[8:11], s27 offen lds
    s_add_u32 m0, s25, 3072
    s_nop 0
    buffer_load_dwordx4 v12, s[8:11], s27 offen lds
    s_add_u32 m0, s26, 0
    s_nop 0
    buffer_load_dwordx4 v13, s[12:15], s42 offen lds
    s_add_u32 m0, s26, 1024
    s_nop 0
    buffer_load_dwordx4 v14, s[12:15], s42 offen lds
    s_add_u32 m0, s26, 2048
    s_nop 0
    buffer_load_dwordx4 v15, s[12:15], s42 offen lds
    s_add_u32 m0, s26, 3072
    s_nop 0
    buffer_load_dwordx4 v16, s[12:15], s42 offen lds
    s_add_u32 s27, s27, 128
    s_add_u32 s42, s42, 131072
    s_waitcnt vmcnt(16)
    s_barrier
    s_add_u32 m0, s25, 32768
    s_nop 0
    buffer_load_dwordx4 v9, s[8:11], s27 offen lds
    s_add_u32 m0, s25, 33792
    s_nop 0
    buffer_load_dwordx4 v10, s[8:11], s27 offen lds
    s_add_u32 m0, s25, 34816
    s_nop 0
    buffer_load_dwordx4 v11, s[8:11], s27 offen lds
    s_add_u32 m0, s25, 35840
    s_nop 0
    buffer_load_dwordx4 v12, s[8:11], s27 offen lds
    s_add_u32 m0, s26, 32768
    s_nop 0
    buffer_load_dwordx4 v13, s[12:15], s42 offen lds
    s_add_u32 m0, s26, 33792
    s_nop 0
    buffer_load_dwordx4 v14, s[12:15], s42 offen lds
    s_add_u32 m0, s26, 34816
    s_nop 0
    buffer_load_dwordx4 v15, s[12:15], s42 offen lds
    s_add_u32 m0, s26, 35840
    s_nop 0
    buffer_load_dwordx4 v16, s[12:15], s42 offen lds
    s_add_u32 s27, s27, 128
    s_add_u32 s42, s42, 131072
    s_waitcnt vmcnt(16)
    s_barrier
    s_add_u32 m0, s25, 65536
    s_nop 0
    buffer_load_dwordx4 v9, s[8:11], s27 offen lds
    s_add_u32 m0, s25, 66560
    s_nop 0
    buffer_load_dwordx4 v10, s[8:11], s27 offen lds
    s_add_u32 m0, s25, 67584
    s_nop 0
    buffer_load_dwordx4 v11, s[8:11], s27 offen lds
    s_add_u32 m0, s25, 68608
    s_nop 0
    buffer_load_dwordx4 v12, s[8:11], s27 offen lds
    s_add_u32 m0, s26, 65536
    s_nop 0
    buffer_load_dwordx4 v13, s[12:15], s42 offen lds
    s_add_u32 m0, s26, 66560
    s_nop 0
    buffer_load_dwordx4 v14, s[12:15], s42 offen lds
    s_add_u32 m0, s26, 67584
    s_nop 0
    buffer_load_dwordx4 v15, s[12:15], s42 offen lds
    s_add_u32 m0, s26, 68608
    s_nop 0
    buffer_load_dwordx4 v16, s[12:15], s42 offen lds
    s_add_u32 s27, s27, 128
    s_add_u32 s42, s42, 131072
    s_waitcnt vmcnt(16)
    s_barrier
    s_add_u32 m0, s25, 98304
    s_nop 0
    buffer_load_dwordx4 v9, s[8:11], s27 offen lds
    s_add_u32 m0, s25, 99328
    s_nop 0
    buffer_load_dwordx4 v10, s[8:11], s27 offen lds
    s_add_u32 m0, s25, 100352
    s_nop 0
    buffer_load_dwordx4 v11, s[8:11], s27 offen lds
    s_add_u32 m0, s25, 101376
    s_nop 0
    buffer_load_dwordx4 v12, s[8:11], s27 offen lds
    s_add_u32 m0, s26, 98304
    s_nop 0
    buffer_load_dwordx4 v13, s[12:15], s42 offen lds
    s_add_u32 m0, s26, 99328
    s_nop 0
    buffer_load_dwordx4 v14, s[12:15], s42 offen lds
    s_add_u32 m0, s26, 100352
    s_nop 0
    buffer_load_dwordx4 v15, s[12:15], s42 offen lds
    s_add_u32 m0, s26, 101376
    s_nop 0
    buffer_load_dwordx4 v16, s[12:15], s42 offen lds
    s_add_u32 s27, s27, 128
    s_add_u32 s42, s42, 131072
    s_sub_u32 s28, s28, 1
    s_cmp_lg_u32 s28, 0
    s_cbranch_scc1 gemm_b2_kernel_lloop
    s_waitcnt vmcnt(16)
    s_barrier
    s_waitcnt vmcnt(8)
    s_barrier
    s_waitcnt vmcnt(0)
    s_barrier
    s_endpgm
gemm_b2_kernel_compute:
    v_and_b32 v3, 15, v1
    v_lshrrev_b32 v4, 4, v1
    v_and_b32 v5, 1, v2
    v_lshrrev_b32 v6, 1, v2
    v_and_b32 v7, 3, v3
    v_lshrrev_b32 v8, 1, v3
    v_and_or_b32 v7, v8, 4, v7
    v_xor_b32 v7, v7, v4
    v_lshlrev_b32 v7, 4, v7
    v_mul_u32_u24 v8, 64, v5
    v_add_u32 v8, v8, v3
    v_lshlrev_b32 v8, 7, v8
    v_add_u32 v17, v8, v7
    v_xor_b32 v18, 64, v17
    v_add_u32 v19, 0x10000, v17
    v_add_u32 v20, 0x10000, v18
    v_lshrrev_b32 v26, 2, v3
    v_and_b32 v27, 3, v3
    v_and_b32 v28, 1, v4
    v_lshl_or_b32 v28, v28, 2, v26
    v_lshl_add_u32 v25, v4, 3, v26
    v_lshlrev_b32 v25, 8, v25
    v_add_u32 v25, 16384, v25
    v_mul_u32_u24 v7, 4, v6
    v_add_u32 v7, 0, v7
    v_xor_b32 v7, v7, v28
    v_lshl_add_u32 v29, v7, 5, v25
    v_lshl_add_u32 v29, v27, 3, v29
    v_add_u32 v30, 0x10000, v29
    v_mul_u32_u24 v7, 4, v6
    v_add_u32 v7, 1, v7
    v_xor_b32 v7, v7, v28
    v_lshl_add_u32 v31, v7, 5, v25
    v_lshl_add_u32 v31, v27, 3, v31
    v_add_u32 v32, 0x10000, v31
    v_mul_u32_u24 v7, 4, v6
    v_add_u32 v7, 2, v7
    v_xor_b32 v7, v7, v28
    v_lshl_add_u32 v33, v7, 5, v25
    v_lshl_add_u32 v33, v27, 3, v33
    v_add_u32 v34, 0x10000, v33
    v_mul_u32_u24 v7, 4, v6
    v_add_u32 v7, 3, v7
    v_xor_b32 v7, v7, v28
    v_lshl_add_u32 v35, v7, 5, v25
    v_lshl_add_u32 v35, v27, 3, v35
    v_add_u32 v36, 0x10000, v35
    v_mul_u32_u24 v7, 64, v5
    v_add_u32 v7, v7, v3
    v_mul_u32_u24 v7, 4096, v7
    v_mul_u32_u24 v8, 256, v6
    v_add_u32 v7, v7, v8
    v_lshlrev_b32 v39, 4, v1
    v_lshl_add_u32 v39, v5, 14, v39
    v_lshl_add_u32 v37, v4, 4, v7
    v_lshl_add_u32 v38, v4, 3, v7
    v_accvgpr_write_b32 a0, 0
    v_accvgpr_write_b32 a1, 0
    v_accvgpr_write_b32 a2, 0
    v_accvgpr_write_b32 a3, 0
    v_accvgpr_write_b32 a4, 0
    v_accvgpr_write_b32 a5, 0
    v_accvgpr_write_b32 a6, 0
    v_accvgpr_write_b32 a7, 0
    v_accvgpr_write_b32 a8, 0
    v_accvgpr_write_b32 a9, 0
    v_accvgpr_write_b32 a10, 0
    v_accvgpr_write_b32 a11, 0
    v_accvgpr_write_b32 a12, 0
    v_accvgpr_write_b32 a13, 0
    v_accvgpr_write_b32 a14, 0
    v_accvgpr_write_b32 a15, 0
    v_accvgpr_write_b32 a16, 0
    v_accvgpr_write_b32 a17, 0
    v_accvgpr_write_b32 a18, 0
    v_accvgpr_write_b32 a19, 0
    v_accvgpr_write_b32 a20, 0
    v_accvgpr_write_b32 a21, 0
    v_accvgpr_write_b32 a22, 0
    v_accvgpr_write_b32 a23, 0
    v_accvgpr_write_b32 a24, 0
    v_accvgpr_write_b32 a25, 0
    v_accvgpr_write_b32 a26, 0
    v_accvgpr_write_b32 a27, 0
    v_accvgpr_write_b32 a28, 0
    v_accvgpr_write_b32 a29, 0
    v_accvgpr_write_b32 a30, 0
    v_accvgpr_write_b32 a31, 0
    v_accvgpr_write_b32 a32, 0
    v_accvgpr_write_b32 a33, 0
    v_accvgpr_write_b32 a34, 0
    v_accvgpr_write_b32 a35, 0
    v_accvgpr_write_b32 a36, 0
    v_accvgpr_write_b32 a37, 0
    v_accvgpr_write_b32 a38, 0
    v_accvgpr_write_b32 a39, 0
    v_accvgpr_write_b32 a40, 0
    v_accvgpr_write_b32 a41, 0
    v_accvgpr_write_b32 a42, 0
    v_accvgpr_write_b32 a43, 0
    v_accvgpr_write_b32 a44, 0
    v_accvgpr_write_b32 a45, 0
    v_accvgpr_write_b32 a46, 0
    v_accvgpr_write_b32 a47, 0
    v_accvgpr_write_b32 a48, 0
    v_accvgpr_write_b32 a49, 0
    v_accvgpr_write_b32 a50, 0
    v_accvgpr_write_b32 a51, 0
    v_accvgpr_write_b32 a52, 0
    v_accvgpr_write_b32 a53, 0
    v_accvgpr_write_b32 a54, 0
    v_accvgpr_write_b32 a55, 0
    v_accvgpr_write_b32 a56, 0
    v_accvgpr_write_b32 a57, 0
    v_accvgpr_write_b32 a58, 0
    v_accvgpr_write_b32 a59, 0
    v_accvgpr_write_b32 a60, 0
    v_accvgpr_write_b32 a61, 0
    v_accvgpr_write_b32 a62, 0
    v_accvgpr_write_b32 a63, 0
    s_barrier
    ds_read_b64_tr_b16 v[72:73], v29 offset:0
    ds_read_b128 v[40:43], v17 offset:0
    ds_read_b64_tr_b16 v[74:75], v29 offset:1024
    ds_read_b128 v[44:47], v17 offset:2048
    ds_read_b64_tr_b16 v[76:77], v31 offset:0
    ds_read_b128 v[48:51], v17 offset:4096
    ds_read_b64_tr_b16 v[78:79], v31 offset:1024
    ds_read_b128 v[52:55], v17 offset:6144
    ds_read_b64_tr_b16 v[80:81], v33 offset:0
    ds_read_b64_tr_b16 v[82:83], v33 offset:1024
    ds_read_b64_tr_b16 v[84:85], v35 offset:0
    ds_read_b64_tr_b16 v[86:87], v35 offset:1024
    s_mov_b32 s28, 6
gemm_b2_kernel_loop:
    s_waitcnt lgkmcnt(0)
    v_mfma_f32_16x16x32_bf16 a[0:3], v[72:75], v[40:43], a[0:3]
    ds_read_b64_tr_b16 v[88:89], v29 offset:8192
    ds_read_b128 v[56:59], v18 offset:0
    v_mfma_f32_16x16x32_bf16 a[4:7], v[72:75], v[44:47], a[4:7]
    ds_read_b64_tr_b16 v[90:91], v29 offset:9216
    ds_read_b128 v[60:63], v18 offset:2048
    v_mfma_f32_16x16x32_bf16 a[8:11], v[72:75], v[48:51], a[8:11]
    ds_read_b64_tr_b16 v[92:93], v31 offset:8192
    ds_read_b128 v[64:67], v18 offset:4096
    v_mfma_f32_16x16x32_bf16 a[12:15], v[72:75], v[52:55], a[12:15]
    ds_read_b64_tr_b16 v[94:95], v31 offset:9216
    ds_read_b128 v[68:71], v18 offset:6144
    v_mfma_f32_16x16x32_bf16 a[16:19], v[76:79], v[40:43], a[16:19]
    ds_read_b64_tr_b16 v[96:97], v33 offset:8192
    ds_read_b64_tr_b16 v[98:99], v33 offset:9216
    v_mfma_f32_16x16x32_bf16 a[20:23], v[76:79], v[44:47], a[20:23]
    ds_read_b64_tr_b16 v[100:101], v35 offset:8192
    ds_read_b64_tr_b16 v[102:103], v35 offset:9216
    v_mfma_f32_16x16x32_bf16 a[24:27], v[76:79], v[48:51], a[24:27]
    v_mfma_f32_16x16x32_bf16 a[28:31], v[76:79], v[52:55], a[28:31]
    v_mfma_f32_16x16x32_bf16 a[32:35], v[80:83], v[40:43], a[32:35]
    v_mfma_f32_16x16x32_bf16 a[36:39], v[80:83], v[44:47], a[36:39]
    v_mfma_f32_16x16x32_bf16 a[40:43], v[80:83], v[48:51], a[40:43]
    v_mfma_f32_16x16x32_bf16 a[44:47], v[80:83], v[52:55], a[44:47]
    v_mfma_f32_16x16x32_bf16 a[48:51], v[84:87], v[40:43], a[48:51]
    v_mfma_f32_16x16x32_bf16 a[52:55], v[84:87], v[44:47], a[52:55]
    v_mfma_f32_16x16x32_bf16 a[56:59], v[84:87], v[48:51], a[56:59]
    v_mfma_f32_16x16x32_bf16 a[60:63], v[84:87], v[52:55], a[60:63]
    s_waitcnt lgkmcnt(0)
    s_barrier
    v_mfma_f32_16x16x32_bf16 a[0:3], v[88:91], v[56:59], a[0:3]
    ds_read_b64_tr_b16 v[72:73], v29 offset:32768
    v_mfma_f32_16x16x32_bf16 a[4:7], v[88:91], v[60:63], a[4:7]
    ds_read_b128 v[40:43], v17 offset:32768
    v_mfma_f32_16x16x32_bf16 a[8:11], v[88:91], v[64:67], a[8:11]
    ds_read_b64_tr_b16 v[74:75], v29 offset:33792
    v_mfma_f32_16x16x32_bf16 a[12:15], v[88:91], v[68:71], a[12:15]
    ds_read_b128 v[44:47], v17 offset:34816
    v_mfma_f32_16x16x32_bf16 a[16:19], v[92:95], v[56:59], a[16:19]
    ds_read_b64_tr_b16 v[76:77], v31 offset:32768
    v_mfma_f32_16x16x32_bf16 a[20:23], v[92:95], v[60:63], a[20:23]
    ds_read_b128 v[48:51], v17 offset:36864
    v_mfma_f32_16x16x32_bf16 a[24:27], v[92:95], v[64:67], a[24:27]
    ds_read_b64_tr_b16 v[78:79], v31 offset:33792
    v_mfma_f32_16x16x32_bf16 a[28:31], v[92:95], v[68:71], a[28:31]
    ds_read_b128 v[52:55], v17 offset:38912
    v_mfma_f32_16x16x32_bf16 a[32:35], v[96:99], v[56:59], a[32:35]
    ds_read_b64_tr_b16 v[80:81], v33 offset:32768
    v_mfma_f32_16x16x32_bf16 a[36:39], v[96:99], v[60:63], a[36:39]
    ds_read_b64_tr_b16 v[82:83], v33 offset:33792
    v_mfma_f32_16x16x32_bf16 a[40:43], v[96:99], v[64:67], a[40:43]
    ds_read_b64_tr_b16 v[84:85], v35 offset:32768
    v_mfma_f32_16x16x32_bf16 a[44:47], v[96:99], v[68:71], a[44:47]
    ds_read_b64_tr_b16 v[86:87], v35 offset:33792
    v_mfma_f32_16x16x32_bf16 a[48:51], v[100:103], v[56:59], a[48:51]
    v_mfma_f32_16x16x32_bf16 a[52:55], v[100:103], v[60:63], a[52:55]
    v_mfma_f32_16x16x32_bf16 a[56:59], v[100:103], v[64:67], a[56:59]
    v_mfma_f32_16x16x32_bf16 a[60:63], v[100:103], v[68:71], a[60:63]
    s_waitcnt lgkmcnt(0)
    v_mfma_f32_16x16x32_bf16 a[0:3], v[72:75], v[40:43], a[0:3]
    ds_read_b64_tr_b16 v[88:89], v29 offset:40960
    ds_read_b128 v[56:59], v18 offset:32768
    v_mfma_f32_16x16x32_bf16 a[4:7], v[72:75], v[44:47], a[4:7]
    ds_read_b64_tr_b16 v[90:91], v29 offset:41984
    ds_read_b128 v[60:63], v18 offset:34816
    v_mfma_f32_16x16x32_bf16 a[8:11], v[72:75], v[48:51], a[8:11]
    ds_read_b64_tr_b16 v[92:93], v31 offset:40960
    ds_read_b128 v[64:67], v18 offset:36864
    v_mfma_f32_16x16x32_bf16 a[12:15], v[72:75], v[52:55], a[12:15]
    ds_read_b64_tr_b16 v[94:95], v31 offset:41984
    ds_read_b128 v[68:71], v18 offset:38912
    v_mfma_f32_16x16x32_bf16 a[16:19], v[76:79], v[40:43], a[16:19]
    ds_read_b64_tr_b16 v[96:97], v33 offset:40960
    ds_read_b64_tr_b16 v[98:99], v33 offset:41984
    v_mfma_f32_16x16x32_bf16 a[20:23], v[76:79], v[44:47], a[20:23]
    ds_read_b64_tr_b16 v[100:101], v35 offset:40960
    ds_read_b64_tr_b16 v[102:103], v35 offset:41984
    v_mfma_f32_16x16x32_bf16 a[24:27], v[76:79], v[48:51], a[24:27]
    v_mfma_f32_16x16x32_bf16 a[28:31], v[76:79], v[52:55], a[28:31]
    v_mfma_f32_16x16x32_bf16 a[32:35], v[80:83], v[40:43], a[32:35]
    v_mfma_f32_16x16x32_bf16 a[36:39], v[80:83], v[44:47], a[36:39]
    v_mfma_f32_16x16x32_bf16 a[40:43], v[80:83], v[48:51], a[40:43]
    v_mfma_f32_16x16x32_bf16 a[44:47], v[80:83], v[52:55], a[44:47]
    v_mfma_f32_16x16x32_bf16 a[48:51], v[84:87], v[40:43], a[48:51]
    v_mfma_f32_16x16x32_bf16 a[52:55], v[84:87], v[44:47], a[52:55]
    v_mfma_f32_16x16x32_bf16 a[56:59], v[84:87], v[48:51], a[56:59]
    v_mfma_f32_16x16x32_bf16 a[60:63], v[84:87], v[52:55], a[60:63]
    s_waitcnt lgkmcnt(0)
    s_barrier
    v_mfma_f32_16x16x32_bf16 a[0:3], v[88:91], v[56:59], a[0:3]
    ds_read_b64_tr_b16 v[72:73], v30 offset:0
    v_mfma_f32_16x16x32_bf16 a[4:7], v[88:91], v[60:63], a[4:7]
    ds_read_b128 v[40:43], v19 offset:0
    v_mfma_f32_16x16x32_bf16 a[8:11], v[88:91], v[64:67], a[8:11]
    ds_read_b64_tr_b16 v[74:75], v30 offset:1024
    v_mfma_f32_16x16x32_bf16 a[12:15], v[88:91], v[68:71], a[12:15]
    ds_read_b128 v[44:47], v19 offset:2048
    v_mfma_f32_16x16x32_bf16 a[16:19], v[92:95], v[56:59], a[16:19]
    ds_read_b64_tr_b16 v[76:77], v32 offset:0
    v_mfma_f32_16x16x32_bf16 a[20:23], v[92:95], v[60:63], a[20:23]
    ds_read_b128 v[48:51], v19 offset:4096
    v_mfma_f32_16x16x32_bf16 a[24:27], v[92:95], v[64:67], a[24:27]
    ds_read_b64_tr_b16 v[78:79], v32 offset:1024
    v_mfma_f32_16x16x32_bf16 a[28:31], v[92:95], v[68:71], a[28:31]
    ds_read_b128 v[52:55], v19 offset:6144
    v_mfma_f32_16x16x32_bf16 a[32:35], v[96:99], v[56:59], a[32:35]
    ds_read_b64_tr_b16 v[80:81], v34 offset:0
    v_mfma_f32_16x16x32_bf16 a[36:39], v[96:99], v[60:63], a[36:39]
    ds_read_b64_tr_b16 v[82:83], v34 offset:1024
    v_mfma_f32_16x16x32_bf16 a[40:43], v[96:99], v[64:67], a[40:43]
    ds_read_b64_tr_b16 v[84:85], v36 offset:0
    v_mfma_f32_16x16x32_bf16 a[44:47], v[96:99], v[68:71], a[44:47]
    ds_read_b64_tr_b16 v[86:87], v36 offset:1024
    v_mfma_f32_16x16x32_bf16 a[48:51], v[100:103], v[56:59], a[48:51]
    v_mfma_f32_16x16x32_bf16 a[52:55], v[100:103], v[60:63], a[52:55]
    v_mfma_f32_16x16x32_bf16 a[56:59], v[100:103], v[64:67], a[56:59]
    v_mfma_f32_16x16x32_bf16 a[60:63], v[100:103], v[68:71], a[60:63]
    s_waitcnt lgkmcnt(0)
    v_mfma_f32_16x16x32_bf16 a[0:3], v[72:75], v[40:43], a[0:3]
    ds_read_b64_tr_b16 v[88:89], v30 offset:8192
    ds_read_b128 v[56:59], v20 offset:0
    v_mfma_f32_16x16x32_bf16 a[4:7], v[72:75], v[44:47], a[4:7]
    ds_read_b64_tr_b16 v[90:91], v30 offset:9216
    ds_read_b128 v[60:63], v20 offset:2048
    v_mfma_f32_16x16x32_bf16 a[8:11], v[72:75], v[48:51], a[8:11]
    ds_read_b64_tr_b16 v[92:93], v32 offset:8192
    ds_read_b128 v[64:67], v20 offset:4096
    v_mfma_f32_16x16x32_bf16 a[12:15], v[72:75], v[52:55], a[12:15]
    ds_read_b64_tr_b16 v[94:95], v32 offset:9216
    ds_read_b128 v[68:71], v20 offset:6144
    v_mfma_f32_16x16x32_bf16 a[16:19], v[76:79], v[40:43], a[16:19]
    ds_read_b64_tr_b16 v[96:97], v34 offset:8192
    ds_read_b64_tr_b16 v[98:99], v34 offset:9216
    v_mfma_f32_16x16x32_bf16 a[20:23], v[76:79], v[44:47], a[20:23]
    ds_read_b64_tr_b16 v[100:101], v36 offset:8192
    ds_read_b64_tr_b16 v[102:103], v36 offset:9216
    v_mfma_f32_16x16x32_bf16 a[24:27], v[76:79], v[48:51], a[24:27]
    v_mfma_f32_16x16x32_bf16 a[28:31], v[76:79], v[52:55], a[28:31]
    v_mfma_f32_16x16x32_bf16 a[32:35], v[80:83], v[40:43], a[32:35]
    v_mfma_f32_16x16x32_bf16 a[36:39], v[80:83], v[44:47], a[36:39]
    v_mfma_f32_16x16x32_bf16 a[40:43], v[80:83], v[48:51], a[40:43]
    v_mfma_f32_16x16x32_bf16 a[44:47], v[80:83], v[52:55], a[44:47]
    v_mfma_f32_16x16x32_bf16 a[48:51], v[84:87], v[40:43], a[48:51]
    v_mfma_f32_16x16x32_bf16 a[52:55], v[84:87], v[44:47], a[52:55]
    v_mfma_f32_16x16x32_bf16 a[56:59], v[84:87], v[48:51], a[56:59]
    v_mfma_f32_16x16x32_bf16 a[60:63], v[84:87], v[52:55], a[60:63]
    s_waitcnt lgkmcnt(0)
    s_barrier
    v_mfma_f32_16x16x32_bf16 a[0:3], v[88:91], v[56:59], a[0:3]
    ds_read_b64_tr_b16 v[72:73], v30 offset:32768
    v_mfma_f32_16x16x32_bf16 a[4:7], v[88:91], v[60:63], a[4:7]
    ds_read_b128 v[40:43], v19 offset:32768
    v_mfma_f32_16x16x32_bf16 a[8:11], v[88:91], v[64:67], a[8:11]
    ds_read_b64_tr_b16 v[74:75], v30 offset:33792
    v_mfma_f32_16x16x32_bf16 a[12:15], v[88:91], v[68:71], a[12:15]
    ds_read_b128 v[44:47], v19 offset:34816
    v_mfma_f32_16x16x32_bf16 a[16:19], v[92:95], v[56:59], a[16:19]
    ds_read_b64_tr_b16 v[76:77], v32 offset:32768
    v_mfma_f32_16x16x32_bf16 a[20:23], v[92:95], v[60:63], a[20:23]
    ds_read_b128 v[48:51], v19 offset:36864
    v_mfma_f32_16x16x32_bf16 a[24:27], v[92:95], v[64:67], a[24:27]
    ds_read_b64_tr_b16 v[78:79], v32 offset:33792
    v_mfma_f32_16x16x32_bf16 a[28:31], v[92:95], v[68:71], a[28:31]
    ds_read_b128 v[52:55], v19 offset:38912
    v_mfma_f32_16x16x32_bf16 a[32:35], v[96:99], v[56:59], a[32:35]
    ds_read_b64_tr_b16 v[80:81], v34 offset:32768
    v_mfma_f32_16x16x32_bf16 a[36:39], v[96:99], v[60:63], a[36:39]
    ds_read_b64_tr_b16 v[82:83], v34 offset:33792
    v_mfma_f32_16x16x32_bf16 a[40:43], v[96:99], v[64:67], a[40:43]
    ds_read_b64_tr_b16 v[84:85], v36 offset:32768
    v_mfma_f32_16x16x32_bf16 a[44:47], v[96:99], v[68:71], a[44:47]
    ds_read_b64_tr_b16 v[86:87], v36 offset:33792
    v_mfma_f32_16x16x32_bf16 a[48:51], v[100:103], v[56:59], a[48:51]
    v_mfma_f32_16x16x32_bf16 a[52:55], v[100:103], v[60:63], a[52:55]
    v_mfma_f32_16x16x32_bf16 a[56:59], v[100:103], v[64:67], a[56:59]
    v_mfma_f32_16x16x32_bf16 a[60:63], v[100:103], v[68:71], a[60:63]
    s_waitcnt lgkmcnt(0)
    v_mfma_f32_16x16x32_bf16 a[0:3], v[72:75], v[40:43], a[0:3]
    ds_read_b64_tr_b16 v[88:89], v30 offset:40960
    ds_read_b128 v[56:59], v20 offset:32768
    v_mfma_f32_16x16x32_bf16 a[4:7], v[72:75], v[44:47], a[4:7]
    ds_read_b64_tr_b16 v[90:91], v30 offset:41984
    ds_read_b128 v[60:63], v20 offset:34816
    v_mfma_f32_16x16x32_bf16 a[8:11], v[72:75], v[48:51], a[8:11]
    ds_read_b64_tr_b16 v[92:93], v32 offset:40960
    ds_read_b128 v[64:67], v20 offset:36864
    v_mfma_f32_16x16x32_bf16 a[12:15], v[72:75], v[52:55], a[12:15]
    ds_read_b64_tr_b16 v[94:95], v32 offset:41984
    ds_read_b128 v[68:71], v20 offset:38912
    v_mfma_f32_16x16x32_bf16 a[16:19], v[76:79], v[40:43], a[16:19]
    ds_read_b64_tr_b16 v[96:97], v34 offset:40960
    ds_read_b64_tr_b16 v[98:99], v34 offset:41984
    v_mfma_f32_16x16x32_bf16 a[20:23], v[76:79], v[44:47], a[20:23]
    ds_read_b64_tr_b16 v[100:101], v36 offset:40960
    ds_read_b64_tr_b16 v[102:103], v36 offset:41984
    v_mfma_f32_16x16x32_bf16 a[24:27], v[76:79], v[48:51], a[24:27]
    v_mfma_f32_16x16x32_bf16 a[28:31], v[76:79], v[52:55], a[28:31]
    v_mfma_f32_16x16x32_bf16 a[32:35], v[80:83], v[40:43], a[32:35]
    v_mfma_f32_16x16x32_bf16 a[36:39], v[80:83], v[44:47], a[36:39]
    v_mfma_f32_16x16x32_bf16 a[40:43], v[80:83], v[48:51], a[40:43]
    v_mfma_f32_16x16x32_bf16 a[44:47], v[80:83], v[52:55], a[44:47]
    v_mfma_f32_16x16x32_bf16 a[48:51], v[84:87], v[40:43], a[48:51]
    v_mfma_f32_16x16x32_bf16 a[52:55], v[84:87], v[44:47], a[52:55]
    v_mfma_f32_16x16x32_bf16 a[56:59], v[84:87], v[48:51], a[56:59]
    v_mfma_f32_16x16x32_bf16 a[60:63], v[84:87], v[52:55], a[60:63]
    s_waitcnt lgkmcnt(0)
    s_barrier
    v_mfma_f32_16x16x32_bf16 a[0:3], v[88:91], v[56:59], a[0:3]
    ds_read_b64_tr_b16 v[72:73], v29 offset:0
    v_mfma_f32_16x16x32_bf16 a[4:7], v[88:91], v[60:63], a[4:7]
    ds_read_b128 v[40:43], v17 offset:0
    v_mfma_f32_16x16x32_bf16 a[8:11], v[88:91], v[64:67], a[8:11]
    ds_read_b64_tr_b16 v[74:75], v29 offset:1024
    v_mfma_f32_16x16x32_bf16 a[12:15], v[88:91], v[68:71], a[12:15]
    ds_read_b128 v[44:47], v17 offset:2048
    v_mfma_f32_16x16x32_bf16 a[16:19], v[92:95], v[56:59], a[16:19]
    ds_read_b64_tr_b16 v[76:77], v31 offset:0
    v_mfma_f32_16x16x32_bf16 a[20:23], v[92:95], v[60:63], a[20:23]
    ds_read_b128 v[48:51], v17 offset:4096
    v_mfma_f32_16x16x32_bf16 a[24:27], v[92:95], v[64:67], a[24:27]
    ds_read_b64_tr_b16 v[78:79], v31 offset:1024
    v_mfma_f32_16x16x32_bf16 a[28:31], v[92:95], v[68:71], a[28:31]
    ds_read_b128 v[52:55], v17 offset:6144
    v_mfma_f32_16x16x32_bf16 a[32:35], v[96:99], v[56:59], a[32:35]
    ds_read_b64_tr_b16 v[80:81], v33 offset:0
    v_mfma_f32_16x16x32_bf16 a[36:39], v[96:99], v[60:63], a[36:39]
    ds_read_b64_tr_b16 v[82:83], v33 offset:1024
    v_mfma_f32_16x16x32_bf16 a[40:43], v[96:99], v[64:67], a[40:43]
    ds_read_b64_tr_b16 v[84:85], v35 offset:0
    v_mfma_f32_16x16x32_bf16 a[44:47], v[96:99], v[68:71], a[44:47]
    ds_read_b64_tr_b16 v[86:87], v35 offset:1024
    v_mfma_f32_16x16x32_bf16 a[48:51], v[100:103], v[56:59], a[48:51]
    v_mfma_f32_16x16x32_bf16 a[52:55], v[100:103], v[60:63], a[52:55]
    v_mfma_f32_16x16x32_bf16 a[56:59], v[100:103], v[64:67], a[56:59]
    v_mfma_f32_16x16x32_bf16 a[60:63], v[100:103], v[68:71], a[60:63]
    s_sub_u32 s28, s28, 1
    s_cmp_lg_u32 s28, 0
    s_cbranch_scc1 gemm_b2_kernel_loop
    s_waitcnt lgkmcnt(0)
    v_mfma_f32_16x16x32_bf16 a[0:3], v[72:75], v[40:43], a[0:3]
    ds_read_b64_tr_b16 v[88:89], v29 offset:8192
    ds_read_b128 v[56:59], v18 offset:0
    v_mfma_f32_16x16x32_bf16 a[4:7], v[72:75], v[44:47], a[4:7]
    ds_read_b64_tr_b16 v[90:91], v29 offset:9216
    ds_read_b128 v[60:63], v18 offset:2048
    v_mfma_f32_16x16x32_bf16 a[8:11], v[72:75], v[48:51], a[8:11]
    ds_read_b64_tr_b16 v[92:93], v31 offset:8192
    ds_read_b128 v[64:67], v18 offset:4096
    v_mfma_f32_16x16x32_bf16 a[12:15], v[72:75], v[52:55], a[12:15]
    ds_read_b64_tr_b16 v[94:95], v31 offset:9216
    ds_read_b128 v[68:71], v18 offset:6144
    v_mfma_f32_16x16x32_bf16 a[16:19], v[76:79], v[40:43], a[16:19]
    ds_read_b64_tr_b16 v[96:97], v33 offset:8192
    ds_read_b64_tr_b16 v[98:99], v33 offset:9216
    v_mfma_f32_16x16x32_bf16 a[20:23], v[76:79], v[44:47], a[20:23]
    ds_read_b64_tr_b16 v[100:101], v35 offset:8192
    ds_read_b64_tr_b16 v[102:103], v35 offset:9216
    v_mfma_f32_16x16x32_bf16 a[24:27], v[76:79], v[48:51], a[24:27]
    v_mfma_f32_16x16x32_bf16 a[28:31], v[76:79], v[52:55], a[28:31]
    v_mfma_f32_16x16x32_bf16 a[32:35], v[80:83], v[40:43], a[32:35]
    v_mfma_f32_16x16x32_bf16 a[36:39], v[80:83], v[44:47], a[36:39]
    v_mfma_f32_16x16x32_bf16 a[40:43], v[80:83], v[48:51], a[40:43]
    v_mfma_f32_16x16x32_bf16 a[44:47], v[80:83], v[52:55], a[44:47]
    v_mfma_f32_16x16x32_bf16 a[48:51], v[84:87], v[40:43], a[48:51]
    v_mfma_f32_16x16x32_bf16 a[52:55], v[84:87], v[44:47], a[52:55]
    v_mfma_f32_16x16x32_bf16 a[56:59], v[84:87], v[48:51], a[56:59]
    v_mfma_f32_16x16x32_bf16 a[60:63], v[84:87], v[52:55], a[60:63]
    s_waitcnt lgkmcnt(0)
    s_barrier
    v_mfma_f32_16x16x32_bf16 a[0:3], v[88:91], v[56:59], a[0:3]
    ds_read_b64_tr_b16 v[72:73], v29 offset:32768
    v_mfma_f32_16x16x32_bf16 a[4:7], v[88:91], v[60:63], a[4:7]
    ds_read_b128 v[40:43], v17 offset:32768
    v_mfma_f32_16x16x32_bf16 a[8:11], v[88:91], v[64:67], a[8:11]
    ds_read_b64_tr_b16 v[74:75], v29 offset:33792
    v_mfma_f32_16x16x32_bf16 a[12:15], v[88:91], v[68:71], a[12:15]
    ds_read_b128 v[44:47], v17 offset:34816
    v_mfma_f32_16x16x32_bf16 a[16:19], v[92:95], v[56:59], a[16:19]
    ds_read_b64_tr_b16 v[76:77], v31 offset:32768
    v_mfma_f32_16x16x32_bf16 a[20:23], v[92:95], v[60:63], a[20:23]
    ds_read_b128 v[48:51], v17 offset:36864
    v_mfma_f32_16x16x32_bf16 a[24:27], v[92:95], v[64:67], a[24:27]
    ds_read_b64_tr_b16 v[78:79], v31 offset:33792
    v_mfma_f32_16x16x32_bf16 a[28:31], v[92:95], v[68:71], a[28:31]
    ds_read_b128 v[52:55], v17 offset:38912
    v_mfma_f32_16x16x32_bf16 a[32:35], v[96:99], v[56:59], a[32:35]
    ds_read_b64_tr_b16 v[80:81], v33 offset:32768
    v_mfma_f32_16x16x32_bf16 a[36:39], v[96:99], v[60:63], a[36:39]
    ds_read_b64_tr_b16 v[82:83], v33 offset:33792
    v_mfma_f32_16x16x32_bf16 a[40:43], v[96:99], v[64:67], a[40:43]
    ds_read_b64_tr_b16 v[84:85], v35 offset:32768
    v_mfma_f32_16x16x32_bf16 a[44:47], v[96:99], v[68:71], a[44:47]
    ds_read_b64_tr_b16 v[86:87], v35 offset:33792
    v_mfma_f32_16x16x32_bf16 a[48:51], v[100:103], v[56:59], a[48:51]
    v_mfma_f32_16x16x32_bf16 a[52:55], v[100:103], v[60:63], a[52:55]
    v_mfma_f32_16x16x32_bf16 a[56:59], v[100:103], v[64:67], a[56:59]
    v_mfma_f32_16x16x32_bf16 a[60:63], v[100:103], v[68:71], a[60:63]
    s_waitcnt lgkmcnt(0)
    v_mfma_f32_16x16x32_bf16 a[0:3], v[72:75], v[40:43], a[0:3]
    ds_read_b64_tr_b16 v[88:89], v29 offset:40960
    ds_read_b128 v[56:59], v18 offset:32768
    v_mfma_f32_16x16x32_bf16 a[4:7], v[72:75], v[44:47], a[4:7]
    ds_read_b64_tr_b16 v[90:91], v29 offset:41984
    ds_read_b128 v[60:63], v18 offset:34816
    v_mfma_f32_16x16x32_bf16 a[8:11], v[72:75], v[48:51], a[8:11]
    ds_read_b64_tr_b16 v[92:93], v31 offset:40960
    ds_read_b128 v[64:67], v18 offset:36864
    v_mfma_f32_16x16x32_bf16 a[12:15], v[72:75], v[52:55], a[12:15]
    ds_read_b64_tr_b16 v[94:95], v31 offset:41984
    ds_read_b128 v[68:71], v18 offset:38912
    v_mfma_f32_16x16x32_bf16 a[16:19], v[76:79], v[40:43], a[16:19]
    ds_read_b64_tr_b16 v[96:97], v33 offset:40960
    ds_read_b64_tr_b16 v[98:99], v33 offset:41984
    v_mfma_f32_16x16x32_bf16 a[20:23], v[76:79], v[44:47], a[20:23]
    ds_read_b64_tr_b16 v[100:101], v35 offset:40960
    ds_read_b64_tr_b16 v[102:103], v35 offset:41984
    v_mfma_f32_16x16x32_bf16 a[24:27], v[76:79], v[48:51], a[24:27]
    v_mfma_f32_16x16x32_bf16 a[28:31], v[76:79], v[52:55], a[28:31]
    v_mfma_f32_16x16x32_bf16 a[32:35], v[80:83], v[40:43], a[32:35]
    v_mfma_f32_16x16x32_bf16 a[36:39], v[80:83], v[44:47], a[36:39]
    v_mfma_f32_16x16x32_bf16 a[40:43], v[80:83], v[48:51], a[40:43]
    v_mfma_f32_16x16x32_bf16 a[44:47], v[80:83], v[52:55], a[44:47]
    v_mfma_f32_16x16x32_bf16 a[48:51], v[84:87], v[40:43], a[48:51]
    v_mfma_f32_16x16x32_bf16 a[52:55], v[84:87], v[44:47], a[52:55]
    v_mfma_f32_16x16x32_bf16 a[56:59], v[84:87], v[48:51], a[56:59]
    v_mfma_f32_16x16x32_bf16 a[60:63], v[84:87], v[52:55], a[60:63]
    s_waitcnt lgkmcnt(0)
    s_barrier
    v_mfma_f32_16x16x32_bf16 a[0:3], v[88:91], v[56:59], a[0:3]
    ds_read_b64_tr_b16 v[72:73], v30 offset:0
    v_mfma_f32_16x16x32_bf16 a[4:7], v[88:91], v[60:63], a[4:7]
    ds_read_b128 v[40:43], v19 offset:0
    v_mfma_f32_16x16x32_bf16 a[8:11], v[88:91], v[64:67], a[8:11]
    ds_read_b64_tr_b16 v[74:75], v30 offset:1024
    v_mfma_f32_16x16x32_bf16 a[12:15], v[88:91], v[68:71], a[12:15]
    ds_read_b128 v[44:47], v19 offset:2048
    v_mfma_f32_16x16x32_bf16 a[16:19], v[92:95], v[56:59], a[16:19]
    ds_read_b64_tr_b16 v[76:77], v32 offset:0
    v_mfma_f32_16x16x32_bf16 a[20:23], v[92:95], v[60:63], a[20:23]
    ds_read_b128 v[48:51], v19 offset:4096
    v_mfma_f32_16x16x32_bf16 a[24:27], v[92:95], v[64:67], a[24:27]
    ds_read_b64_tr_b16 v[78:79], v32 offset:1024
    v_mfma_f32_16x16x32_bf16 a[28:31], v[92:95], v[68:71], a[28:31]
    ds_read_b128 v[52:55], v19 offset:6144
    v_mfma_f32_16x16x32_bf16 a[32:35], v[96:99], v[56:59], a[32:35]
    ds_read_b64_tr_b16 v[80:81], v34 offset:0
    v_mfma_f32_16x16x32_bf16 a[36:39], v[96:99], v[60:63], a[36:39]
    ds_read_b64_tr_b16 v[82:83], v34 offset:1024
    v_mfma_f32_16x16x32_bf16 a[40:43], v[96:99], v[64:67], a[40:43]
    ds_read_b64_tr_b16 v[84:85], v36 offset:0
    v_mfma_f32_16x16x32_bf16 a[44:47], v[96:99], v[68:71], a[44:47]
    ds_read_b64_tr_b16 v[86:87], v36 offset:1024
    v_mfma_f32_16x16x32_bf16 a[48:51], v[100:103], v[56:59], a[48:51]
    v_mfma_f32_16x16x32_bf16 a[52:55], v[100:103], v[60:63], a[52:55]
    v_mfma_f32_16x16x32_bf16 a[56:59], v[100:103], v[64:67], a[56:59]
    v_mfma_f32_16x16x32_bf16 a[60:63], v[100:103], v[68:71], a[60:63]
    s_waitcnt lgkmcnt(0)
    v_mfma_f32_16x16x32_bf16 a[0:3], v[72:75], v[40:43], a[0:3]
    ds_read_b64_tr_b16 v[88:89], v30 offset:8192
    ds_read_b128 v[56:59], v20 offset:0
    v_mfma_f32_16x16x32_bf16 a[4:7], v[72:75], v[44:47], a[4:7]
    ds_read_b64_tr_b16 v[90:91], v30 offset:9216
    ds_read_b128 v[60:63], v20 offset:2048
    v_mfma_f32_16x16x32_bf16 a[8:11], v[72:75], v[48:51], a[8:11]
    ds_read_b64_tr_b16 v[92:93], v32 offset:8192
    ds_read_b128 v[64:67], v20 offset:4096
    v_mfma_f32_16x16x32_bf16 a[12:15], v[72:75], v[52:55], a[12:15]
    ds_read_b64_tr_b16 v[94:95], v32 offset:9216
    ds_read_b128 v[68:71], v20 offset:6144
    v_mfma_f32_16x16x32_bf16 a[16:19], v[76:79], v[40:43], a[16:19]
    ds_read_b64_tr_b16 v[96:97], v34 offset:8192
    ds_read_b64_tr_b16 v[98:99], v34 offset:9216
    v_mfma_f32_16x16x32_bf16 a[20:23], v[76:79], v[44:47], a[20:23]
    ds_read_b64_tr_b16 v[100:101], v36 offset:8192
    ds_read_b64_tr_b16 v[102:103], v36 offset:9216
    v_mfma_f32_16x16x32_bf16 a[24:27], v[76:79], v[48:51], a[24:27]
    v_mfma_f32_16x16x32_bf16 a[28:31], v[76:79], v[52:55], a[28:31]
    v_mfma_f32_16x16x32_bf16 a[32:35], v[80:83], v[40:43], a[32:35]
    v_mfma_f32_16x16x32_bf16 a[36:39], v[80:83], v[44:47], a[36:39]
    v_mfma_f32_16x16x32_bf16 a[40:43], v[80:83], v[48:51], a[40:43]
    v_mfma_f32_16x16x32_bf16 a[44:47], v[80:83], v[52:55], a[44:47]
    v_mfma_f32_16x16x32_bf16 a[48:51], v[84:87], v[40:43], a[48:51]
    v_mfma_f32_16x16x32_bf16 a[52:55], v[84:87], v[44:47], a[52:55]
    v_mfma_f32_16x16x32_bf16 a[56:59], v[84:87], v[48:51], a[56:59]
    v_mfma_f32_16x16x32_bf16 a[60:63], v[84:87], v[52:55], a[60:63]
    s_waitcnt lgkmcnt(0)
    s_barrier
    v_mfma_f32_16x16x32_bf16 a[0:3], v[88:91], v[56:59], a[0:3]
    ds_read_b64_tr_b16 v[72:73], v30 offset:32768
    v_mfma_f32_16x16x32_bf16 a[4:7], v[88:91], v[60:63], a[4:7]
    ds_read_b128 v[40:43], v19 offset:32768
    v_mfma_f32_16x16x32_bf16 a[8:11], v[88:91], v[64:67], a[8:11]
    ds_read_b64_tr_b16 v[74:75], v30 offset:33792
    v_mfma_f32_16x16x32_bf16 a[12:15], v[88:91], v[68:71], a[12:15]
    ds_read_b128 v[44:47], v19 offset:34816
    v_mfma_f32_16x16x32_bf16 a[16:19], v[92:95], v[56:59], a[16:19]
    ds_read_b64_tr_b16 v[76:77], v32 offset:32768
    v_mfma_f32_16x16x32_bf16 a[20:23], v[92:95], v[60:63], a[20:23]
    ds_read_b128 v[48:51], v19 offset:36864
    v_mfma_f32_16x16x32_bf16 a[24:27], v[92:95], v[64:67], a[24:27]
    ds_read_b64_tr_b16 v[78:79], v32 offset:33792
    v_mfma_f32_16x16x32_bf16 a[28:31], v[92:95], v[68:71], a[28:31]
    ds_read_b128 v[52:55], v19 offset:38912
    v_mfma_f32_16x16x32_bf16 a[32:35], v[96:99], v[56:59], a[32:35]
    ds_read_b64_tr_b16 v[80:81], v34 offset:32768
    v_mfma_f32_16x16x32_bf16 a[36:39], v[96:99], v[60:63], a[36:39]
    ds_read_b64_tr_b16 v[82:83], v34 offset:33792
    v_mfma_f32_16x16x32_bf16 a[40:43], v[96:99], v[64:67], a[40:43]
    ds_read_b64_tr_b16 v[84:85], v36 offset:32768
    v_mfma_f32_16x16x32_bf16 a[44:47], v[96:99], v[68:71], a[44:47]
    ds_read_b64_tr_b16 v[86:87], v36 offset:33792
    v_mfma_f32_16x16x32_bf16 a[48:51], v[100:103], v[56:59], a[48:51]
    v_mfma_f32_16x16x32_bf16 a[52:55], v[100:103], v[60:63], a[52:55]
    v_mfma_f32_16x16x32_bf16 a[56:59], v[100:103], v[64:67], a[56:59]
    v_mfma_f32_16x16x32_bf16 a[60:63], v[100:103], v[68:71], a[60:63]
    s_waitcnt lgkmcnt(0)
    v_mfma_f32_16x16x32_bf16 a[0:3], v[72:75], v[40:43], a[0:3]
    ds_read_b64_tr_b16 v[88:89], v30 offset:40960
    ds_read_b128 v[56:59], v20 offset:32768
    v_mfma_f32_16x16x32_bf16 a[4:7], v[72:75], v[44:47], a[4:7]
    ds_read_b64_tr_b16 v[90:91], v30 offset:41984
    ds_read_b128 v[60:63], v20 offset:34816
    v_mfma_f32_16x16x32_bf16 a[8:11], v[72:75], v[48:51], a[8:11]
    ds_read_b64_tr_b16 v[92:93], v32 offset:40960
    ds_read_b128 v[64:67], v20 offset:36864
    v_mfma_f32_16x16x32_bf16 a[12:15], v[72:75], v[52:55], a[12:15]
    ds_read_b64_tr_b16 v[94:95], v32 offset:41984
    ds_read_b128 v[68:71], v20 offset:38912
    v_mfma_f32_16x16x32_bf16 a[16:19], v[76:79], v[40:43], a[16:19]
    ds_read_b64_tr_b16 v[96:97], v34 offset:40960
    ds_read_b64_tr_b16 v[98:99], v34 offset:41984
    v_mfma_f32_16x16x32_bf16 a[20:23], v[76:79], v[44:47], a[20:23]
    ds_read_b64_tr_b16 v[100:101], v36 offset:40960
    ds_read_b64_tr_b16 v[102:103], v36 offset:41984
    v_mfma_f32_16x16x32_bf16 a[24:27], v[76:79], v[48:51], a[24:27]
    v_mfma_f32_16x16x32_bf16 a[28:31], v[76:79], v[52:55], a[28:31]
    v_mfma_f32_16x16x32_bf16 a[32:35], v[80:83], v[40:43], a[32:35]
    v_mfma_f32_16x16x32_bf16 a[36:39], v[80:83], v[44:47], a[36:39]
    v_mfma_f32_16x16x32_bf16 a[40:43], v[80:83], v[48:51], a[40:43]
    v_mfma_f32_16x16x32_bf16 a[44:47], v[80:83], v[52:55], a[44:47]
    v_mfma_f32_16x16x32_bf16 a[48:51], v[84:87], v[40:43], a[48:51]
    v_mfma_f32_16x16x32_bf16 a[52:55], v[84:87], v[44:47], a[52:55]
    v_mfma_f32_16x16x32_bf16 a[56:59], v[84:87], v[48:51], a[56:59]
    v_mfma_f32_16x16x32_bf16 a[60:63], v[84:87], v[52:55], a[60:63]
    s_waitcnt lgkmcnt(0)
    v_mfma_f32_16x16x32_bf16 a[0:3], v[88:91], v[56:59], a[0:3]
    v_mfma_f32_16x16x32_bf16 a[4:7], v[88:91], v[60:63], a[4:7]
    v_mfma_f32_16x16x32_bf16 a[8:11], v[88:91], v[64:67], a[8:11]
    v_mfma_f32_16x16x32_bf16 a[12:15], v[88:91], v[68:71], a[12:15]
    v_mfma_f32_16x16x32_bf16 a[16:19], v[92:95], v[56:59], a[16:19]
    v_mfma_f32_16x16x32_bf16 a[20:23], v[92:95], v[60:63], a[20:23]
    v_mfma_f32_16x16x32_bf16 a[24:27], v[92:95], v[64:67], a[24:27]
    v_mfma_f32_16x16x32_bf16 a[28:31], v[92:95], v[68:71], a[28:31]
    v_mfma_f32_16x16x32_bf16 a[32:35], v[96:99], v[56:59], a[32:35]
    v_mfma_f32_16x16x32_bf16 a[36:39], v[96:99], v[60:63], a[36:39]
    v_mfma_f32_16x16x32_bf16 a[40:43], v[96:99], v[64:67], a[40:43]
    v_mfma_f32_16x16x32_bf16 a[44:47], v[96:99], v[68:71], a[44:47]
    v_mfma_f32_16x16x32_bf16 a[48:51], v[100:103], v[56:59], a[48:51]
    v_mfma_f32_16x16x32_bf16 a[52:55], v[100:103], v[60:63], a[52:55]
    v_mfma_f32_16x16x32_bf16 a[56:59], v[100:103], v[64:67], a[56:59]
    v_mfma_f32_16x16x32_bf16 a[60:63], v[100:103], v[68:71], a[60:63]
    s_nop 15
    s_nop 7
    v_accvgpr_read_b32 v40, a0
    v_accvgpr_read_b32 v41, a1
    v_accvgpr_read_b32 v42, a2
    v_accvgpr_read_b32 v43, a3
    s_mov_b32 s29, 0
    buffer_store_dwordx4 v[40:43], v37, s[16:19], s29 offen
    v_accvgpr_read_b32 v56, a16
    v_accvgpr_read_b32 v57, a17
    v_accvgpr_read_b32 v58, a18
    v_accvgpr_read_b32 v59, a19
    s_mov_b32 s29, 64
    buffer_store_dwordx4 v[56:59], v37, s[16:19], s29 offen
    v_accvgpr_read_b32 v72, a32
    v_accvgpr_read_b32 v73, a33
    v_accvgpr_read_b32 v74, a34
    v_accvgpr_read_b32 v75, a35
    s_mov_b32 s29, 128
    buffer_store_dwordx4 v[72:75], v37, s[16:19], s29 offen
    v_accvgpr_read_b32 v88, a48
    v_accvgpr_read_b32 v89, a49
    v_accvgpr_read_b32 v90, a50
    v_accvgpr_read_b32 v91, a51
    s_mov_b32 s29, 192
    buffer_store_dwordx4 v[88:91], v37, s[16:19], s29 offen
    v_accvgpr_read_b32 v40, a4
    v_accvgpr_read_b32 v41, a5
    v_accvgpr_read_b32 v42, a6
    v_accvgpr_read_b32 v43, a7
    s_mov_b32 s29, 65536
    buffer_store_dwordx4 v[40:43], v37, s[16:19], s29 offen
    v_accvgpr_read_b32 v56, a20
    v_accvgpr_read_b32 v57, a21
    v_accvgpr_read_b32 v58, a22
    v_accvgpr_read_b32 v59, a23
    s_mov_b32 s29, 65600
    buffer_store_dwordx4 v[56:59], v37, s[16:19], s29 offen
    v_accvgpr_read_b32 v72, a36
    v_accvgpr_read_b32 v73, a37
    v_accvgpr_read_b32 v74, a38
    v_accvgpr_read_b32 v75, a39
    s_mov_b32 s29, 65664
    buffer_store_dwordx4 v[72:75], v37, s[16:19], s29 offen
    v_accvgpr_read_b32 v88, a52
    v_accvgpr_read_b32 v89, a53
    v_accvgpr_read_b32 v90, a54
    v_accvgpr_read_b32 v91, a55
    s_mov_b32 s29, 65728
    buffer_store_dwordx4 v[88:91], v37, s[16:19], s29 offen
    v_accvgpr_read_b32 v40, a8
    v_accvgpr_read_b32 v41, a9
    v_accvgpr_read_b32 v42, a10
    v_accvgpr_read_b32 v43, a11
    s_mov_b32 s29, 131072
    buffer_store_dwordx4 v[40:43], v37, s[16:19], s29 offen
    v_accvgpr_read_b32 v56, a24
    v_accvgpr_read_b32 v57, a25
    v_accvgpr_read_b32 v58, a26
    v_accvgpr_read_b32 v59, a27
    s_mov_b32 s29, 131136
    buffer_store_dwordx4 v[56:59], v37, s[16:19], s29 offen
    v_accvgpr_read_b32 v72, a40
    v_accvgpr_read_b32 v73, a41
    v_accvgpr_read_b32 v74, a42
    v_accvgpr_read_b32 v75, a43
    s_mov_b32 s29, 131200
    buffer_store_dwordx4 v[72:75], v37, s[16:19], s29 offen
    v_accvgpr_read_b32 v88, a56
    v_accvgpr_read_b32 v89, a57
    v_accvgpr_read_b32 v90, a58
    v_accvgpr_read_b32 v91, a59
    s_mov_b32 s29, 131264
    buffer_store_dwordx4 v[88:91], v37, s[16:19], s29 offen
    v_accvgpr_read_b32 v40, a12
    v_accvgpr_read_b32 v41, a13
    v_accvgpr_read_b32 v42, a14
    v_accvgpr_read_b32 v43, a15
    s_mov_b32 s29, 196608
    buffer_store_dwordx4 v[40:43], v37, s[16:19], s29 offen
    v_accvgpr_read_b32 v56, a28
    v_accvgpr_read_b32 v57, a29
    v_accvgpr_read_b32 v58, a30
    v_accvgpr_read_b32 v59, a31
    s_mov_b32 s29, 196672
    buffer_store_dwordx4 v[56:59], v37, s[16:19], s29 offen
    v_accvgpr_read_b32 v72, a44
    v_accvgpr_read_b32 v73, a45
    v_accvgpr_read_b32 v74, a46
    v_accvgpr_read_b32 v75, a47
    s_mov_b32 s29, 196736
    buffer_store_dwordx4 v[72:75], v37, s[16:19], s29 offen
    v_accvgpr_read_b32 v88, a60
    v_accvgpr_read_b32 v89, a61
    v_accvgpr_read_b32 v90, a62
    v_accvgpr_read_b32 v91, a63
    s_mov_b32 s29, 196800
    buffer_store_dwordx4 v[88:91], v37, s[16:19], s29 offen
gemm_b2_kernel_end:
    s_endpgm
.section .rodata,"a"
.p2align 6
.amdhsa_kernel gemm_b2_kernel
  .amdhsa_next_free_vgpr 168
  .amdhsa_next_free_sgpr 48
  .amdhsa_accum_offset 104
  .amdhsa_group_segment_fixed_size 0
  .amdhsa_kernarg_size 96
  .amdhsa_user_sgpr_count 2
  .amdhsa_user_sgpr_kernarg_segment_ptr 1
  .amdhsa_system_sgpr_workgroup_id_x 1
  .amdhsa_float_denorm_mode_32 3
  .amdhsa_float_denorm_mode_16_64 3
.end_amdhsa_kernel

.text
.globl ln_first_kernel
.p2align 8
.type ln_first_kernel,@function
ln_first_kernel:
    s_cmp_ge_u32 s2, 512
    s_cbranch_scc1 ln_first_kernel_end
    s_load_dwordx2 s[4:5], s[0:1], 0
    s_load_dwordx2 s[6:7], s[0:1], 88
    s_load_dwordx2 s[8:9], s[0:1], 72
    s_waitcnt lgkmcnt(0)
    s_mov_b32 s12, s4
    s_mov_b32 s13, s5
    s_mov_b32 s14, 4194304
    s_mov_b32 s15, 0x20000
    s_mov_b32 s28, s6
    s_mov_b32 s29, s7
    s_mov_b32 s30, 4194304
    s_mov_b32 s31, 0x20000
    s_mov_b32 s32, 0xffff0000
    v_and_b32 v1, 63, v0
    v_lshrrev_b32 v2, 6, v0
    s_lshl_b32 s3, s2, 2
    v_add_u32 v2, s3, v2
    v_lshlrev_b32 v3, 11, v2
    v_lshl_add_u32 v3, v1, 4, v3
    v_lshlrev_b32 v4, 12, v2
    v_lshl_add_u32 v4, v1, 5, v4
    buffer_load_dwordx4 v[8:11], v3, s[12:15], 0 offen
    buffer_load_dwordx4 v[12:15], v3, s[12:15], 0 offen offset:1024
    s_waitcnt vmcnt(0)
    v_lshlrev_b32 v16, 16, v8
    v_and_b32 v17, s32, v8
    v_lshlrev_b32 v18, 16, v9
    v_and_b32 v19, s32, v9
    v_lshlrev_b32 v20, 16, v10
    v_and_b32 v21, s32, v10
    v_lshlrev_b32 v22, 16, v11
    v_and_b32 v23, s32, v11
    v_lshlrev_b32 v24, 16, v12
    v_and_b32 v25, s32, v12
    v_lshlrev_b32 v26, 16, v13
    v_and_b32 v27, s32, v13
    v_lshlrev_b32 v28, 16, v14
    v_and_b32 v29, s32, v14
    v_lshlrev_b32 v30, 16, v15
    v_and_b32 v31, s32, v15
    v_add_f32 v56, v16, v17
    v_add_f32 v56, v56, v18
    v_add_f32 v56, v56, v19
    v_add_f32 v56, v56, v20
    v_add_f32 v56, v56, v21
    v_add_f32 v56, v56, v22
    v_add_f32 v56, v56, v23
    v_add_f32 v56, v56, v24
    v_add_f32 v56, v56, v25
    v_add_f32 v56, v56, v26
    v_add_f32 v56, v56, v27
    v_add_f32 v56, v56, v28
    v_add_f32 v56, v56, v29
    v_add_f32 v56, v56, v30
    v_add_f32 v56, v56, v31
    s_nop 1
    v_add_f32_dpp v56, v56, v56 row_shr:1 row_mask:0xf bank_mask:0xf
    s_nop 1
    v_add_f32_dpp v56, v56, v56 row_shr:2 row_mask:0xf bank_mask:0xf
    s_nop 1
    v_add_f32_dpp v56, v56, v56 row_shr:4 row_mask:0xf bank_mask:0xf
    s_nop 1
    v_add_f32_dpp v56, v56, v56 row_shr:8 row_mask:0xf bank_mask:0xf
    s_nop 1
    v_add_f32_dpp v56, v56, v56 row_bcast:15 row_mask:0xa bank_mask:0xf
    s_nop 1
    v_add_f32_dpp v56, v56, v56 row_bcast:31 row_mask:0xc bank_mask:0xf
    s_nop 1
    v_readlane_b32 s34, v56, 63
    s_nop 1
    v_mov_b32 v57, 0x3a800000
    v_mul_f32 v57, s34, v57
    v_cvt_pk_bf16_f32 v58, v57, v57
    v_and_b32 v58, s32, v58
    v_sub_f32 v59, v16, v57
    v_mul_f32 v56, v59, v59
    v_sub_f32 v59, v17, v57
    v_fmac_f32 v56, v59, v59
    v_sub_f32 v59, v18, v57
    v_fmac_f32 v56, v59, v59
    v_sub_f32 v59, v19, v57
    v_fmac_f32 v56, v59, v59
    v_sub_f32 v59, v20, v57
    v_fmac_f32 v56, v59, v59
    v_sub_f32 v59, v21, v57
    v_fmac_f32 v56, v59, v59
    v_sub_f32 v59, v22, v57
    v_fmac_f32 v56, v59, v59
    v_sub_f32 v59, v23, v57
    v_fmac_f32 v56, v59, v59
    v_sub_f32 v59, v24, v57
    v_fmac_f32 v56, v59, v59
    v_sub_f32 v59, v25, v57
    v_fmac_f32 v56, v59, v59
    v_sub_f32 v59, v26, v57
    v_fmac_f32 v56, v59, v59
    v_sub_f32 v59, v27, v57
    v_fmac_f32 v56, v59, v59
    v_sub_f32 v59, v28, v57
    v_fmac_f32 v56, v59, v59
    v_sub_f32 v59, v29, v57
    v_fmac_f32 v56, v59, v59
    v_sub_f32 v59, v30, v57
    v_fmac_f32 v56, v59, v59
    v_sub_f32 v59, v31, v57
    v_fmac_f32 v56, v59, v59
    s_nop 1
    v_add_f32_dpp v56, v56, v56 row_shr:1 row_mask:0xf bank_mask:0xf
    s_nop 1
    v_add_f32_dpp v56, v56, v56 row_shr:2 row_mask:0xf bank_mask:0xf
    s_nop 1
    v_add_f32_dpp v56, v56, v56 row_shr:4 row_mask:0xf bank_mask:0xf
    s_nop 1
    v_add_f32_dpp v56, v56, v56 row_shr:8 row_mask:0xf bank_mask:0xf
    s_nop 1
    v_add_f32_dpp v56, v56, v56 row_bcast:15 row_mask:0xa bank_mask:0xf
    s_nop 1
    v_add_f32_dpp v56, v56, v56 row_bcast:31 row_mask:0xc bank_mask:0xf
    s_nop 1
    v_readlane_b32 s35, v56, 63
    s_nop 1
    v_mov_b32 v60, 0x3a800000
    v_mul_f32 v60, s35, v60
    v_cvt_pk_bf16_f32 v60, v60, v60
    v_and_b32 v60, s32, v60
    v_add_f32 v60, 0x3727c5ac, v60
    v_cvt_pk_bf16_f32 v60, v60, v60
    v_and_b32 v60, s32, v60
    v_sqrt_f32 v60, v60
    s_nop 0
    v_cvt_pk_bf16_f32 v60, v60, v60
    v_and_b32 v60, s32, v60
    v_rcp_f32 v61, v60
    v_sub_f32 v32, v16, v58
    v_sub_f32 v33, v17, v58
    v_sub_f32 v34, v18, v58
    v_sub_f32 v35, v19, v58
    v_sub_f32 v36, v20, v58
    v_sub_f32 v37, v21, v58
    v_sub_f32 v38, v22, v58
    v_sub_f32 v39, v23, v58
    v_sub_f32 v40, v24, v58
    v_sub_f32 v41, v25, v58
    v_sub_f32 v42, v26, v58
    v_sub_f32 v43, v27, v58
    v_sub_f32 v44, v28, v58
    v_sub_f32 v45, v29, v58
    v_sub_f32 v46, v30, v58
    v_sub_f32 v47, v31, v58
    v_cvt_pk_bf16_f32 v48, v32, v33
    v_cvt_pk_bf16_f32 v49, v34, v35
    v_cvt_pk_bf16_f32 v50, v36, v37
    v_cvt_pk_bf16_f32 v51, v38, v39
    v_cvt_pk_bf16_f32 v52, v40, v41
    v_cvt_pk_bf16_f32 v53, v42, v43
    v_cvt_pk_bf16_f32 v54, v44, v45
    v_cvt_pk_bf16_f32 v55, v46, v47
    v_lshlrev_b32 v32, 16, v48
    v_and_b32 v33, s32, v48
    v_lshlrev_b32 v34, 16, v49
    v_and_b32 v35, s32, v49
    v_lshlrev_b32 v36, 16, v50
    v_and_b32 v37, s32, v50
    v_lshlrev_b32 v38, 16, v51
    v_and_b32 v39, s32, v51
    v_lshlrev_b32 v40, 16, v52
    v_and_b32 v41, s32, v52
    v_lshlrev_b32 v42, 16, v53
    v_and_b32 v43, s32, v53
    v_lshlrev_b32 v44, 16, v54
    v_and_b32 v45, s32, v54
    v_lshlrev_b32 v46, 16, v55
    v_and_b32 v47, s32, v55
    v_mul_f32 v16, v32, v61
    v_mul_f32 v17, v33, v61
    v_mul_f32 v18, v34, v61
    v_mul_f32 v19, v35, v61
    v_mul_f32 v20, v36, v61
    v_mul_f32 v21, v37, v61
    v_mul_f32 v22, v38, v61
    v_mul_f32 v23, v39, v61
    v_mul_f32 v24, v40, v61
    v_mul_f32 v25, v41, v61
    v_mul_f32 v26, v42, v61
    v_mul_f32 v27, v43, v61
    v_mul_f32 v28, v44, v61
    v_mul_f32 v29, v45, v61
    v_mul_f32 v30, v46, v61
    v_mul_f32 v31, v47, v61
    v_fma_f32 v32, -v16, v60, v32
    v_fma_f32 v33, -v17, v60, v33
    v_fma_f32 v34, -v18, v60, v34
    v_fma_f32 v35, -v19, v60, v35
    v_fma_f32 v36, -v20, v60, v36
    v_fma_f32 v37, -v21, v60, v37
    v_fma_f32 v38, -v22, v60, v38
    v_fma_f32 v39, -v23, v60, v39
    v_fma_f32 v40, -v24, v60, v40
    v_fma_f32 v41, -v25, v60, v41
    v_fma_f32 v42, -v26, v60, v42
    v_fma_f32 v43, -v27, v60, v43
    v_fma_f32 v44, -v28, v60, v44
    v_fma_f32 v45, -v29, v60, v45
    v_fma_f32 v46, -v30, v60, v46
    v_fma_f32 v47, -v31, v60, v47
    v_fmac_f32 v16, v32, v61
    v_fmac_f32 v17, v33, v61
    v_fmac_f32 v18, v34, v61
    v_fmac_f32 v19, v35, v61
    v_fmac_f32 v20, v36, v61
    v_fmac_f32 v21, v37, v61
    v_fmac_f32 v22, v38, v61
    v_fmac_f32 v23, v39, v61
    v_fmac_f32 v24, v40, v61
    v_fmac_f32 v25, v41, v61
    v_fmac_f32 v26, v42, v61
    v_fmac_f32 v27, v43, v61
    v_fmac_f32 v28, v44, v61
    v_fmac_f32 v29, v45, v61
    v_fmac_f32 v30, v46, v61
    v_fmac_f32 v31, v47, v61
    v_cvt_pk_bf16_f32 v64, v16, v17
    v_cvt_pk_bf16_f32 v65, v18, v19
    v_cvt_pk_bf16_f32 v66, v20, v21
    v_cvt_pk_bf16_f32 v67, v22, v23
    v_cvt_pk_bf16_f32 v68, v24, v25
    v_cvt_pk_bf16_f32 v69, v26, v27
    v_cvt_pk_bf16_f32 v70, v28, v29
    v_cvt_pk_bf16_f32 v71, v30, v31
    buffer_store_dwordx4 v[64:67], v3, s[28:31], 0 offen
    buffer_store_dwordx4 v[68:71], v3, s[28:31], 0 offen offset:1024
ln_first_kernel_end:
    s_endpgm
.section .rodata,"a"
.p2align 6
.amdhsa_kernel ln_first_kernel
  .amdhsa_next_free_vgpr 72
  .amdhsa_next_free_sgpr 40
  .amdhsa_accum_offset 72
  .amdhsa_group_segment_fixed_size 0
  .amdhsa_kernarg_size 96
  .amdhsa_user_sgpr_count 2
  .amdhsa_user_sgpr_kernarg_segment_ptr 1
  .amdhsa_system_sgpr_workgroup_id_x 1
  .amdhsa_float_denorm_mode_32 3
  .amdhsa_float_denorm_mode_16_64 3
.end_amdhsa_kernel

.text
.globl ln_a_in_kernel
.p2align 8
.type ln_a_in_kernel,@function
ln_a_in_kernel:
    s_cmp_ge_u32 s2, 512
    s_cbranch_scc1 ln_a_in_kernel_end
    s_load_dwordx2 s[4:5], s[0:1], 0
    s_load_dwordx2 s[6:7], s[0:1], 88
    s_load_dwordx2 s[8:9], s[0:1], 72
    s_waitcnt lgkmcnt(0)
    s_mov_b32 s12, s4
    s_mov_b32 s13, s5
    s_mov_b32 s14, 4194304
    s_mov_b32 s15, 0x20000
    s_add_u32 s16, s6, 12582912
    s_addc_u32 s17, s7, 0
    s_mov_b32 s18, 4194304
    s_mov_b32 s19, 0x20000
    s_add_u32 s20, s6, 16777216
    s_addc_u32 s21, s7, 0
    s_mov_b32 s22, 4194304
    s_mov_b32 s23, 0x20000
    s_add_u32 s24, s6, 20971520
    s_addc_u32 s25, s7, 0
    s_mov_b32 s26, 4194304
    s_mov_b32 s27, 0x20000
    s_mov_b32 s28, s6
    s_mov_b32 s29, s7
    s_mov_b32 s30, 4194304
    s_mov_b32 s31, 0x20000
    s_mov_b32 s32, 0xffff0000
    v_and_b32 v1, 63, v0
    v_lshrrev_b32 v2, 6, v0
    s_lshl_b32 s3, s2, 2
    v_add_u32 v2, s3, v2
    v_lshlrev_b32 v3, 11, v2
    v_lshl_add_u32 v3, v1, 4, v3
    v_lshlrev_b32 v4, 12, v2
    v_lshl_add_u32 v4, v1, 5, v4
    buffer_load_dwordx4 v[8:11], v3, s[12:15], 0 offen
    buffer_load_dwordx4 v[12:15], v3, s[12:15], 0 offen offset:1024
    buffer_load_dwordx4 v[16:19], v3, s[16:19], 0 offen
    buffer_load_dwordx4 v[20:23], v3, s[16:19], 0 offen offset:1024
    buffer_load_dwordx4 v[24:27], v3, s[20:23], 0 offen
    buffer_load_dwordx4 v[28:31], v3, s[20:23], 0 offen offset:1024
    s_waitcnt vmcnt(0)
    v_lshlrev_b32 v32, 16, v8
    v_and_b32 v33, s32, v8
    v_lshlrev_b32 v34, 16, v9
    v_and_b32 v35, s32, v9
    v_lshlrev_b32 v36, 16, v10
    v_and_b32 v37, s32, v10
    v_lshlrev_b32 v38, 16, v11
    v_and_b32 v39, s32, v11
    v_lshlrev_b32 v40, 16, v12
    v_and_b32 v41, s32, v12
    v_lshlrev_b32 v42, 16, v13
    v_and_b32 v43, s32, v13
    v_lshlrev_b32 v44, 16, v14
    v_and_b32 v45, s32, v14
    v_lshlrev_b32 v46, 16, v15
    v_and_b32 v47, s32, v15
    v_lshlrev_b32 v48, 16, v16
    v_and_b32 v49, s32, v16
    v_lshlrev_b32 v50, 16, v17
    v_and_b32 v51, s32, v17
    v_lshlrev_b32 v52, 16, v18
    v_and_b32 v53, s32, v18
    v_lshlrev_b32 v54, 16, v19
    v_and_b32 v55, s32, v19
    v_lshlrev_b32 v56, 16, v20
    v_and_b32 v57, s32, v20
    v_lshlrev_b32 v58, 16, v21
    v_and_b32 v59, s32, v21
    v_lshlrev_b32 v60, 16, v22
    v_and_b32 v61, s32, v22
    v_lshlrev_b32 v62, 16, v23
    v_and_b32 v63, s32, v23
    v_lshlrev_b32 v72, 16, v24
    v_and_b32 v73, s32, v24
    v_lshlrev_b32 v74, 16, v25
    v_and_b32 v75, s32, v25
    v_lshlrev_b32 v76, 16, v26
    v_and_b32 v77, s32, v26
    v_lshlrev_b32 v78, 16, v27
    v_and_b32 v79, s32, v27
    v_lshlrev_b32 v80, 16, v28
    v_and_b32 v81, s32, v28
    v_lshlrev_b32 v82, 16, v29
    v_and_b32 v83, s32, v29
    v_lshlrev_b32 v84, 16, v30
    v_and_b32 v85, s32, v30
    v_lshlrev_b32 v86, 16, v31
    v_and_b32 v87, s32, v31
    v_sub_f32 v48, v48, v72
    v_sub_f32 v49, v49, v73
    v_sub_f32 v50, v50, v74
    v_sub_f32 v51, v51, v75
    v_sub_f32 v52, v52, v76
    v_sub_f32 v53, v53, v77
    v_sub_f32 v54, v54, v78
    v_sub_f32 v55, v55, v79
    v_sub_f32 v56, v56, v80
    v_sub_f32 v57, v57, v81
    v_sub_f32 v58, v58, v82
    v_sub_f32 v59, v59, v83
    v_sub_f32 v60, v60, v84
    v_sub_f32 v61, v61, v85
    v_sub_f32 v62, v62, v86
    v_sub_f32 v63, v63, v87
    v_cvt_pk_bf16_f32 v64, v48, v49
    v_cvt_pk_bf16_f32 v65, v50, v51
    v_cvt_pk_bf16_f32 v66, v52, v53
    v_cvt_pk_bf16_f32 v67, v54, v55
    v_cvt_pk_bf16_f32 v68, v56, v57
    v_cvt_pk_bf16_f32 v69, v58, v59
    v_cvt_pk_bf16_f32 v70, v60, v61
    v_cvt_pk_bf16_f32 v71, v62, v63
    v_lshlrev_b32 v48, 16, v64
    v_and_b32 v49, s32, v64
    v_lshlrev_b32 v50, 16, v65
    v_and_b32 v51, s32, v65
    v_lshlrev_b32 v52, 16, v66
    v_and_b32 v53, s32, v66
    v_lshlrev_b32 v54, 16, v67
    v_and_b32 v55, s32, v67
    v_lshlrev_b32 v56, 16, v68
    v_and_b32 v57, s32, v68
    v_lshlrev_b32 v58, 16, v69
    v_and_b32 v59, s32, v69
    v_lshlrev_b32 v60, 16, v70
    v_and_b32 v61, s32, v70
    v_lshlrev_b32 v62, 16, v71
    v_and_b32 v63, s32, v71
    v_add_f32 v32, v32, v48
    v_add_f32 v33, v33, v49
    v_add_f32 v34, v34, v50
    v_add_f32 v35, v35, v51
    v_add_f32 v36, v36, v52
    v_add_f32 v37, v37, v53
    v_add_f32 v38, v38, v54
    v_add_f32 v39, v39, v55
    v_add_f32 v40, v40, v56
    v_add_f32 v41, v41, v57
    v_add_f32 v42, v42, v58
    v_add_f32 v43, v43, v59
    v_add_f32 v44, v44, v60
    v_add_f32 v45, v45, v61
    v_add_f32 v46, v46, v62
    v_add_f32 v47, v47, v63
    v_cvt_pk_bf16_f32 v64, v32, v33
    v_cvt_pk_bf16_f32 v65, v34, v35
    v_cvt_pk_bf16_f32 v66, v36, v37
    v_cvt_pk_bf16_f32 v67, v38, v39
    v_cvt_pk_bf16_f32 v68, v40, v41
    v_cvt_pk_bf16_f32 v69, v42, v43
    v_cvt_pk_bf16_f32 v70, v44, v45
    v_cvt_pk_bf16_f32 v71, v46, v47
    v_lshlrev_b32 v32, 16, v64
    v_and_b32 v33, s32, v64
    v_lshlrev_b32 v34, 16, v65
    v_and_b32 v35, s32, v65
    v_lshlrev_b32 v36, 16, v66
    v_and_b32 v37, s32, v66
    v_lshlrev_b32 v38, 16, v67
    v_and_b32 v39, s32, v67
    v_lshlrev_b32 v40, 16, v68
    v_and_b32 v41, s32, v68
    v_lshlrev_b32 v42, 16, v69
    v_and_b32 v43, s32, v69
    v_lshlrev_b32 v44, 16, v70
    v_and_b32 v45, s32, v70
    v_lshlrev_b32 v46, 16, v71
    v_and_b32 v47, s32, v71
    buffer_store_dwordx4 v[64:67], v3, s[24:27], 0 offen
    buffer_store_dwordx4 v[68:71], v3, s[24:27], 0 offen offset:1024
    v_add_f32 v88, v32, v33
    v_add_f32 v88, v88, v34
    v_add_f32 v88, v88, v35
    v_add_f32 v88, v88, v36
    v_add_f32 v88, v88, v37
    v_add_f32 v88, v88, v38
    v_add_f32 v88, v88, v39
    v_add_f32 v88, v88, v40
    v_add_f32 v88, v88, v41
    v_add_f32 v88, v88, v42
    v_add_f32 v88, v88, v43
    v_add_f32 v88, v88, v44
    v_add_f32 v88, v88, v45
    v_add_f32 v88, v88, v46
    v_add_f32 v88, v88, v47
    s_nop 1
    v_add_f32_dpp v88, v88, v88 row_shr:1 row_mask:0xf bank_mask:0xf
    s_nop 1
    v_add_f32_dpp v88, v88, v88 row_shr:2 row_mask:0xf bank_mask:0xf
    s_nop 1
    v_add_f32_dpp v88, v88, v88 row_shr:4 row_mask:0xf bank_mask:0xf
    s_nop 1
    v_add_f32_dpp v88, v88, v88 row_shr:8 row_mask:0xf bank_mask:0xf
    s_nop 1
    v_add_f32_dpp v88, v88, v88 row_bcast:15 row_mask:0xa bank_mask:0xf
    s_nop 1
    v_add_f32_dpp v88, v88, v88 row_bcast:31 row_mask:0xc bank_mask:0xf
    s_nop 1
    v_readlane_b32 s34, v88, 63
    s_nop 1
    v_mov_b32 v89, 0x3a800000
    v_mul_f32 v89, s34, v89
    v_cvt_pk_bf16_f32 v90, v89, v89
    v_and_b32 v90, s32, v90
    v_sub_f32 v91, v32, v89
    v_mul_f32 v88, v91, v91
    v_sub_f32 v91, v33, v89
    v_fmac_f32 v88, v91, v91
    v_sub_f32 v91, v34, v89
    v_fmac_f32 v88, v91, v91
    v_sub_f32 v91, v35, v89
    v_fmac_f32 v88, v91, v91
    v_sub_f32 v91, v36, v89
    v_fmac_f32 v88, v91, v91
    v_sub_f32 v91, v37, v89
    v_fmac_f32 v88, v91, v91
    v_sub_f32 v91, v38, v89
    v_fmac_f32 v88, v91, v91
    v_sub_f32 v91, v39, v89
    v_fmac_f32 v88, v91, v91
    v_sub_f32 v91, v40, v89
    v_fmac_f32 v88, v91, v91
    v_sub_f32 v91, v41, v89
    v_fmac_f32 v88, v91, v91
    v_sub_f32 v91, v42, v89
    v_fmac_f32 v88, v91, v91
    v_sub_f32 v91, v43, v89
    v_fmac_f32 v88, v91, v91
    v_sub_f32 v91, v44, v89
    v_fmac_f32 v88, v91, v91
    v_sub_f32 v91, v45, v89
    v_fmac_f32 v88, v91, v91
    v_sub_f32 v91, v46, v89
    v_fmac_f32 v88, v91, v91
    v_sub_f32 v91, v47, v89
    v_fmac_f32 v88, v91, v91
    s_nop 1
    v_add_f32_dpp v88, v88, v88 row_shr:1 row_mask:0xf bank_mask:0xf
    s_nop 1
    v_add_f32_dpp v88, v88, v88 row_shr:2 row_mask:0xf bank_mask:0xf
    s_nop 1
    v_add_f32_dpp v88, v88, v88 row_shr:4 row_mask:0xf bank_mask:0xf
    s_nop 1
    v_add_f32_dpp v88, v88, v88 row_shr:8 row_mask:0xf bank_mask:0xf
    s_nop 1
    v_add_f32_dpp v88, v88, v88 row_bcast:15 row_mask:0xa bank_mask:0xf
    s_nop 1
    v_add_f32_dpp v88, v88, v88 row_bcast:31 row_mask:0xc bank_mask:0xf
    s_nop 1
    v_readlane_b32 s35, v88, 63
    s_nop 1
    v_mov_b32 v92, 0x3a800000
    v_mul_f32 v92, s35, v92
    v_cvt_pk_bf16_f32 v92, v92, v92
    v_and_b32 v92, s32, v92
    v_add_f32 v92, 0x3727c5ac, v92
    v_cvt_pk_bf16_f32 v92, v92, v92
    v_and_b32 v92, s32, v92
    v_sqrt_f32 v92, v92
    s_nop 0
    v_cvt_pk_bf16_f32 v92, v92, v92
    v_and_b32 v92, s32, v92
    v_rcp_f32 v93, v92
    v_sub_f32 v48, v32, v90
    v_sub_f32 v49, v33, v90
    v_sub_f32 v50, v34, v90
    v_sub_f32 v51, v35, v90
    v_sub_f32 v52, v36, v90
    v_sub_f32 v53, v37, v90
    v_sub_f32 v54, v38, v90
    v_sub_f32 v55, v39, v90
    v_sub_f32 v56, v40, v90
    v_sub_f32 v57, v41, v90
    v_sub_f32 v58, v42, v90
    v_sub_f32 v59, v43, v90
    v_sub_f32 v60, v44, v90
    v_sub_f32 v61, v45, v90
    v_sub_f32 v62, v46, v90
    v_sub_f32 v63, v47, v90
    v_cvt_pk_bf16_f32 v64, v48, v49
    v_cvt_pk_bf16_f32 v65, v50, v51
    v_cvt_pk_bf16_f32 v66, v52, v53
    v_cvt_pk_bf16_f32 v67, v54, v55
    v_cvt_pk_bf16_f32 v68, v56, v57
    v_cvt_pk_bf16_f32 v69, v58, v59
    v_cvt_pk_bf16_f32 v70, v60, v61
    v_cvt_pk_bf16_f32 v71, v62, v63
    v_lshlrev_b32 v48, 16, v64
    v_and_b32 v49, s32, v64
    v_lshlrev_b32 v50, 16, v65
    v_and_b32 v51, s32, v65
    v_lshlrev_b32 v52, 16, v66
    v_and_b32 v53, s32, v66
    v_lshlrev_b32 v54, 16, v67
    v_and_b32 v55, s32, v67
    v_lshlrev_b32 v56, 16, v68
    v_and_b32 v57, s32, v68
    v_lshlrev_b32 v58, 16, v69
    v_and_b32 v59, s32, v69
    v_lshlrev_b32 v60, 16, v70
    v_and_b32 v61, s32, v70
    v_lshlrev_b32 v62, 16, v71
    v_and_b32 v63, s32, v71
    v_mul_f32 v32, v48, v93
    v_mul_f32 v33, v49, v93
    v_mul_f32 v34, v50, v93
    v_mul_f32 v35, v51, v93
    v_mul_f32 v36, v52, v93
    v_mul_f32 v37, v53, v93
    v_mul_f32 v38, v54, v93
    v_mul_f32 v39, v55, v93
    v_mul_f32 v40, v56, v93
    v_mul_f32 v41, v57, v93
    v_mul_f32 v42, v58, v93
    v_mul_f32 v43, v59, v93
    v_mul_f32 v44, v60, v93
    v_mul_f32 v45, v61, v93
    v_mul_f32 v46, v62, v93
    v_mul_f32 v47, v63, v93
    v_fma_f32 v48, -v32, v92, v48
    v_fma_f32 v49, -v33, v92, v49
    v_fma_f32 v50, -v34, v92, v50
    v_fma_f32 v51, -v35, v92, v51
    v_fma_f32 v52, -v36, v92, v52
    v_fma_f32 v53, -v37, v92, v53
    v_fma_f32 v54, -v38, v92, v54
    v_fma_f32 v55, -v39, v92, v55
    v_fma_f32 v56, -v40, v92, v56
    v_fma_f32 v57, -v41, v92, v57
    v_fma_f32 v58, -v42, v92, v58
    v_fma_f32 v59, -v43, v92, v59
    v_fma_f32 v60, -v44, v92, v60
    v_fma_f32 v61, -v45, v92, v61
    v_fma_f32 v62, -v46, v92, v62
    v_fma_f32 v63, -v47, v92, v63
    v_fmac_f32 v32, v48, v93
    v_fmac_f32 v33, v49, v93
    v_fmac_f32 v34, v50, v93
    v_fmac_f32 v35, v51, v93
    v_fmac_f32 v36, v52, v93
    v_fmac_f32 v37, v53, v93
    v_fmac_f32 v38, v54, v93
    v_fmac_f32 v39, v55, v93
    v_fmac_f32 v40, v56, v93
    v_fmac_f32 v41, v57, v93
    v_fmac_f32 v42, v58, v93
    v_fmac_f32 v43, v59, v93
    v_fmac_f32 v44, v60, v93
    v_fmac_f32 v45, v61, v93
    v_fmac_f32 v46, v62, v93
    v_fmac_f32 v47, v63, v93
    v_cvt_pk_bf16_f32 v96, v32, v33
    v_cvt_pk_bf16_f32 v97, v34, v35
    v_cvt_pk_bf16_f32 v98, v36, v37
    v_cvt_pk_bf16_f32 v99, v38, v39
    v_cvt_pk_bf16_f32 v100, v40, v41
    v_cvt_pk_bf16_f32 v101, v42, v43
    v_cvt_pk_bf16_f32 v102, v44, v45
    v_cvt_pk_bf16_f32 v103, v46, v47
    buffer_store_dwordx4 v[96:99], v3, s[28:31], 0 offen
    buffer_store_dwordx4 v[100:103], v3, s[28:31], 0 offen offset:1024
ln_a_in_kernel_end:
    s_endpgm
.section .rodata,"a"
.p2align 6
.amdhsa_kernel ln_a_in_kernel
  .amdhsa_next_free_vgpr 104
  .amdhsa_next_free_sgpr 40
  .amdhsa_accum_offset 104
  .amdhsa_group_segment_fixed_size 0
  .amdhsa_kernarg_size 96
  .amdhsa_user_sgpr_count 2
  .amdhsa_user_sgpr_kernarg_segment_ptr 1
  .amdhsa_system_sgpr_workgroup_id_x 1
  .amdhsa_float_denorm_mode_32 3
  .amdhsa_float_denorm_mode_16_64 3
.end_amdhsa_kernel

.text
.globl ln_a_ws_kernel
.p2align 8
.type ln_a_ws_kernel,@function
ln_a_ws_kernel:
    s_cmp_ge_u32 s2, 512
    s_cbranch_scc1 ln_a_ws_kernel_end
    s_load_dwordx2 s[4:5], s[0:1], 0
    s_load_dwordx2 s[6:7], s[0:1], 88
    s_load_dwordx2 s[8:9], s[0:1], 72
    s_waitcnt lgkmcnt(0)
    s_add_u32 s12, s6, 20971520
    s_addc_u32 s13, s7, 0
    s_mov_b32 s14, 4194304
    s_mov_b32 s15, 0x20000
    s_add_u32 s16, s6, 12582912
    s_addc_u32 s17, s7, 0
    s_mov_b32 s18, 4194304
    s_mov_b32 s19, 0x20000
    s_add_u32 s20, s6, 16777216
    s_addc_u32 s21, s7, 0
    s_mov_b32 s22, 4194304
    s_mov_b32 s23, 0x20000
    s_add_u32 s24, s6, 20971520
    s_addc_u32 s25, s7, 0
    s_mov_b32 s26, 4194304
    s_mov_b32 s27, 0x20000
    s_mov_b32 s28, s6
    s_mov_b32 s29, s7
    s_mov_b32 s30, 4194304
    s_mov_b32 s31, 0x20000
    s_mov_b32 s32, 0xffff0000
    v_and_b32 v1, 63, v0
    v_lshrrev_b32 v2, 6, v0
    s_lshl_b32 s3, s2, 2
    v_add_u32 v2, s3, v2
    v_lshlrev_b32 v3, 11, v2
    v_lshl_add_u32 v3, v1, 4, v3
    v_lshlrev_b32 v4, 12, v2
    v_lshl_add_u32 v4, v1, 5, v4
    buffer_load_dwordx4 v[8:11], v3, s[12:15], 0 offen
    buffer_load_dwordx4 v[12:15], v3, s[12:15], 0 offen offset:1024
    buffer_load_dwordx4 v[16:19], v3, s[16:19], 0 offen
    buffer_load_dwordx4 v[20:23], v3, s[16:19], 0 offen offset:1024
    buffer_load_dwordx4 v[24:27], v3, s[20:23], 0 offen
    buffer_load_dwordx4 v[28:31], v3, s[20:23], 0 offen offset:1024
    s_waitcnt vmcnt(0)
    v_lshlrev_b32 v32, 16, v8
    v_and_b32 v33, s32, v8
    v_lshlrev_b32 v34, 16, v9
    v_and_b32 v35, s32, v9
    v_lshlrev_b32 v36, 16, v10
    v_and_b32 v37, s32, v10
    v_lshlrev_b32 v38, 16, v11
    v_and_b32 v39, s32, v11
    v_lshlrev_b32 v40, 16, v12
    v_and_b32 v41, s32, v12
    v_lshlrev_b32 v42, 16, v13
    v_and_b32 v43, s32, v13
    v_lshlrev_b32 v44, 16, v14
    v_and_b32 v45, s32, v14
    v_lshlrev_b32 v46, 16, v15
    v_and_b32 v47, s32, v15
    v_lshlrev_b32 v48, 16, v16
    v_and_b32 v49, s32, v16
    v_lshlrev_b32 v50, 16, v17
    v_and_b32 v51, s32, v17
    v_lshlrev_b32 v52, 16, v18
    v_and_b32 v53, s32, v18
    v_lshlrev_b32 v54, 16, v19
    v_and_b32 v55, s32, v19
    v_lshlrev_b32 v56, 16, v20
    v_and_b32 v57, s32, v20
    v_lshlrev_b32 v58, 16, v21
    v_and_b32 v59, s32, v21
    v_lshlrev_b32 v60, 16, v22
    v_and_b32 v61, s32, v22
    v_lshlrev_b32 v62, 16, v23
    v_and_b32 v63, s32, v23
    v_lshlrev_b32 v72, 16, v24
    v_and_b32 v73, s32, v24
    v_lshlrev_b32 v74, 16, v25
    v_and_b32 v75, s32, v25
    v_lshlrev_b32 v76, 16, v26
    v_and_b32 v77, s32, v26
    v_lshlrev_b32 v78, 16, v27
    v_and_b32 v79, s32, v27
    v_lshlrev_b32 v80, 16, v28
    v_and_b32 v81, s32, v28
    v_lshlrev_b32 v82, 16, v29
    v_and_b32 v83, s32, v29
    v_lshlrev_b32 v84, 16, v30
    v_and_b32 v85, s32, v30
    v_lshlrev_b32 v86, 16, v31
    v_and_b32 v87, s32, v31
    v_sub_f32 v48, v48, v72
    v_sub_f32 v49, v49, v73
    v_sub_f32 v50, v50, v74
    v_sub_f32 v51, v51, v75
    v_sub_f32 v52, v52, v76
    v_sub_f32 v53, v53, v77
    v_sub_f32 v54, v54, v78
    v_sub_f32 v55, v55, v79
    v_sub_f32 v56, v56, v80
    v_sub_f32 v57, v57, v81
    v_sub_f32 v58, v58, v82
    v_sub_f32 v59, v59, v83
    v_sub_f32 v60, v60, v84
    v_sub_f32 v61, v61, v85
    v_sub_f32 v62, v62, v86
    v_sub_f32 v63, v63, v87
    v_cvt_pk_bf16_f32 v64, v48, v49
    v_cvt_pk_bf16_f32 v65, v50, v51
    v_cvt_pk_bf16_f32 v66, v52, v53
    v_cvt_pk_bf16_f32 v67, v54, v55
    v_cvt_pk_bf16_f32 v68, v56, v57
    v_cvt_pk_bf16_f32 v69, v58, v59
    v_cvt_pk_bf16_f32 v70, v60, v61
    v_cvt_pk_bf16_f32 v71, v62, v63
    v_lshlrev_b32 v48, 16, v64
    v_and_b32 v49, s32, v64
    v_lshlrev_b32 v50, 16, v65
    v_and_b32 v51, s32, v65
    v_lshlrev_b32 v52, 16, v66
    v_and_b32 v53, s32, v66
    v_lshlrev_b32 v54, 16, v67
    v_and_b32 v55, s32, v67
    v_lshlrev_b32 v56, 16, v68
    v_and_b32 v57, s32, v68
    v_lshlrev_b32 v58, 16, v69
    v_and_b32 v59, s32, v69
    v_lshlrev_b32 v60, 16, v70
    v_and_b32 v61, s32, v70
    v_lshlrev_b32 v62, 16, v71
    v_and_b32 v63, s32, v71
    v_add_f32 v32, v32, v48
    v_add_f32 v33, v33, v49
    v_add_f32 v34, v34, v50
    v_add_f32 v35, v35, v51
    v_add_f32 v36, v36, v52
    v_add_f32 v37, v37, v53
    v_add_f32 v38, v38, v54
    v_add_f32 v39, v39, v55
    v_add_f32 v40, v40, v56
    v_add_f32 v41, v41, v57
    v_add_f32 v42, v42, v58
    v_add_f32 v43, v43, v59
    v_add_f32 v44, v44, v60
    v_add_f32 v45, v45, v61
    v_add_f32 v46, v46, v62
    v_add_f32 v47, v47, v63
    v_cvt_pk_bf16_f32 v64, v32, v33
    v_cvt_pk_bf16_f32 v65, v34, v35
    v_cvt_pk_bf16_f32 v66, v36, v37
    v_cvt_pk_bf16_f32 v67, v38, v39
    v_cvt_pk_bf16_f32 v68, v40, v41
    v_cvt_pk_bf16_f32 v69, v42, v43
    v_cvt_pk_bf16_f32 v70, v44, v45
    v_cvt_pk_bf16_f32 v71, v46, v47
    v_lshlrev_b32 v32, 16, v64
    v_and_b32 v33, s32, v64
    v_lshlrev_b32 v34, 16, v65
    v_and_b32 v35, s32, v65
    v_lshlrev_b32 v36, 16, v66
    v_and_b32 v37, s32, v66
    v_lshlrev_b32 v38, 16, v67
    v_and_b32 v39, s32, v67
    v_lshlrev_b32 v40, 16, v68
    v_and_b32 v41, s32, v68
    v_lshlrev_b32 v42, 16, v69
    v_and_b32 v43, s32, v69
    v_lshlrev_b32 v44, 16, v70
    v_and_b32 v45, s32, v70
    v_lshlrev_b32 v46, 16, v71
    v_and_b32 v47, s32, v71
    buffer_store_dwordx4 v[64:67], v3, s[24:27], 0 offen
    buffer_store_dwordx4 v[68:71], v3, s[24:27], 0 offen offset:1024
    v_add_f32 v88, v32, v33
    v_add_f32 v88, v88, v34
    v_add_f32 v88, v88, v35
    v_add_f32 v88, v88, v36
    v_add_f32 v88, v88, v37
    v_add_f32 v88, v88, v38
    v_add_f32 v88, v88, v39
    v_add_f32 v88, v88, v40
    v_add_f32 v88, v88, v41
    v_add_f32 v88, v88, v42
    v_add_f32 v88, v88, v43
    v_add_f32 v88, v88, v44
    v_add_f32 v88, v88, v45
    v_add_f32 v88, v88, v46
    v_add_f32 v88, v88, v47
    s_nop 1
    v_add_f32_dpp v88, v88, v88 row_shr:1 row_mask:0xf bank_mask:0xf
    s_nop 1
    v_add_f32_dpp v88, v88, v88 row_shr:2 row_mask:0xf bank_mask:0xf
    s_nop 1
    v_add_f32_dpp v88, v88, v88 row_shr:4 row_mask:0xf bank_mask:0xf
    s_nop 1
    v_add_f32_dpp v88, v88, v88 row_shr:8 row_mask:0xf bank_mask:0xf
    s_nop 1
    v_add_f32_dpp v88, v88, v88 row_bcast:15 row_mask:0xa bank_mask:0xf
    s_nop 1
    v_add_f32_dpp v88, v88, v88 row_bcast:31 row_mask:0xc bank_mask:0xf
    s_nop 1
    v_readlane_b32 s34, v88, 63
    s_nop 1
    v_mov_b32 v89, 0x3a800000
    v_mul_f32 v89, s34, v89
    v_cvt_pk_bf16_f32 v90, v89, v89
    v_and_b32 v90, s32, v90
    v_sub_f32 v91, v32, v89
    v_mul_f32 v88, v91, v91
    v_sub_f32 v91, v33, v89
    v_fmac_f32 v88, v91, v91
    v_sub_f32 v91, v34, v89
    v_fmac_f32 v88, v91, v91
    v_sub_f32 v91, v35, v89
    v_fmac_f32 v88, v91, v91
    v_sub_f32 v91, v36, v89
    v_fmac_f32 v88, v91, v91
    v_sub_f32 v91, v37, v89
    v_fmac_f32 v88, v91, v91
    v_sub_f32 v91, v38, v89
    v_fmac_f32 v88, v91, v91
    v_sub_f32 v91, v39, v89
    v_fmac_f32 v88, v91, v91
    v_sub_f32 v91, v40, v89
    v_fmac_f32 v88, v91, v91
    v_sub_f32 v91, v41, v89
    v_fmac_f32 v88, v91, v91
    v_sub_f32 v91, v42, v89
    v_fmac_f32 v88, v91, v91
    v_sub_f32 v91, v43, v89
    v_fmac_f32 v88, v91, v91
    v_sub_f32 v91, v44, v89
    v_fmac_f32 v88, v91, v91
    v_sub_f32 v91, v45, v89
    v_fmac_f32 v88, v91, v91
    v_sub_f32 v91, v46, v89
    v_fmac_f32 v88, v91, v91
    v_sub_f32 v91, v47, v89
    v_fmac_f32 v88, v91, v91
    s_nop 1
    v_add_f32_dpp v88, v88, v88 row_shr:1 row_mask:0xf bank_mask:0xf
    s_nop 1
    v_add_f32_dpp v88, v88, v88 row_shr:2 row_mask:0xf bank_mask:0xf
    s_nop 1
    v_add_f32_dpp v88, v88, v88 row_shr:4 row_mask:0xf bank_mask:0xf
    s_nop 1
    v_add_f32_dpp v88, v88, v88 row_shr:8 row_mask:0xf bank_mask:0xf
    s_nop 1
    v_add_f32_dpp v88, v88, v88 row_bcast:15 row_mask:0xa bank_mask:0xf
    s_nop 1
    v_add_f32_dpp v88, v88, v88 row_bcast:31 row_mask:0xc bank_mask:0xf
    s_nop 1
    v_readlane_b32 s35, v88, 63
    s_nop 1
    v_mov_b32 v92, 0x3a800000
    v_mul_f32 v92, s35, v92
    v_cvt_pk_bf16_f32 v92, v92, v92
    v_and_b32 v92, s32, v92
    v_add_f32 v92, 0x3727c5ac, v92
    v_cvt_pk_bf16_f32 v92, v92, v92
    v_and_b32 v92, s32, v92
    v_sqrt_f32 v92, v92
    s_nop 0
    v_cvt_pk_bf16_f32 v92, v92, v92
    v_and_b32 v92, s32, v92
    v_rcp_f32 v93, v92
    v_sub_f32 v48, v32, v90
    v_sub_f32 v49, v33, v90
    v_sub_f32 v50, v34, v90
    v_sub_f32 v51, v35, v90
    v_sub_f32 v52, v36, v90
    v_sub_f32 v53, v37, v90
    v_sub_f32 v54, v38, v90
    v_sub_f32 v55, v39, v90
    v_sub_f32 v56, v40, v90
    v_sub_f32 v57, v41, v90
    v_sub_f32 v58, v42, v90
    v_sub_f32 v59, v43, v90
    v_sub_f32 v60, v44, v90
    v_sub_f32 v61, v45, v90
    v_sub_f32 v62, v46, v90
    v_sub_f32 v63, v47, v90
    v_cvt_pk_bf16_f32 v64, v48, v49
    v_cvt_pk_bf16_f32 v65, v50, v51
    v_cvt_pk_bf16_f32 v66, v52, v53
    v_cvt_pk_bf16_f32 v67, v54, v55
    v_cvt_pk_bf16_f32 v68, v56, v57
    v_cvt_pk_bf16_f32 v69, v58, v59
    v_cvt_pk_bf16_f32 v70, v60, v61
    v_cvt_pk_bf16_f32 v71, v62, v63
    v_lshlrev_b32 v48, 16, v64
    v_and_b32 v49, s32, v64
    v_lshlrev_b32 v50, 16, v65
    v_and_b32 v51, s32, v65
    v_lshlrev_b32 v52, 16, v66
    v_and_b32 v53, s32, v66
    v_lshlrev_b32 v54, 16, v67
    v_and_b32 v55, s32, v67
    v_lshlrev_b32 v56, 16, v68
    v_and_b32 v57, s32, v68
    v_lshlrev_b32 v58, 16, v69
    v_and_b32 v59, s32, v69
    v_lshlrev_b32 v60, 16, v70
    v_and_b32 v61, s32, v70
    v_lshlrev_b32 v62, 16, v71
    v_and_b32 v63, s32, v71
    v_mul_f32 v32, v48, v93
    v_mul_f32 v33, v49, v93
    v_mul_f32 v34, v50, v93
    v_mul_f32 v35, v51, v93
    v_mul_f32 v36, v52, v93
    v_mul_f32 v37, v53, v93
    v_mul_f32 v38, v54, v93
    v_mul_f32 v39, v55, v93
    v_mul_f32 v40, v56, v93
    v_mul_f32 v41, v57, v93
    v_mul_f32 v42, v58, v93
    v_mul_f32 v43, v59, v93
    v_mul_f32 v44, v60, v93
    v_mul_f32 v45, v61, v93
    v_mul_f32 v46, v62, v93
    v_mul_f32 v47, v63, v93
    v_fma_f32 v48, -v32, v92, v48
    v_fma_f32 v49, -v33, v92, v49
    v_fma_f32 v50, -v34, v92, v50
    v_fma_f32 v51, -v35, v92, v51
    v_fma_f32 v52, -v36, v92, v52
    v_fma_f32 v53, -v37, v92, v53
    v_fma_f32 v54, -v38, v92, v54
    v_fma_f32 v55, -v39, v92, v55
    v_fma_f32 v56, -v40, v92, v56
    v_fma_f32 v57, -v41, v92, v57
    v_fma_f32 v58, -v42, v92, v58
    v_fma_f32 v59, -v43, v92, v59
    v_fma_f32 v60, -v44, v92, v60
    v_fma_f32 v61, -v45, v92, v61
    v_fma_f32 v62, -v46, v92, v62
    v_fma_f32 v63, -v47, v92, v63
    v_fmac_f32 v32, v48, v93
    v_fmac_f32 v33, v49, v93
    v_fmac_f32 v34, v50, v93
    v_fmac_f32 v35, v51, v93
    v_fmac_f32 v36, v52, v93
    v_fmac_f32 v37, v53, v93
    v_fmac_f32 v38, v54, v93
    v_fmac_f32 v39, v55, v93
    v_fmac_f32 v40, v56, v93
    v_fmac_f32 v41, v57, v93
    v_fmac_f32 v42, v58, v93
    v_fmac_f32 v43, v59, v93
    v_fmac_f32 v44, v60, v93
    v_fmac_f32 v45, v61, v93
    v_fmac_f32 v46, v62, v93
    v_fmac_f32 v47, v63, v93
    v_cvt_pk_bf16_f32 v96, v32, v33
    v_cvt_pk_bf16_f32 v97, v34, v35
    v_cvt_pk_bf16_f32 v98, v36, v37
    v_cvt_pk_bf16_f32 v99, v38, v39
    v_cvt_pk_bf16_f32 v100, v40, v41
    v_cvt_pk_bf16_f32 v101, v42, v43
    v_cvt_pk_bf16_f32 v102, v44, v45
    v_cvt_pk_bf16_f32 v103, v46, v47
    buffer_store_dwordx4 v[96:99], v3, s[28:31], 0 offen
    buffer_store_dwordx4 v[100:103], v3, s[28:31], 0 offen offset:1024
ln_a_ws_kernel_end:
    s_endpgm
.section .rodata,"a"
.p2align 6
.amdhsa_kernel ln_a_ws_kernel
  .amdhsa_next_free_vgpr 104
  .amdhsa_next_free_sgpr 40
  .amdhsa_accum_offset 104
  .amdhsa_group_segment_fixed_size 0
  .amdhsa_kernarg_size 96
  .amdhsa_user_sgpr_count 2
  .amdhsa_user_sgpr_kernarg_segment_ptr 1
  .amdhsa_system_sgpr_workgroup_id_x 1
  .amdhsa_float_denorm_mode_32 3
  .amdhsa_float_denorm_mode_16_64 3
.end_amdhsa_kernel

.text
.globl ln_b_kernel
.p2align 8
.type ln_b_kernel,@function
ln_b_kernel:
    s_cmp_ge_u32 s2, 512
    s_cbranch_scc1 ln_b_kernel_end
    s_load_dwordx2 s[4:5], s[0:1], 0
    s_load_dwordx2 s[6:7], s[0:1], 88
    s_load_dwordx2 s[8:9], s[0:1], 72
    s_waitcnt lgkmcnt(0)
    s_add_u32 s12, s6, 20971520
    s_addc_u32 s13, s7, 0
    s_mov_b32 s14, 4194304
    s_mov_b32 s15, 0x20000
    s_add_u32 s16, s6, 41943040
    s_addc_u32 s17, s7, 0
    s_mov_b32 s18, 8388608
    s_mov_b32 s19, 0x20000
    s_add_u32 s20, s6, 50331648
    s_addc_u32 s21, s7, 0
    s_mov_b32 s22, 8388608
    s_mov_b32 s23, 0x20000
    s_add_u32 s24, s6, 20971520
    s_addc_u32 s25, s7, 0
    s_mov_b32 s26, 4194304
    s_mov_b32 s27, 0x20000
    s_mov_b32 s28, s6
    s_mov_b32 s29, s7
    s_mov_b32 s30, 4194304
    s_mov_b32 s31, 0x20000
    s_mov_b32 s32, 0xffff0000
    v_and_b32 v1, 63, v0
    v_lshrrev_b32 v2, 6, v0
    s_lshl_b32 s3, s2, 2
    v_add_u32 v2, s3, v2
    v_lshlrev_b32 v3, 11, v2
    v_lshl_add_u32 v3, v1, 4, v3
    v_lshlrev_b32 v4, 12, v2
    v_lshl_add_u32 v4, v1, 5, v4
    buffer_load_dwordx4 v[8:11], v3, s[12:15], 0 offen
    buffer_load_dwordx4 v[12:15], v3, s[12:15], 0 offen offset:1024
    buffer_load_dwordx4 v[16:19], v4, s[16:19], 0 offen offset:0
    buffer_load_dwordx4 v[20:23], v4, s[16:19], 0 offen offset:16
    buffer_load_dwordx4 v[24:27], v4, s[16:19], 0 offen offset:2048
    buffer_load_dwordx4 v[28:31], v4, s[16:19], 0 offen offset:2064
    buffer_load_dwordx4 v[32:35], v4, s[20:23], 0 offen offset:0
    buffer_load_dwordx4 v[36:39], v4, s[20:23], 0 offen offset:16
    buffer_load_dwordx4 v[40:43], v4, s[20:23], 0 offen offset:2048
    buffer_load_dwordx4 v[44:47], v4, s[20:23], 0 offen offset:2064
    s_waitcnt vmcnt(0)
    v_lshlrev_b32 v48, 16, v8
    v_and_b32 v49, s32, v8
    v_lshlrev_b32 v50, 16, v9
    v_and_b32 v51, s32, v9
    v_lshlrev_b32 v52, 16, v10
    v_and_b32 v53, s32, v10
    v_lshlrev_b32 v54, 16, v11
    v_and_b32 v55, s32, v11
    v_lshlrev_b32 v56, 16, v12
    v_and_b32 v57, s32, v12
    v_lshlrev_b32 v58, 16, v13
    v_and_b32 v59, s32, v13
    v_lshlrev_b32 v60, 16, v14
    v_and_b32 v61, s32, v14
    v_lshlrev_b32 v62, 16, v15
    v_and_b32 v63, s32, v15
    v_add_f32 v64, v16, v32
    v_add_f32 v65, v17, v33
    v_add_f32 v66, v18, v34
    v_add_f32 v67, v19, v35
    v_add_f32 v68, v20, v36
    v_add_f32 v69, v21, v37
    v_add_f32 v70, v22, v38
    v_add_f32 v71, v23, v39
    v_add_f32 v72, v24, v40
    v_add_f32 v73, v25, v41
    v_add_f32 v74, v26, v42
    v_add_f32 v75, v27, v43
    v_add_f32 v76, v28, v44
    v_add_f32 v77, v29, v45
    v_add_f32 v78, v30, v46
    v_add_f32 v79, v31, v47
    v_cvt_pk_bf16_f32 v80, v64, v65
    v_cvt_pk_bf16_f32 v81, v66, v67
    v_cvt_pk_bf16_f32 v82, v68, v69
    v_cvt_pk_bf16_f32 v83, v70, v71
    v_cvt_pk_bf16_f32 v84, v72, v73
    v_cvt_pk_bf16_f32 v85, v74, v75
    v_cvt_pk_bf16_f32 v86, v76, v77
    v_cvt_pk_bf16_f32 v87, v78, v79
    v_lshlrev_b32 v64, 16, v80
    v_and_b32 v65, s32, v80
    v_lshlrev_b32 v66, 16, v81
    v_and_b32 v67, s32, v81
    v_lshlrev_b32 v68, 16, v82
    v_and_b32 v69, s32, v82
    v_lshlrev_b32 v70, 16, v83
    v_and_b32 v71, s32, v83
    v_lshlrev_b32 v72, 16, v84
    v_and_b32 v73, s32, v84
    v_lshlrev_b32 v74, 16, v85
    v_and_b32 v75, s32, v85
    v_lshlrev_b32 v76, 16, v86
    v_and_b32 v77, s32, v86
    v_lshlrev_b32 v78, 16, v87
    v_and_b32 v79, s32, v87
    v_add_f32 v48, v48, v64
    v_add_f32 v49, v49, v65
    v_add_f32 v50, v50, v66
    v_add_f32 v51, v51, v67
    v_add_f32 v52, v52, v68
    v_add_f32 v53, v53, v69
    v_add_f32 v54, v54, v70
    v_add_f32 v55, v55, v71
    v_add_f32 v56, v56, v72
    v_add_f32 v57, v57, v73
    v_add_f32 v58, v58, v74
    v_add_f32 v59, v59, v75
    v_add_f32 v60, v60, v76
    v_add_f32 v61, v61, v77
    v_add_f32 v62, v62, v78
    v_add_f32 v63, v63, v79
    v_cvt_pk_bf16_f32 v80, v48, v49
    v_cvt_pk_bf16_f32 v81, v50, v51
    v_cvt_pk_bf16_f32 v82, v52, v53
    v_cvt_pk_bf16_f32 v83, v54, v55
    v_cvt_pk_bf16_f32 v84, v56, v57
    v_cvt_pk_bf16_f32 v85, v58, v59
    v_cvt_pk_bf16_f32 v86, v60, v61
    v_cvt_pk_bf16_f32 v87, v62, v63
    v_lshlrev_b32 v48, 16, v80
    v_and_b32 v49, s32, v80
    v_lshlrev_b32 v50, 16, v81
    v_and_b32 v51, s32, v81
    v_lshlrev_b32 v52, 16, v82
    v_and_b32 v53, s32, v82
    v_lshlrev_b32 v54, 16, v83
    v_and_b32 v55, s32, v83
    v_lshlrev_b32 v56, 16, v84
    v_and_b32 v57, s32, v84
    v_lshlrev_b32 v58, 16, v85
    v_and_b32 v59, s32, v85
    v_lshlrev_b32 v60, 16, v86
    v_and_b32 v61, s32, v86
    v_lshlrev_b32 v62, 16, v87
    v_and_b32 v63, s32, v87
    buffer_store_dwordx4 v[80:83], v3, s[24:27], 0 offen
    buffer_store_dwordx4 v[84:87], v3, s[24:27], 0 offen offset:1024
    v_add_f32 v88, v48, v49
    v_add_f32 v88, v88, v50
    v_add_f32 v88, v88, v51
    v_add_f32 v88, v88, v52
    v_add_f32 v88, v88, v53
    v_add_f32 v88, v88, v54
    v_add_f32 v88, v88, v55
    v_add_f32 v88, v88, v56
    v_add_f32 v88, v88, v57
    v_add_f32 v88, v88, v58
    v_add_f32 v88, v88, v59
    v_add_f32 v88, v88, v60
    v_add_f32 v88, v88, v61
    v_add_f32 v88, v88, v62
    v_add_f32 v88, v88, v63
    s_nop 1
    v_add_f32_dpp v88, v88, v88 row_shr:1 row_mask:0xf bank_mask:0xf
    s_nop 1
    v_add_f32_dpp v88, v88, v88 row_shr:2 row_mask:0xf bank_mask:0xf
    s_nop 1
    v_add_f32_dpp v88, v88, v88 row_shr:4 row_mask:0xf bank_mask:0xf
    s_nop 1
    v_add_f32_dpp v88, v88, v88 row_shr:8 row_mask:0xf bank_mask:0xf
    s_nop 1
    v_add_f32_dpp v88, v88, v88 row_bcast:15 row_mask:0xa bank_mask:0xf
    s_nop 1
    v_add_f32_dpp v88, v88, v88 row_bcast:31 row_mask:0xc bank_mask:0xf
    s_nop 1
    v_readlane_b32 s34, v88, 63
    s_nop 1
    v_mov_b32 v89, 0x3a800000
    v_mul_f32 v89, s34, v89
    v_cvt_pk_bf16_f32 v90, v89, v89
    v_and_b32 v90, s32, v90
    v_sub_f32 v91, v48, v89
    v_mul_f32 v88, v91, v91
    v_sub_f32 v91, v49, v89
    v_fmac_f32 v88, v91, v91
    v_sub_f32 v91, v50, v89
    v_fmac_f32 v88, v91, v91
    v_sub_f32 v91, v51, v89
    v_fmac_f32 v88, v91, v91
    v_sub_f32 v91, v52, v89
    v_fmac_f32 v88, v91, v91
    v_sub_f32 v91, v53, v89
    v_fmac_f32 v88, v91, v91
    v_sub_f32 v91, v54, v89
    v_fmac_f32 v88, v91, v91
    v_sub_f32 v91, v55, v89
    v_fmac_f32 v88, v91, v91
    v_sub_f32 v91, v56, v89
    v_fmac_f32 v88, v91, v91
    v_sub_f32 v91, v57, v89
    v_fmac_f32 v88, v91, v91
    v_sub_f32 v91, v58, v89
    v_fmac_f32 v88, v91, v91
    v_sub_f32 v91, v59, v89
    v_fmac_f32 v88, v91, v91
    v_sub_f32 v91, v60, v89
    v_fmac_f32 v88, v91, v91
    v_sub_f32 v91, v61, v89
    v_fmac_f32 v88, v91, v91
    v_sub_f32 v91, v62, v89
    v_fmac_f32 v88, v91, v91
    v_sub_f32 v91, v63, v89
    v_fmac_f32 v88, v91, v91
    s_nop 1
    v_add_f32_dpp v88, v88, v88 row_shr:1 row_mask:0xf bank_mask:0xf
    s_nop 1
    v_add_f32_dpp v88, v88, v88 row_shr:2 row_mask:0xf bank_mask:0xf
    s_nop 1
    v_add_f32_dpp v88, v88, v88 row_shr:4 row_mask:0xf bank_mask:0xf
    s_nop 1
    v_add_f32_dpp v88, v88, v88 row_shr:8 row_mask:0xf bank_mask:0xf
    s_nop 1
    v_add_f32_dpp v88, v88, v88 row_bcast:15 row_mask:0xa bank_mask:0xf
    s_nop 1
    v_add_f32_dpp v88, v88, v88 row_bcast:31 row_mask:0xc bank_mask:0xf
    s_nop 1
    v_readlane_b32 s35, v88, 63
    s_nop 1
    v_mov_b32 v92, 0x3a800000
    v_mul_f32 v92, s35, v92
    v_cvt_pk_bf16_f32 v92, v92, v92
    v_and_b32 v92, s32, v92
    v_add_f32 v92, 0x3727c5ac, v92
    v_cvt_pk_bf16_f32 v92, v92, v92
    v_and_b32 v92, s32, v92
    v_sqrt_f32 v92, v92
    s_nop 0
    v_cvt_pk_bf16_f32 v92, v92, v92
    v_and_b32 v92, s32, v92
    v_rcp_f32 v93, v92
    v_sub_f32 v64, v48, v90
    v_sub_f32 v65, v49, v90
    v_sub_f32 v66, v50, v90
    v_sub_f32 v67, v51, v90
    v_sub_f32 v68, v52, v90
    v_sub_f32 v69, v53, v90
    v_sub_f32 v70, v54, v90
    v_sub_f32 v71, v55, v90
    v_sub_f32 v72, v56, v90
    v_sub_f32 v73, v57, v90
    v_sub_f32 v74, v58, v90
    v_sub_f32 v75, v59, v90
    v_sub_f32 v76, v60, v90
    v_sub_f32 v77, v61, v90
    v_sub_f32 v78, v62, v90
    v_sub_f32 v79, v63, v90
    v_cvt_pk_bf16_f32 v80, v64, v65
    v_cvt_pk_bf16_f32 v81, v66, v67
    v_cvt_pk_bf16_f32 v82, v68, v69
    v_cvt_pk_bf16_f32 v83, v70, v71
    v_cvt_pk_bf16_f32 v84, v72, v73
    v_cvt_pk_bf16_f32 v85, v74, v75
    v_cvt_pk_bf16_f32 v86, v76, v77
    v_cvt_pk_bf16_f32 v87, v78, v79
    v_lshlrev_b32 v64, 16, v80
    v_and_b32 v65, s32, v80
    v_lshlrev_b32 v66, 16, v81
    v_and_b32 v67, s32, v81
    v_lshlrev_b32 v68, 16, v82
    v_and_b32 v69, s32, v82
    v_lshlrev_b32 v70, 16, v83
    v_and_b32 v71, s32, v83
    v_lshlrev_b32 v72, 16, v84
    v_and_b32 v73, s32, v84
    v_lshlrev_b32 v74, 16, v85
    v_and_b32 v75, s32, v85
    v_lshlrev_b32 v76, 16, v86
    v_and_b32 v77, s32, v86
    v_lshlrev_b32 v78, 16, v87
    v_and_b32 v79, s32, v87
    v_mul_f32 v48, v64, v93
    v_mul_f32 v49, v65, v93
    v_mul_f32 v50, v66, v93
    v_mul_f32 v51, v67, v93
    v_mul_f32 v52, v68, v93
    v_mul_f32 v53, v69, v93
    v_mul_f32 v54, v70, v93
    v_mul_f32 v55, v71, v93
    v_mul_f32 v56, v72, v93
    v_mul_f32 v57, v73, v93
    v_mul_f32 v58, v74, v93
    v_mul_f32 v59, v75, v93
    v_mul_f32 v60, v76, v93
    v_mul_f32 v61, v77, v93
    v_mul_f32 v62, v78, v93
    v_mul_f32 v63, v79, v93
    v_fma_f32 v64, -v48, v92, v64
    v_fma_f32 v65, -v49, v92, v65
    v_fma_f32 v66, -v50, v92, v66
    v_fma_f32 v67, -v51, v92, v67
    v_fma_f32 v68, -v52, v92, v68
    v_fma_f32 v69, -v53, v92, v69
    v_fma_f32 v70, -v54, v92, v70
    v_fma_f32 v71, -v55, v92, v71
    v_fma_f32 v72, -v56, v92, v72
    v_fma_f32 v73, -v57, v92, v73
    v_fma_f32 v74, -v58, v92, v74
    v_fma_f32 v75, -v59, v92, v75
    v_fma_f32 v76, -v60, v92, v76
    v_fma_f32 v77, -v61, v92, v77
    v_fma_f32 v78, -v62, v92, v78
    v_fma_f32 v79, -v63, v92, v79
    v_fmac_f32 v48, v64, v93
    v_fmac_f32 v49, v65, v93
    v_fmac_f32 v50, v66, v93
    v_fmac_f32 v51, v67, v93
    v_fmac_f32 v52, v68, v93
    v_fmac_f32 v53, v69, v93
    v_fmac_f32 v54, v70, v93
    v_fmac_f32 v55, v71, v93
    v_fmac_f32 v56, v72, v93
    v_fmac_f32 v57, v73, v93
    v_fmac_f32 v58, v74, v93
    v_fmac_f32 v59, v75, v93
    v_fmac_f32 v60, v76, v93
    v_fmac_f32 v61, v77, v93
    v_fmac_f32 v62, v78, v93
    v_fmac_f32 v63, v79, v93
    v_cvt_pk_bf16_f32 v96, v48, v49
    v_cvt_pk_bf16_f32 v97, v50, v51
    v_cvt_pk_bf16_f32 v98, v52, v53
    v_cvt_pk_bf16_f32 v99, v54, v55
    v_cvt_pk_bf16_f32 v100, v56, v57
    v_cvt_pk_bf16_f32 v101, v58, v59
    v_cvt_pk_bf16_f32 v102, v60, v61
    v_cvt_pk_bf16_f32 v103, v62, v63
    buffer_store_dwordx4 v[96:99], v3, s[28:31], 0 offen
    buffer_store_dwordx4 v[100:103], v3, s[28:31], 0 offen offset:1024
ln_b_kernel_end:
    s_endpgm
.section .rodata,"a"
.p2align 6
.amdhsa_kernel ln_b_kernel
  .amdhsa_next_free_vgpr 104
  .amdhsa_next_free_sgpr 40
  .amdhsa_accum_offset 104
  .amdhsa_group_segment_fixed_size 0
  .amdhsa_kernarg_size 96
  .amdhsa_user_sgpr_count 2
  .amdhsa_user_sgpr_kernarg_segment_ptr 1
  .amdhsa_system_sgpr_workgroup_id_x 1
  .amdhsa_float_denorm_mode_32 3
  .amdhsa_float_denorm_mode_16_64 3
.end_amdhsa_kernel

.text
.globl ln_final_kernel
.p2align 8
.type ln_final_kernel,@function
ln_final_kernel:
    s_cmp_ge_u32 s2, 512
    s_cbranch_scc1 ln_final_kernel_end
    s_load_dwordx2 s[4:5], s[0:1], 0
    s_load_dwordx2 s[6:7], s[0:1], 88
    s_load_dwordx2 s[8:9], s[0:1], 72
    s_waitcnt lgkmcnt(0)
    s_add_u32 s12, s6, 20971520
    s_addc_u32 s13, s7, 0
    s_mov_b32 s14, 4194304
    s_mov_b32 s15, 0x20000
    s_add_u32 s16, s6, 41943040
    s_addc_u32 s17, s7, 0
    s_mov_b32 s18, 8388608
    s_mov_b32 s19, 0x20000
    s_add_u32 s20, s6, 50331648
    s_addc_u32 s21, s7, 0
    s_mov_b32 s22, 8388608
    s_mov_b32 s23, 0x20000
    s_mov_b32 s24, s8
    s_mov_b32 s25, s9
    s_mov_b32 s26, 4194304
    s_mov_b32 s27, 0x20000
    s_mov_b32 s32, 0xffff0000
    v_and_b32 v1, 63, v0
    v_lshrrev_b32 v2, 6, v0
    s_lshl_b32 s3, s2, 2
    v_add_u32 v2, s3, v2
    v_lshlrev_b32 v3, 11, v2
    v_lshl_add_u32 v3, v1, 4, v3
    v_lshlrev_b32 v4, 12, v2
    v_lshl_add_u32 v4, v1, 5, v4
    buffer_load_dwordx4 v[8:11], v3, s[12:15], 0 offen
    buffer_load_dwordx4 v[12:15], v3, s[12:15], 0 offen offset:1024
    buffer_load_dwordx4 v[16:19], v4, s[16:19], 0 offen offset:0
    buffer_load_dwordx4 v[20:23], v4, s[16:19], 0 offen offset:16
    buffer_load_dwordx4 v[24:27], v4, s[16:19], 0 offen offset:2048
    buffer_load_dwordx4 v[28:31], v4, s[16:19], 0 offen offset:2064
    buffer_load_dwordx4 v[32:35], v4, s[20:23], 0 offen offset:0
    buffer_load_dwordx4 v[36:39], v4, s[20:23], 0 offen offset:16
    buffer_load_dwordx4 v[40:43], v4, s[20:23], 0 offen offset:2048
    buffer_load_dwordx4 v[44:47], v4, s[20:23], 0 offen offset:2064
    s_waitcnt vmcnt(0)
    v_lshlrev_b32 v48, 16, v8
    v_and_b32 v49, s32, v8
    v_lshlrev_b32 v50, 16, v9
    v_and_b32 v51, s32, v9
    v_lshlrev_b32 v52, 16, v10
    v_and_b32 v53, s32, v10
    v_lshlrev_b32 v54, 16, v11
    v_and_b32 v55, s32, v11
    v_lshlrev_b32 v56, 16, v12
    v_and_b32 v57, s32, v12
    v_lshlrev_b32 v58, 16, v13
    v_and_b32 v59, s32, v13
    v_lshlrev_b32 v60, 16, v14
    v_and_b32 v61, s32, v14
    v_lshlrev_b32 v62, 16, v15
    v_and_b32 v63, s32, v15
    v_add_f32 v64, v16, v32
    v_add_f32 v65, v17, v33
    v_add_f32 v66, v18, v34
    v_add_f32 v67, v19, v35
    v_add_f32 v68, v20, v36
    v_add_f32 v69, v21, v37
    v_add_f32 v70, v22, v38
    v_add_f32 v71, v23, v39
    v_add_f32 v72, v24, v40
    v_add_f32 v73, v25, v41
    v_add_f32 v74, v26, v42
    v_add_f32 v75, v27, v43
    v_add_f32 v76, v28, v44
    v_add_f32 v77, v29, v45
    v_add_f32 v78, v30, v46
    v_add_f32 v79, v31, v47
    v_cvt_pk_bf16_f32 v80, v64, v65
    v_cvt_pk_bf16_f32 v81, v66, v67
    v_cvt_pk_bf16_f32 v82, v68, v69
    v_cvt_pk_bf16_f32 v83, v70, v71
    v_cvt_pk_bf16_f32 v84, v72, v73
    v_cvt_pk_bf16_f32 v85, v74, v75
    v_cvt_pk_bf16_f32 v86, v76, v77
    v_cvt_pk_bf16_f32 v87, v78, v79
    v_lshlrev_b32 v64, 16, v80
    v_and_b32 v65, s32, v80
    v_lshlrev_b32 v66, 16, v81
    v_and_b32 v67, s32, v81
    v_lshlrev_b32 v68, 16, v82
    v_and_b32 v69, s32, v82
    v_lshlrev_b32 v70, 16, v83
    v_and_b32 v71, s32, v83
    v_lshlrev_b32 v72, 16, v84
    v_and_b32 v73, s32, v84
    v_lshlrev_b32 v74, 16, v85
    v_and_b32 v75, s32, v85
    v_lshlrev_b32 v76, 16, v86
    v_and_b32 v77, s32, v86
    v_lshlrev_b32 v78, 16, v87
    v_and_b32 v79, s32, v87
    v_add_f32 v48, v48, v64
    v_add_f32 v49, v49, v65
    v_add_f32 v50, v50, v66
    v_add_f32 v51, v51, v67
    v_add_f32 v52, v52, v68
    v_add_f32 v53, v53, v69
    v_add_f32 v54, v54, v70
    v_add_f32 v55, v55, v71
    v_add_f32 v56, v56, v72
    v_add_f32 v57, v57, v73
    v_add_f32 v58, v58, v74
    v_add_f32 v59, v59, v75
    v_add_f32 v60, v60, v76
    v_add_f32 v61, v61, v77
    v_add_f32 v62, v62, v78
    v_add_f32 v63, v63, v79
    v_cvt_pk_bf16_f32 v80, v48, v49
    v_cvt_pk_bf16_f32 v81, v50, v51
    v_cvt_pk_bf16_f32 v82, v52, v53
    v_cvt_pk_bf16_f32 v83, v54, v55
    v_cvt_pk_bf16_f32 v84, v56, v57
    v_cvt_pk_bf16_f32 v85, v58, v59
    v_cvt_pk_bf16_f32 v86, v60, v61
    v_cvt_pk_bf16_f32 v87, v62, v63
    v_lshlrev_b32 v48, 16, v80
    v_and_b32 v49, s32, v80
    v_lshlrev_b32 v50, 16, v81
    v_and_b32 v51, s32, v81
    v_lshlrev_b32 v52, 16, v82
    v_and_b32 v53, s32, v82
    v_lshlrev_b32 v54, 16, v83
    v_and_b32 v55, s32, v83
    v_lshlrev_b32 v56, 16, v84
    v_and_b32 v57, s32, v84
    v_lshlrev_b32 v58, 16, v85
    v_and_b32 v59, s32, v85
    v_lshlrev_b32 v60, 16, v86
    v_and_b32 v61, s32, v86
    v_lshlrev_b32 v62, 16, v87
    v_and_b32 v63, s32, v87
    buffer_store_dwordx4 v[80:83], v3, s[24:27], 0 offen
    buffer_store_dwordx4 v[84:87], v3, s[24:27], 0 offen offset:1024
ln_final_kernel_end:
    s_endpgm
.section .rodata,"a"
.p2align 6
.amdhsa_kernel ln_final_kernel
  .amdhsa_next_free_vgpr 88
  .amdhsa_next_free_sgpr 40
  .amdhsa_accum_offset 88
  .amdhsa_group_segment_fixed_size 0
  .amdhsa_kernarg_size 96
  .amdhsa_user_sgpr_count 2
  .amdhsa_user_sgpr_kernarg_segment_ptr 1
  .amdhsa_system_sgpr_workgroup_id_x 1
  .amdhsa_float_denorm_mode_32 3
  .amdhsa_float_denorm_mode_16_64 3
.end_amdhsa_kernel
```
